```python
import torch

def _softmax(x, axis=-1):
    return torch.softmax(x, dim=axis)
def _gelu(x):
    return torch.nn.functional.gelu(x, approximate="tanh")
def _silu(x):
    return torch.nn.functional.silu(x)
def _sigmoid(x):
    return torch.sigmoid(x)
def _layernorm(x, axis=-1, eps=1e-5):
    m = x.mean(dim=axis, keepdim=True)
    v = x.var(dim=axis, keepdim=True, unbiased=False)
    return (x - m) / torch.sqrt(v + eps)
def _scatter_add(tgt, idx, src, axis=0):
    return tgt.clone().index_add_(axis, idx, src)
def _segment_sum(src, seg, n):
    out = torch.zeros((n,) + src.shape[1:], dtype=src.dtype)
    return out.index_add_(0, seg, src)
def _pad(x, pw):
    flat = tuple(v for pair in reversed(pw) for v in pair)
    return torch.nn.functional.pad(x, flat)

kernel_name = 'gather_scatter__edge_featured_mpnn_mpnn__graph'

def setup_inputs():

    _w = (lambda a: (lambda t: t.to(torch.bfloat16) if t.is_floating_point() else t)(torch.as_tensor(a)))
    N, deg, D, De = 25000, 16, 128, max(16, 1)
    E = N * deg
    H = 2 * D
    return {
        "x": _w((lambda *s: torch.randn(*s, dtype=torch.bfloat16) * 0.05)(N, D)),
        "e_attr": _w((lambda *s: torch.randn(*s, dtype=torch.bfloat16) * 0.8)(E, De)),
        "src": _w((lambda lo, hi, *s: torch.randint(lo, hi, s))(0, N, E).to(torch.int64)),
        "dst": _w((lambda lo, hi, *s: torch.randint(lo, hi, s))(0, N, E).to(torch.int64)),
        "w1": _w((lambda *s: torch.randn(*s, dtype=torch.bfloat16) * 0.8)(2 * D + De, H) * (1.0 / (2 * D + De) ** 0.5)),
        "b1": _w((lambda *s: torch.randn(*s, dtype=torch.bfloat16) * 0.4)(H) * 0.01),
        "w2": _w((lambda *s: torch.randn(*s, dtype=torch.bfloat16) * 0.05)(H, D) * (1.0 / H ** 0.5)),
        "b2": _w((lambda *s: torch.randn(*s, dtype=torch.bfloat16) * 0.05)(D) * 0.01),
    }

def reference(x, e_attr, src, dst, w1, b1, w2, b2):
    N, D = x.shape
    h_src = x[src]
    h_dst = x[dst]
    m_in = torch.concatenate([h_src, h_dst, e_attr], axis=-1)
    h = _silu(m_in @ w1 + b1)
    msg = h @ w2 + b2
    return _segment_sum(msg, dst, N)
```

```asm
; @launch grid=(256,1,1) block=(512,1,1) lds=163840
.amdgcn_target "amdgcn-amd-amdhsa--gfx950"
.text
  .globl gather_scatter__edge_featured_mpnn_mpnn__graph_kernel
  .p2align 8
  .type gather_scatter__edge_featured_mpnn_mpnn__graph_kernel,@function
gather_scatter__edge_featured_mpnn_mpnn__graph_kernel:
  s_cmp_ge_u32 s2, 256
  s_cbranch_scc1 V_END
  s_load_dwordx16 s[64:79], s[0:1], 0
  s_load_dwordx4 s[80:83], s[0:1], 64
  s_load_dwordx2 s[60:61], s[0:1], 80
  s_getpc_b64 s[4:5]
V_PC:
  s_add_u32 s4, s4, V_TAB-V_PC
  s_addc_u32 s5, s5, 0
  v_and_b32 v1, 63, v0
  v_lshrrev_b32 v2, 6, v0
  v_lshlrev_b32 v3, 4, v0
  v_readfirstlane_b32 s3, v2
  v_lshlrev_b32 v4, 4, v1
  v_and_b32 v7, 31, v1
  v_lshrrev_b32 v6, 5, v1
  v_mov_b32 v44, 0
  v_lshlrev_b32 v45, 2, v0
  s_mul_i32 s48, s2, 6256
  s_mul_i32 s36, s2, 98
  v_cmp_gt_u32 vcc, 256, v0
  s_and_saveexec_b64 s[50:51], vcc
  ds_write_b32 v45, v44 offset:0
  s_mov_b64 exec, s[50:51]
  ds_write_b32 v44, v44 offset:3108
  ds_write_b32 v44, v44 offset:3112
  ds_write_b32 v44, v44 offset:3116
  ds_write_b32 v44, v44 offset:3120
  ds_write_b32 v44, v44 offset:3136
  ds_write_b32 v44, v44 offset:3140
  ds_write_b32 v44, v44 offset:3144
  ds_write_b32 v44, v44 offset:3148
  s_waitcnt lgkmcnt(0)
  s_mov_b32 s32, s70
  s_mov_b32 s33, s71
  s_mov_b32 s34, 0x186a00
  s_mov_b32 s35, 0x00020000
  buffer_load_dwordx4 v[64:67], v3, s[32:35], s48 offen
  s_mov_b32 s8, s68
  s_mov_b32 s9, s69
  s_mov_b32 s10, 0x186a00
  s_mov_b32 s11, 0x00020000
  buffer_load_dwordx4 v[68:71], v3, s[8:11], s48 offen
  s_mov_b32 s16, s72
  s_mov_b32 s17, s73
  s_mov_b32 s18, 0x22000
  s_mov_b32 s19, 0x00020000
  v_lshlrev_b32 v48, 1, v6
  v_xor_b32 v48, v48, v7
  v_lshlrev_b32 v48, 4, v48
  v_lshl_add_u32 v48, v6, 9, v48
  v_xor_b32 v49, 64, v48
  v_xor_b32 v50, 128, v48
  v_xor_b32 v51, 192, v48
  s_lshr_b32 s53, s2, 3
  s_add_u32 s50, s53, s3
  s_and_b32 s50, s50, 7
  s_lshl_b32 s50, s50, 13
  s_add_u32 s51, s50, 32000
  s_add_u32 m0, s51, 0
  s_add_u32 s52, s50, 0
  buffer_load_dwordx4 v48, s[16:19], s52 offen offset:0 lds
  buffer_load_dwordx4 v49, s[16:19], s52 offen offset:1024 lds
  buffer_load_dwordx4 v48, s[16:19], s52 offen offset:2048 lds
  buffer_load_dwordx4 v49, s[16:19], s52 offen offset:3072 lds
  s_add_u32 m0, s51, 4096
  s_add_u32 s52, s50, 4096
  buffer_load_dwordx4 v50, s[16:19], s52 offen offset:0 lds
  buffer_load_dwordx4 v51, s[16:19], s52 offen offset:1024 lds
  buffer_load_dwordx4 v50, s[16:19], s52 offen offset:2048 lds
  buffer_load_dwordx4 v51, s[16:19], s52 offen offset:3072 lds
  s_barrier
  s_mov_b32 s28, s60
  s_mov_b32 s29, s61
  s_mov_b32 s30, 0x1200000
  s_mov_b32 s31, 0x00020000
  s_lshr_b32 s37, s3, 1
  s_and_b32 s38, s3, 1
  s_add_u32 s6, s4, 4096
  s_addc_u32 s7, s5, 0
  s_cmp_eq_u32 s3, 7
  s_cbranch_scc1 V_W7
  s_mul_i32 s54, s2, 1564
  s_sub_u32 s55, 400000, s54
  s_min_u32 s55, s55, 1564
  v_lshlrev_b32 v52, 2, v0
  s_mov_b32 s48, 42800
  s_mov_b32 s49, 0xffffff9e
  v_mov_b32 v53, 1
  v_add_lshl_u32 v54, v52, s54, 5
  v_cmp_gt_u32 vcc, s55, v52
  s_and_saveexec_b64 s[56:57], vcc
  s_mov_b64 s[58:59], exec
  s_waitcnt vmcnt(8)
  v_mul_u32_u24 v72, s48, v64
  v_lshrrev_b32 v72, 22, v72
  v_lshlrev_b32 v88, 2, v72
  ds_add_rtn_u32 v76, v88, v53 offset:0
  v_mul_u32_u24 v73, s48, v65
  v_lshrrev_b32 v73, 22, v73
  v_lshlrev_b32 v89, 2, v73
  ds_add_rtn_u32 v77, v89, v53 offset:0
  v_mul_u32_u24 v74, s48, v66
  v_lshrrev_b32 v74, 22, v74
  v_lshlrev_b32 v90, 2, v74
  ds_add_rtn_u32 v78, v90, v53 offset:0
  v_mul_u32_u24 v75, s48, v67
  v_lshrrev_b32 v75, 22, v75
  v_lshlrev_b32 v91, 2, v75
  ds_add_rtn_u32 v79, v91, v53 offset:0
  s_mov_b64 exec, s[56:57]
  s_mov_b32 s8, s64
  s_mov_b32 s9, s65
  s_mov_b32 s10, 0x61a800
  s_mov_b32 s11, 0x00020000
  v_lshrrev_b32 v59, 4, v1
  v_and_b32 v60, 15, v1
  v_xor_b32 v60, v60, v59
  s_and_b32 s53, s3, 3
  s_lshl_b32 s53, s53, 2
  v_xor_b32 v60, s53, v60
  v_lshlrev_b32 v60, 4, v60
  v_lshl_add_u32 v60, v59, 8, v60
  s_lshl_b32 s50, s36, 8
  s_lshl_b32 s51, s3, 10
  s_add_u32 s50, s50, s51
  s_add_u32 s51, s51, 6400
  s_add_u32 m0, s51, 0
  s_add_u32 s52, s50, 0
  buffer_load_dwordx4 v60, s[8:11], s52 offen lds
  s_add_u32 m0, s51, 8192
  s_add_u32 s52, s50, 8192
  buffer_load_dwordx4 v60, s[8:11], s52 offen lds
  s_add_u32 m0, s51, 16384
  s_add_u32 s52, s50, 16384
  buffer_load_dwordx4 v60, s[8:11], s52 offen lds
  s_mov_b64 exec, s[58:59]
  v_mad_i32_i24 v55, v72, s49, v64
  v_sub_u32 v56, v55, v53
  v_max_i32 v56, 0, v56
  v_mul_u32_u24 v56, 43, v56
  v_lshrrev_b32 v56, 10, v56
  v_min_u32 v56, 3, v56
  v_min_u32 v58, 1, v56
  v_sub_u32 v55, v55, v58
  v_mad_u32_u24 v55, v56, 8, v55
  v_mul_u32_u24 v57, 335, v68
  v_lshrrev_b32 v57, 19, v57
  v_lshl_add_u32 v57, v56, 4, v57
  v_lshlrev_b32 v80, 9, v68
  v_lshl_or_b32 v80, v55, 24, v80
  v_add_u32 v56, 0, v54
  v_lshl_or_b32 v81, v57, 24, v56
  v_mad_i32_i24 v55, v73, s49, v65
  v_sub_u32 v56, v55, v53
  v_max_i32 v56, 0, v56
  v_mul_u32_u24 v56, 43, v56
  v_lshrrev_b32 v56, 10, v56
  v_min_u32 v56, 3, v56
  v_min_u32 v58, 1, v56
  v_sub_u32 v55, v55, v58
  v_mad_u32_u24 v55, v56, 8, v55
  v_mul_u32_u24 v57, 335, v69
  v_lshrrev_b32 v57, 19, v57
  v_lshl_add_u32 v57, v56, 4, v57
  v_lshlrev_b32 v82, 9, v69
  v_lshl_or_b32 v82, v55, 24, v82
  v_add_u32 v56, 32, v54
  v_lshl_or_b32 v83, v57, 24, v56
  v_mad_i32_i24 v55, v74, s49, v66
  v_sub_u32 v56, v55, v53
  v_max_i32 v56, 0, v56
  v_mul_u32_u24 v56, 43, v56
  v_lshrrev_b32 v56, 10, v56
  v_min_u32 v56, 3, v56
  v_min_u32 v58, 1, v56
  v_sub_u32 v55, v55, v58
  v_mad_u32_u24 v55, v56, 8, v55
  v_mul_u32_u24 v57, 335, v70
  v_lshrrev_b32 v57, 19, v57
  v_lshl_add_u32 v57, v56, 4, v57
  v_lshlrev_b32 v84, 9, v70
  v_lshl_or_b32 v84, v55, 24, v84
  v_add_u32 v56, 64, v54
  v_lshl_or_b32 v85, v57, 24, v56
  v_mad_i32_i24 v55, v75, s49, v67
  v_sub_u32 v56, v55, v53
  v_max_i32 v56, 0, v56
  v_mul_u32_u24 v56, 43, v56
  v_lshrrev_b32 v56, 10, v56
  v_min_u32 v56, 3, v56
  v_min_u32 v58, 1, v56
  v_sub_u32 v55, v55, v58
  v_mad_u32_u24 v55, v56, 8, v55
  v_mul_u32_u24 v57, 335, v71
  v_lshrrev_b32 v57, 19, v57
  v_lshl_add_u32 v57, v56, 4, v57
  v_lshlrev_b32 v86, 9, v71
  v_lshl_or_b32 v86, v55, 24, v86
  v_add_u32 v56, 96, v54
  v_lshl_or_b32 v87, v57, 24, v56
  s_mov_b64 exec, s[56:57]
  s_branch V_T1D
V_W7:
  s_mov_b64 s[56:57], exec
  s_mov_b64 s[58:59], 0
  s_mov_b32 s8, s64
  s_mov_b32 s9, s65
  s_mov_b32 s10, 0x61a800
  s_mov_b32 s11, 0x00020000
  v_lshrrev_b32 v46, 4, v1
  v_and_b32 v47, 15, v1
  v_xor_b32 v47, v47, v46
  s_and_b32 s49, s3, 3
  s_lshl_b32 s49, s49, 2
  v_xor_b32 v47, s49, v47
  v_lshlrev_b32 v47, 4, v47
  v_lshl_add_u32 v47, v46, 8, v47
  s_lshl_b32 s50, s36, 8
  s_lshl_b32 s51, s3, 10
  s_add_u32 s50, s50, s51
  s_add_u32 s51, s51, 6400
  s_add_u32 m0, s51, 0
  s_add_u32 s52, s50, 0
  buffer_load_dwordx4 v47, s[8:11], s52 offen lds
  s_add_u32 m0, s51, 8192
  s_add_u32 s52, s50, 8192
  buffer_load_dwordx4 v47, s[8:11], s52 offen lds
  s_add_u32 m0, s51, 16384
  s_add_u32 s52, s50, 16384
  buffer_load_dwordx4 v47, s[8:11], s52 offen lds
  s_lshl_b32 s50, s36, 8
  v_lshrrev_b32 v46, 4, v1
  v_and_b32 v47, 15, v1
  v_xor_b32 v47, v47, v46
  v_lshlrev_b32 v47, 4, v47
  v_lshl_add_u32 v47, v46, 8, v47
  s_mov_b32 m0, 30976
  s_add_u32 s52, s50, 24576
  buffer_load_dwordx4 v47, s[8:11], s52 offen lds
  s_cmp_lg_u32 s2, 0
  s_cbranch_scc1 V_NN
  s_memrealtime s[48:49]
  s_waitcnt lgkmcnt(0)
  s_or_b32 s48, s48, 1
  v_mov_b32 v52, s48
  v_mov_b32 v53, 0
  s_mov_b64 exec, 1
  global_store_dword v53, v52, s[82:83] sc1
  s_mov_b64 exec, -1
V_NN:
  s_mov_b32 m0, 3328
  v_add_u32 v52, 2048, v4
  global_load_lds_dwordx4 v52, s[6:7]
  s_mov_b32 m0, 4352
  v_add_u32 v52, 3072, v4
  global_load_lds_dwordx4 v52, s[6:7]
  s_mov_b32 m0, 5376
  v_add_u32 v52, 4096, v4
  global_load_lds_dwordx4 v52, s[6:7]
  s_mov_b32 s32, s76
  s_mov_b32 s33, s77
  s_mov_b32 s34, 0x10000
  s_mov_b32 s35, 0x00020000
  s_and_b32 s48, s2, 3
  s_lshl_b32 s48, s48, 4
  v_lshrrev_b32 v52, 2, v1
  v_add_u32 v52, s48, v52
  v_and_b32 v53, 3, v1
  v_and_b32 v54, 31, v52
  v_lshrrev_b32 v55, 5, v52
  s_lshr_b32 s48, s2, 2
  s_and_b32 s50, s48, 1
  s_lshl_b32 s50, s50, 2
  v_lshrrev_b32 v56, 1, v53
  v_lshl_add_u32 v56, v56, 1, v55
  v_add_u32 v56, s50, v56
  s_bfe_u32 s50, s48, 0x20001
  v_and_b32 v57, 3, v56
  v_xor_b32 v57, s50, v57
  v_lshlrev_b32 v57, 2, v57
  v_lshl_add_u32 v56, v56, 4, v57
  v_and_b32 v57, 1, v53
  v_lshl_add_u32 v56, v57, 1, v56
  s_bfe_u32 s49, s48, 0x10003
  s_lshl_b32 s49, s49, 7
  v_add_u32 v56, s49, v56
  s_lshr_b32 s50, s48, 4
  s_lshl_b32 s50, s50, 6
  v_lshlrev_b32 v56, 8, v56
  v_lshl_add_u32 v56, v54, 1, v56
  buffer_load_ushort v92, v56, s[32:35], s50 offen
  buffer_load_ushort v93, v56, s[32:35], s50 offen offset:256
  v_mov_b32 v94, 0
  v_mov_b32 v95, 0
  s_cmp_ge_u32 s2, 32
  s_cbranch_scc1 V_T1D
  s_lshr_b32 s49, s48, 2
  s_lshl_b32 s49, s49, 7
  s_and_b32 s50, s48, 3
  v_lshrrev_b32 v56, 2, v54
  v_and_b32 v57, 3, v56
  v_xor_b32 v57, s50, v57
  v_lshlrev_b32 v57, 2, v57
  v_lshl_add_u32 v56, v56, 4, v57
  v_and_b32 v57, 3, v54
  v_add3_u32 v56, v56, v57, s49
  v_lshlrev_b32 v57, 3, v55
  v_lshl_add_u32 v57, v53, 1, v57
  v_add_u32 v57, 256, v57
  v_lshlrev_b32 v57, 9, v57
  v_lshl_add_u32 v57, v56, 1, v57
  buffer_load_ushort v94, v57, s[16:19], 0 offen
  buffer_load_ushort v95, v57, s[16:19], 0 offen offset:512
V_T1D:
  global_load_dwordx4 v[104:107], v4, s[4:5] offset:0
  global_load_dwordx4 v[108:111], v4, s[4:5] offset:1024
  global_load_dwordx4 v[32:35], v4, s[4:5] offset:2048
  global_load_dwordx4 v[28:31], v4, s[4:5] offset:3072
  global_load_dwordx4 v[36:39], v4, s[6:7] offset:0
  global_load_dwordx4 v[40:43], v4, s[6:7] offset:1024
  s_waitcnt lgkmcnt(0)
  s_barrier
  s_cmp_lg_u32 s3, 7
  s_cbranch_scc1 V_B
  ds_read_b128 v[48:51], v4 offset:0
  s_waitcnt lgkmcnt(0)
  v_add_u32 v55, v48, v49
  v_add_u32 v56, v55, v50
  v_add_u32 v57, v56, v51
  v_mov_b32 v58, v57
  s_nop 1
  v_add_u32_dpp v58, v58, v58 row_shr:1 row_mask:0xf bank_mask:0xf bound_ctrl:0
  s_nop 1
  v_add_u32_dpp v58, v58, v58 row_shr:2 row_mask:0xf bank_mask:0xf bound_ctrl:0
  s_nop 1
  v_add_u32_dpp v58, v58, v58 row_shr:4 row_mask:0xf bank_mask:0xf bound_ctrl:0
  s_nop 1
  v_add_u32_dpp v58, v58, v58 row_shr:8 row_mask:0xf bank_mask:0xf bound_ctrl:0
  s_nop 1
  v_add_u32_dpp v58, v58, v58 row_bcast:15 row_mask:0xa bank_mask:0xf
  s_nop 1
  v_add_u32_dpp v58, v58, v58 row_bcast:31 row_mask:0xc bank_mask:0xf
  v_sub_u32 v60, v58, v57
  v_add_u32 v61, v60, v48
  v_add_u32 v62, v60, v55
  v_add_u32 v63, v60, v56
  ds_write_b128 v4, v[60:63] offset:1024
  v_lshl_or_b32 v240, v48, 16, v60
  v_lshl_or_b32 v241, v49, 16, v61
  v_lshl_or_b32 v242, v50, 16, v62
  v_lshl_or_b32 v243, v51, 16, v63
V_B:
  s_waitcnt lgkmcnt(0)
  s_barrier
  s_mov_b64 exec, s[58:59]
  ds_read_b32 v72, v88 offset:1024
  ds_read_b32 v73, v89 offset:1024
  ds_read_b32 v74, v90 offset:1024
  ds_read_b32 v75, v91 offset:1024
  s_waitcnt lgkmcnt(0)
  v_add_lshl_u32 v72, v72, v76, 3
  v_add_u32 v72, 97536, v72
  ds_write_b64 v72, v[80:81]
  v_add_lshl_u32 v73, v73, v77, 3
  v_add_u32 v73, 97536, v73
  ds_write_b64 v73, v[82:83]
  v_add_lshl_u32 v74, v74, v78, 3
  v_add_u32 v74, 97536, v74
  ds_write_b64 v74, v[84:85]
  v_add_lshl_u32 v75, v75, v79, 3
  v_add_u32 v75, 97536, v75
  ds_write_b64 v75, v[86:87]
  s_mov_b64 exec, s[56:57]
  v_add_u32 v44, 97536, v3
  s_mul_i32 s48, s2, 12512
  s_add_u32 s48, s48, 0xd00000
  v_mov_b32 v245, 0
  v_cmp_gt_u32 vcc, 4320, v3
  v_mov_b32 v45, 18874368
  v_cndmask_b32 v45, v45, v3, vcc
  s_waitcnt lgkmcnt(0)
  s_barrier
  ds_read_b128 v[64:67], v44
  ds_read_b128 v[68:71], v44 offset:8192
  s_waitcnt lgkmcnt(0)
  buffer_store_dwordx4 v[64:67], v3, s[28:31], s48 offen sc1
  s_add_u32 s48, s48, 8192
  buffer_store_dwordx4 v[68:71], v45, s[28:31], s48 offen sc1
  global_load_dword v244, v245, s[82:83] sc1
  s_waitcnt vmcnt(3)
  s_barrier
  s_and_b32 s48, s3, 3
  s_lshl_b32 s48, s48, 13
  v_add_u32 v44, s48, v40
  v_xor_b32 v216, 0, v44
  v_xor_b32 v217, 64, v44
  v_xor_b32 v218, 128, v44
  v_xor_b32 v219, 192, v44
  v_add_u32 v220, 4096, v216
  v_add_u32 v221, 4096, v217
  v_add_u32 v222, 4096, v218
  v_add_u32 v223, 4096, v219
  ds_read_b128 v[48:51], v216
  ds_read_b128 v[52:55], v217
  ds_read_b128 v[56:59], v218
  ds_read_b128 v[60:63], v219
  ds_read_b128 v[224:227], v220
  ds_read_b128 v[228:231], v221
  ds_read_b128 v[232:235], v222
  ds_read_b128 v[236:239], v223
  s_lshr_b32 s49, s3, 2
  s_lshl_b32 s49, s49, 8
  v_add_u32 v44, s49, v38
  v_xor_b32 v208, 0, v44
  v_xor_b32 v209, 40, v44
  v_xor_b32 v210, 80, v44
  v_xor_b32 v211, 120, v44
  v_xor_b32 v212, 128, v44
  v_xor_b32 v213, 168, v44
  v_xor_b32 v214, 208, v44
  v_xor_b32 v215, 248, v44
  s_cmp_lg_u32 s3, 7
  s_cbranch_scc1 V_P
  v_lshl_or_b32 v92, v93, 16, v92
  v_lshlrev_b32 v45, 2, v1
  s_lshl_b32 s49, s2, 8
  s_add_u32 s50, s49, 0x11a0000
  buffer_store_dword v92, v45, s[28:31], s50 offen sc1
  s_mov_b32 s50, 0xbfb8aa3b
  v_lshlrev_b32 v94, 16, v94
  v_lshlrev_b32 v95, 16, v95
  v_mul_f32 v94, s50, v94
  v_mul_f32 v95, s50, v95
  v_cvt_pk_bf16_f32 v94, v94, v95
  v_and_b32 v100, 0x7fff7fff, v94
  v_lshrrev_b32 v101, 16, v100
  v_and_b32 v100, 0xffff, v100
  v_max_u32 v100, v100, v101
  s_cmp_ge_u32 s2, 32
  s_cbranch_scc1 V_P2
  s_add_u32 s50, s49, 0x1194000
  buffer_store_dword v94, v45, s[28:31], s50 offen sc1
V_P2:
  s_nop 1
  v_max_u32_dpp v100, v100, v100 row_shr:1 row_mask:0xf bank_mask:0xf
  s_nop 1
  v_max_u32_dpp v100, v100, v100 row_shr:2 row_mask:0xf bank_mask:0xf
  s_nop 1
  v_max_u32_dpp v100, v100, v100 row_shr:4 row_mask:0xf bank_mask:0xf
  s_nop 1
  v_max_u32_dpp v100, v100, v100 row_shr:8 row_mask:0xf bank_mask:0xf
  s_nop 1
  v_max_u32_dpp v100, v100, v100 row_bcast:15 row_mask:0xa bank_mask:0xf
  s_nop 1
  v_max_u32_dpp v100, v100, v100 row_bcast:31 row_mask:0xc bank_mask:0xf
  s_nop 0
  v_readlane_b32 s98, v100, 63
V_P:
  s_waitcnt lgkmcnt(0)
  ds_read_b64_tr_b16 v[72:73], v208 offset:0
  ds_read_b64_tr_b16 v[74:75], v208 offset:2048
  ds_read_b64_tr_b16 v[76:77], v208 offset:16384
  ds_read_b64_tr_b16 v[78:79], v208 offset:18432
  ds_read_b64_tr_b16 v[80:81], v208 offset:32768
  ds_read_b64_tr_b16 v[82:83], v208 offset:34816
  ds_read_b64_tr_b16 v[84:85], v208 offset:49152
  ds_read_b64_tr_b16 v[86:87], v208 offset:51200
  ds_read_b64_tr_b16 v[88:89], v209 offset:0
  ds_read_b64_tr_b16 v[90:91], v209 offset:2048
  ds_read_b64_tr_b16 v[92:93], v209 offset:16384
  ds_read_b64_tr_b16 v[94:95], v209 offset:18432
  ds_read_b64_tr_b16 v[96:97], v209 offset:32768
  ds_read_b64_tr_b16 v[98:99], v209 offset:34816
  ds_read_b64_tr_b16 v[100:101], v209 offset:49152
  ds_read_b64_tr_b16 v[102:103], v209 offset:51200
  v_xor_b32 v45, v6, v7
  v_lshlrev_b32 v45, 4, v45
  v_lshl_add_u32 v45, v6, 9, v45
  v_xor_b32 v46, 32, v45
  s_lshr_b32 s49, s2, 3
  s_add_u32 s49, s49, s3
  s_and_b32 s49, s49, 7
  s_lshl_b32 s49, s49, 13
  s_add_u32 s51, s49, 97536
  s_add_u32 s50, s49, 65536
  s_waitcnt lgkmcnt(0)
  ds_read_b64_tr_b16 v[112:113], v210 offset:0
  ds_read_b64_tr_b16 v[114:115], v210 offset:2048
  ds_read_b64_tr_b16 v[116:117], v210 offset:16384
  ds_read_b64_tr_b16 v[118:119], v210 offset:18432
  ds_read_b64_tr_b16 v[120:121], v210 offset:32768
  ds_read_b64_tr_b16 v[122:123], v210 offset:34816
  ds_read_b64_tr_b16 v[124:125], v210 offset:49152
  ds_read_b64_tr_b16 v[126:127], v210 offset:51200
  ds_read_b64_tr_b16 v[128:129], v211 offset:0
  ds_read_b64_tr_b16 v[130:131], v211 offset:2048
  ds_read_b64_tr_b16 v[132:133], v211 offset:16384
  ds_read_b64_tr_b16 v[134:135], v211 offset:18432
  ds_read_b64_tr_b16 v[136:137], v211 offset:32768
  ds_read_b64_tr_b16 v[138:139], v211 offset:34816
  ds_read_b64_tr_b16 v[140:141], v211 offset:49152
  ds_read_b64_tr_b16 v[142:143], v211 offset:51200
  v_mfma_f32_16x16x32_bf16 v[144:147], v[48:51], v[72:75], 0
  v_mfma_f32_16x16x32_bf16 v[176:179], v[224:227], v[72:75], 0
  v_mfma_f32_16x16x32_bf16 v[148:151], v[48:51], v[88:91], 0
  v_mfma_f32_16x16x32_bf16 v[180:183], v[224:227], v[88:91], 0
  v_mfma_f32_16x16x32_bf16 v[144:147], v[52:55], v[76:79], v[144:147]
  v_mfma_f32_16x16x32_bf16 v[176:179], v[228:231], v[76:79], v[176:179]
  s_add_u32 m0, s51, 0
  s_add_u32 s52, s50, 0
  buffer_load_dwordx4 v45, s[16:19], s52 offen lds
  v_mfma_f32_16x16x32_bf16 v[148:151], v[52:55], v[92:95], v[148:151]
  v_mfma_f32_16x16x32_bf16 v[180:183], v[228:231], v[92:95], v[180:183]
  v_mfma_f32_16x16x32_bf16 v[144:147], v[56:59], v[80:83], v[144:147]
  v_mfma_f32_16x16x32_bf16 v[176:179], v[232:235], v[80:83], v[176:179]
  v_mfma_f32_16x16x32_bf16 v[148:151], v[56:59], v[96:99], v[148:151]
  v_mfma_f32_16x16x32_bf16 v[180:183], v[232:235], v[96:99], v[180:183]
  s_add_u32 m0, s51, 1024
  s_add_u32 s52, s50, 1024
  buffer_load_dwordx4 v46, s[16:19], s52 offen lds
  v_mfma_f32_16x16x32_bf16 v[144:147], v[60:63], v[84:87], v[144:147]
  v_mfma_f32_16x16x32_bf16 v[176:179], v[236:239], v[84:87], v[176:179]
  v_mfma_f32_16x16x32_bf16 v[148:151], v[60:63], v[100:103], v[148:151]
  v_mfma_f32_16x16x32_bf16 v[180:183], v[236:239], v[100:103], v[180:183]
  s_waitcnt lgkmcnt(0)
  ds_read_b64_tr_b16 v[72:73], v212 offset:0
  ds_read_b64_tr_b16 v[74:75], v212 offset:2048
  ds_read_b64_tr_b16 v[76:77], v212 offset:16384
  ds_read_b64_tr_b16 v[78:79], v212 offset:18432
  ds_read_b64_tr_b16 v[80:81], v212 offset:32768
  ds_read_b64_tr_b16 v[82:83], v212 offset:34816
  ds_read_b64_tr_b16 v[84:85], v212 offset:49152
  ds_read_b64_tr_b16 v[86:87], v212 offset:51200
  ds_read_b64_tr_b16 v[88:89], v213 offset:0
  ds_read_b64_tr_b16 v[90:91], v213 offset:2048
  ds_read_b64_tr_b16 v[92:93], v213 offset:16384
  ds_read_b64_tr_b16 v[94:95], v213 offset:18432
  ds_read_b64_tr_b16 v[96:97], v213 offset:32768
  ds_read_b64_tr_b16 v[98:99], v213 offset:34816
  ds_read_b64_tr_b16 v[100:101], v213 offset:49152
  ds_read_b64_tr_b16 v[102:103], v213 offset:51200
  v_mfma_f32_16x16x32_bf16 v[152:155], v[48:51], v[112:115], 0
  v_mfma_f32_16x16x32_bf16 v[184:187], v[224:227], v[112:115], 0
  v_mfma_f32_16x16x32_bf16 v[156:159], v[48:51], v[128:131], 0
  v_mfma_f32_16x16x32_bf16 v[188:191], v[224:227], v[128:131], 0
  v_mfma_f32_16x16x32_bf16 v[152:155], v[52:55], v[116:119], v[152:155]
  v_mfma_f32_16x16x32_bf16 v[184:187], v[228:231], v[116:119], v[184:187]
  s_add_u32 m0, s51, 2048
  s_add_u32 s52, s50, 2048
  buffer_load_dwordx4 v45, s[16:19], s52 offen lds
  v_mfma_f32_16x16x32_bf16 v[156:159], v[52:55], v[132:135], v[156:159]
  v_mfma_f32_16x16x32_bf16 v[188:191], v[228:231], v[132:135], v[188:191]
  v_mfma_f32_16x16x32_bf16 v[152:155], v[56:59], v[120:123], v[152:155]
  v_mfma_f32_16x16x32_bf16 v[184:187], v[232:235], v[120:123], v[184:187]
  v_mfma_f32_16x16x32_bf16 v[156:159], v[56:59], v[136:139], v[156:159]
  v_mfma_f32_16x16x32_bf16 v[188:191], v[232:235], v[136:139], v[188:191]
  s_add_u32 m0, s51, 3072
  s_add_u32 s52, s50, 3072
  buffer_load_dwordx4 v46, s[16:19], s52 offen lds
  v_mfma_f32_16x16x32_bf16 v[152:155], v[60:63], v[124:127], v[152:155]
  v_mfma_f32_16x16x32_bf16 v[184:187], v[236:239], v[124:127], v[184:187]
  v_mfma_f32_16x16x32_bf16 v[156:159], v[60:63], v[140:143], v[156:159]
  v_mfma_f32_16x16x32_bf16 v[188:191], v[236:239], v[140:143], v[188:191]
  s_waitcnt lgkmcnt(0)
  ds_read_b64_tr_b16 v[112:113], v214 offset:0
  ds_read_b64_tr_b16 v[114:115], v214 offset:2048
  ds_read_b64_tr_b16 v[116:117], v214 offset:16384
  ds_read_b64_tr_b16 v[118:119], v214 offset:18432
  ds_read_b64_tr_b16 v[120:121], v214 offset:32768
  ds_read_b64_tr_b16 v[122:123], v214 offset:34816
  ds_read_b64_tr_b16 v[124:125], v214 offset:49152
  ds_read_b64_tr_b16 v[126:127], v214 offset:51200
  ds_read_b64_tr_b16 v[128:129], v215 offset:0
  ds_read_b64_tr_b16 v[130:131], v215 offset:2048
  ds_read_b64_tr_b16 v[132:133], v215 offset:16384
  ds_read_b64_tr_b16 v[134:135], v215 offset:18432
  ds_read_b64_tr_b16 v[136:137], v215 offset:32768
  ds_read_b64_tr_b16 v[138:139], v215 offset:34816
  ds_read_b64_tr_b16 v[140:141], v215 offset:49152
  ds_read_b64_tr_b16 v[142:143], v215 offset:51200
  v_mfma_f32_16x16x32_bf16 v[160:163], v[48:51], v[72:75], 0
  v_mfma_f32_16x16x32_bf16 v[192:195], v[224:227], v[72:75], 0
  v_mfma_f32_16x16x32_bf16 v[164:167], v[48:51], v[88:91], 0
  v_mfma_f32_16x16x32_bf16 v[196:199], v[224:227], v[88:91], 0
  v_mfma_f32_16x16x32_bf16 v[160:163], v[52:55], v[76:79], v[160:163]
  v_mfma_f32_16x16x32_bf16 v[192:195], v[228:231], v[76:79], v[192:195]
  s_add_u32 m0, s51, 4096
  s_add_u32 s52, s50, 4096
  buffer_load_dwordx4 v45, s[16:19], s52 offen lds
  v_mfma_f32_16x16x32_bf16 v[164:167], v[52:55], v[92:95], v[164:167]
  v_mfma_f32_16x16x32_bf16 v[196:199], v[228:231], v[92:95], v[196:199]
  v_mfma_f32_16x16x32_bf16 v[160:163], v[56:59], v[80:83], v[160:163]
  v_mfma_f32_16x16x32_bf16 v[192:195], v[232:235], v[80:83], v[192:195]
  v_mfma_f32_16x16x32_bf16 v[164:167], v[56:59], v[96:99], v[164:167]
  v_mfma_f32_16x16x32_bf16 v[196:199], v[232:235], v[96:99], v[196:199]
  s_add_u32 m0, s51, 5120
  s_add_u32 s52, s50, 5120
  buffer_load_dwordx4 v46, s[16:19], s52 offen lds
  v_mfma_f32_16x16x32_bf16 v[160:163], v[60:63], v[84:87], v[160:163]
  v_mfma_f32_16x16x32_bf16 v[192:195], v[236:239], v[84:87], v[192:195]
  v_mfma_f32_16x16x32_bf16 v[164:167], v[60:63], v[100:103], v[164:167]
  v_mfma_f32_16x16x32_bf16 v[196:199], v[236:239], v[100:103], v[196:199]
  s_waitcnt lgkmcnt(0)
  v_mfma_f32_16x16x32_bf16 v[168:171], v[48:51], v[112:115], 0
  v_mfma_f32_16x16x32_bf16 v[200:203], v[224:227], v[112:115], 0
  v_mfma_f32_16x16x32_bf16 v[172:175], v[48:51], v[128:131], 0
  v_mfma_f32_16x16x32_bf16 v[204:207], v[224:227], v[128:131], 0
  v_mfma_f32_16x16x32_bf16 v[168:171], v[52:55], v[116:119], v[168:171]
  v_mfma_f32_16x16x32_bf16 v[200:203], v[228:231], v[116:119], v[200:203]
  s_add_u32 m0, s51, 6144
  s_add_u32 s52, s50, 6144
  buffer_load_dwordx4 v45, s[16:19], s52 offen lds
  v_mfma_f32_16x16x32_bf16 v[172:175], v[52:55], v[132:135], v[172:175]
  v_mfma_f32_16x16x32_bf16 v[204:207], v[228:231], v[132:135], v[204:207]
  v_mfma_f32_16x16x32_bf16 v[168:171], v[56:59], v[120:123], v[168:171]
  v_mfma_f32_16x16x32_bf16 v[200:203], v[232:235], v[120:123], v[200:203]
  v_mfma_f32_16x16x32_bf16 v[172:175], v[56:59], v[136:139], v[172:175]
  v_mfma_f32_16x16x32_bf16 v[204:207], v[232:235], v[136:139], v[204:207]
  s_add_u32 m0, s51, 7168
  s_add_u32 s52, s50, 7168
  buffer_load_dwordx4 v46, s[16:19], s52 offen lds
  v_mfma_f32_16x16x32_bf16 v[168:171], v[60:63], v[124:127], v[168:171]
  v_mfma_f32_16x16x32_bf16 v[200:203], v[236:239], v[124:127], v[200:203]
  v_mfma_f32_16x16x32_bf16 v[172:175], v[60:63], v[140:143], v[172:175]
  v_mfma_f32_16x16x32_bf16 v[204:207], v[236:239], v[140:143], v[204:207]
  s_waitcnt vmcnt(8)
  s_barrier
  s_cmp_lg_u32 s3, 7
  s_cbranch_scc1 V_PUBD
  s_mov_b32 s52, 0
V_NP:
  v_readfirstlane_b32 s47, v244
  s_nop 3
  s_cmp_lg_u32 s47, 0
  s_cbranch_scc1 V_NOK
  s_add_u32 s52, s52, 1
  s_cmp_gt_u32 s52, 0x4000
  s_cbranch_scc1 V_NOK
  v_mov_b32 v245, 0
  global_load_dword v244, v245, s[82:83] sc1
  s_waitcnt vmcnt(0)
  s_branch V_NP
V_NOK:
  v_lshlrev_b32 v44, 13, v1
  s_lshl_b32 s48, s2, 3
  s_add_u32 s48, s48, 0x1100000
  v_mov_b32 v64, v240
  v_xor_b32 v65, s47, v64
  buffer_store_dwordx2 v[64:65], v44, s[28:31], s48 offen sc1
  s_add_u32 s48, s48, 2048
  v_mov_b32 v66, v241
  v_xor_b32 v67, s47, v66
  buffer_store_dwordx2 v[66:67], v44, s[28:31], s48 offen sc1
  s_add_u32 s48, s48, 2048
  v_mov_b32 v68, v242
  v_xor_b32 v69, s47, v68
  buffer_store_dwordx2 v[68:69], v44, s[28:31], s48 offen sc1
  s_add_u32 s48, s48, 2048
  v_mov_b32 v70, v243
  v_xor_b32 v71, s47, v70
  buffer_store_dwordx2 v[70:71], v44, s[28:31], s48 offen sc1
  s_add_u32 s48, s48, 2048
V_PUBD:
  v_readfirstlane_b32 s47, v244
  s_mov_b32 s32, s74
  s_mov_b32 s33, s75
  s_mov_b32 s34, 0x200
  s_mov_b32 s35, 0x00020000
  s_lshl_b32 s48, s38, 8
  v_xor_b32 v48, 0, v43
  v_add_u32 v48, v48, v42
  v_xor_b32 v49, 8, v43
  v_add_u32 v49, v49, v42
  v_xor_b32 v50, 16, v43
  v_add_u32 v50, v50, v42
  v_xor_b32 v51, 24, v43
  v_add_u32 v51, v51, v42
  buffer_load_ushort v8, v48, s[32:35], s48 offen
  buffer_load_ushort v9, v49, s[32:35], s48 offen
  buffer_load_ushort v10, v50, s[32:35], s48 offen
  buffer_load_ushort v11, v51, s[32:35], s48 offen
  s_mov_b32 s52, 0xbfb8aa3b
  s_mov_b32 s53, 0xbfb8aa3b
  v_mov_b32 v46, 0
  v_pk_mul_f32 v[144:145], v[144:145], s[52:53]
  v_pk_mul_f32 v[146:147], v[146:147], s[52:53]
  v_pk_mul_f32 v[148:149], v[148:149], s[52:53]
  v_pk_mul_f32 v[150:151], v[150:151], s[52:53]
  v_pk_mul_f32 v[152:153], v[152:153], s[52:53]
  v_pk_mul_f32 v[154:155], v[154:155], s[52:53]
  v_pk_mul_f32 v[156:157], v[156:157], s[52:53]
  v_pk_mul_f32 v[158:159], v[158:159], s[52:53]
  v_pk_mul_f32 v[160:161], v[160:161], s[52:53]
  v_pk_mul_f32 v[162:163], v[162:163], s[52:53]
  v_pk_mul_f32 v[164:165], v[164:165], s[52:53]
  v_pk_mul_f32 v[166:167], v[166:167], s[52:53]
  v_pk_mul_f32 v[168:169], v[168:169], s[52:53]
  v_pk_mul_f32 v[170:171], v[170:171], s[52:53]
  v_pk_mul_f32 v[172:173], v[172:173], s[52:53]
  v_pk_mul_f32 v[174:175], v[174:175], s[52:53]
  v_pk_mul_f32 v[176:177], v[176:177], s[52:53]
  v_pk_mul_f32 v[178:179], v[178:179], s[52:53]
  v_pk_mul_f32 v[180:181], v[180:181], s[52:53]
  v_pk_mul_f32 v[182:183], v[182:183], s[52:53]
  v_pk_mul_f32 v[184:185], v[184:185], s[52:53]
  v_pk_mul_f32 v[186:187], v[186:187], s[52:53]
  v_pk_mul_f32 v[188:189], v[188:189], s[52:53]
  v_pk_mul_f32 v[190:191], v[190:191], s[52:53]
  v_pk_mul_f32 v[192:193], v[192:193], s[52:53]
  v_pk_mul_f32 v[194:195], v[194:195], s[52:53]
  v_pk_mul_f32 v[196:197], v[196:197], s[52:53]
  v_pk_mul_f32 v[198:199], v[198:199], s[52:53]
  v_pk_mul_f32 v[200:201], v[200:201], s[52:53]
  v_pk_mul_f32 v[202:203], v[202:203], s[52:53]
  v_pk_mul_f32 v[204:205], v[204:205], s[52:53]
  v_pk_mul_f32 v[206:207], v[206:207], s[52:53]
  v_cvt_pk_bf16_f32 v224, v144, v148
  v_max3_f32 v46, |v144|, |v148|, v46
  v_cvt_pk_bf16_f32 v225, v152, v156
  v_max3_f32 v46, |v152|, |v156|, v46
  v_cvt_pk_bf16_f32 v226, v160, v164
  v_max3_f32 v46, |v160|, |v164|, v46
  v_cvt_pk_bf16_f32 v227, v168, v172
  v_max3_f32 v46, |v168|, |v172|, v46
  v_cvt_pk_bf16_f32 v228, v145, v149
  v_max3_f32 v46, |v145|, |v149|, v46
  v_cvt_pk_bf16_f32 v229, v153, v157
  v_max3_f32 v46, |v153|, |v157|, v46
  v_cvt_pk_bf16_f32 v230, v161, v165
  v_max3_f32 v46, |v161|, |v165|, v46
  v_cvt_pk_bf16_f32 v231, v169, v173
  v_max3_f32 v46, |v169|, |v173|, v46
  v_cvt_pk_bf16_f32 v232, v146, v150
  v_max3_f32 v46, |v146|, |v150|, v46
  v_cvt_pk_bf16_f32 v233, v154, v158
  v_max3_f32 v46, |v154|, |v158|, v46
  v_cvt_pk_bf16_f32 v234, v162, v166
  v_max3_f32 v46, |v162|, |v166|, v46
  v_cvt_pk_bf16_f32 v235, v170, v174
  v_max3_f32 v46, |v170|, |v174|, v46
  v_cvt_pk_bf16_f32 v236, v147, v151
  v_max3_f32 v46, |v147|, |v151|, v46
  v_cvt_pk_bf16_f32 v237, v155, v159
  v_max3_f32 v46, |v155|, |v159|, v46
  v_cvt_pk_bf16_f32 v238, v163, v167
  v_max3_f32 v46, |v163|, |v167|, v46
  v_cvt_pk_bf16_f32 v239, v171, v175
  v_max3_f32 v46, |v171|, |v175|, v46
  v_cvt_pk_bf16_f32 v240, v176, v180
  v_max3_f32 v46, |v176|, |v180|, v46
  v_cvt_pk_bf16_f32 v241, v184, v188
  v_max3_f32 v46, |v184|, |v188|, v46
  v_cvt_pk_bf16_f32 v242, v192, v196
  v_max3_f32 v46, |v192|, |v196|, v46
  v_cvt_pk_bf16_f32 v243, v200, v204
  v_max3_f32 v46, |v200|, |v204|, v46
  v_cvt_pk_bf16_f32 v244, v177, v181
  v_max3_f32 v46, |v177|, |v181|, v46
  v_cvt_pk_bf16_f32 v245, v185, v189
  v_max3_f32 v46, |v185|, |v189|, v46
  v_cvt_pk_bf16_f32 v246, v193, v197
  v_max3_f32 v46, |v193|, |v197|, v46
  v_cvt_pk_bf16_f32 v247, v201, v205
  v_max3_f32 v46, |v201|, |v205|, v46
  v_cvt_pk_bf16_f32 v248, v178, v182
  v_max3_f32 v46, |v178|, |v182|, v46
  v_cvt_pk_bf16_f32 v249, v186, v190
  v_max3_f32 v46, |v186|, |v190|, v46
  v_cvt_pk_bf16_f32 v250, v194, v198
  v_max3_f32 v46, |v194|, |v198|, v46
  v_cvt_pk_bf16_f32 v251, v202, v206
  v_max3_f32 v46, |v202|, |v206|, v46
  v_cvt_pk_bf16_f32 v252, v179, v183
  v_max3_f32 v46, |v179|, |v183|, v46
  v_cvt_pk_bf16_f32 v253, v187, v191
  v_max3_f32 v46, |v187|, |v191|, v46
  v_cvt_pk_bf16_f32 v254, v195, v199
  v_max3_f32 v46, |v195|, |v199|, v46
  v_cvt_pk_bf16_f32 v255, v203, v207
  v_max3_f32 v46, |v203|, |v207|, v46
  s_and_b32 s48, s3, 3
  s_cmp_eq_u32 s48, 3
  s_cbranch_scc0 V_MX
  v_mov_b32 v46, 0
  v_max3_f32 v46, |v144|, |v145|, v46
  v_max3_f32 v46, |v148|, |v149|, v46
  v_max3_f32 v46, |v152|, |v153|, v46
  v_max3_f32 v46, |v156|, |v157|, v46
  v_max3_f32 v46, |v160|, |v161|, v46
  v_max3_f32 v46, |v164|, |v165|, v46
  v_max3_f32 v46, |v168|, |v169|, v46
  v_max3_f32 v46, |v172|, |v173|, v46
  v_cmp_gt_u32 vcc, 16, v1
  s_nop 1
  v_cndmask_b32 v46, 0, v46, vcc
V_MX:
  s_nop 1
  v_max_u32_dpp v46, v46, v46 row_shr:1 row_mask:0xf bank_mask:0xf
  s_nop 1
  v_max_u32_dpp v46, v46, v46 row_shr:2 row_mask:0xf bank_mask:0xf
  s_nop 1
  v_max_u32_dpp v46, v46, v46 row_shr:4 row_mask:0xf bank_mask:0xf
  s_nop 1
  v_max_u32_dpp v46, v46, v46 row_shr:8 row_mask:0xf bank_mask:0xf
  s_nop 1
  v_max_u32_dpp v46, v46, v46 row_bcast:15 row_mask:0xa bank_mask:0xf
  s_nop 1
  v_max_u32_dpp v46, v46, v46 row_bcast:31 row_mask:0xc bank_mask:0xf
  s_nop 0
  v_readlane_b32 s48, v46, 63
  s_nop 3
  v_mov_b32 v46, s48
  v_mov_b32 v47, 0
  s_mov_b64 exec, 1
  ds_max_u32 v47, v46 offset:3108
  s_mov_b64 exec, -1
  s_add_u32 s48, s36, 98
  s_min_u32 s48, s48, 25000
  s_lshl_b32 s48, s48, 9
  s_mov_b32 s32, s60
  s_mov_b32 s33, s61
  s_mov_b32 s34, s48
  s_mov_b32 s35, 0x00020000
  s_and_b32 s48, s3, 3
  s_lshl_b32 s48, s48, 5
  s_add_u32 s48, s48, s36
  s_lshl_b32 s48, s48, 9
  s_lshr_b32 s49, s3, 2
  s_lshl_b32 s49, s49, 8
  s_add_u32 s48, s48, s49
  v_lshrrev_b32 v48, 4, v1
  v_lshlrev_b32 v48, 11, v48
  v_and_b32 v49, 15, v1
  v_lshl_add_u32 v48, v49, 4, v48
  s_mov_b32 s53, s48
  v_mov_b32 v50, v48
  buffer_store_dwordx4 v[224:227], v50, s[32:35], s53 offen offset:0 sc1 nt
  buffer_store_dwordx4 v[228:231], v50, s[32:35], s53 offen offset:512 sc1 nt
  buffer_store_dwordx4 v[232:235], v50, s[32:35], s53 offen offset:1024 sc1 nt
  buffer_store_dwordx4 v[236:239], v50, s[32:35], s53 offen offset:1536 sc1 nt
  s_add_u32 s53, s53, 8192
  buffer_store_dwordx4 v[240:243], v50, s[32:35], s53 offen offset:0 sc1 nt
  buffer_store_dwordx4 v[244:247], v50, s[32:35], s53 offen offset:512 sc1 nt
  buffer_store_dwordx4 v[248:251], v50, s[32:35], s53 offen offset:1024 sc1 nt
  buffer_store_dwordx4 v[252:255], v50, s[32:35], s53 offen offset:1536 sc1 nt
  s_lshl_b32 s39, s38, 8
  s_add_u32 s40, s39, 128
  s_mov_b32 s46, 0x00ffffff
  s_lshl_b32 s41, s3, 13
  s_add_u32 s41, s41, 106496
  s_cmp_eq_u32 s3, 7
  s_cselect_b32 s41, 62720, s41
  s_mov_b32 s12, s66
  s_mov_b32 s13, s67
  s_mov_b32 s14, 0xc35000
  s_mov_b32 s15, 0x00020000
  s_mov_b32 s20, s80
  s_mov_b32 s21, s81
  s_mov_b32 s22, 0x61a800
  s_mov_b32 s23, 0x00020000
  s_sub_u32 s24, s60, 4096
  s_subb_u32 s25, s61, 0
  s_mov_b32 s26, 12804096
  s_mov_b32 s27, 0x00020000
  s_mov_b32 s43, 0
  s_mov_b32 s44, 256
  s_mov_b32 s62, 0
  s_mov_b32 s45, 0
  v_mov_b32 v5, 0x7fff7fff
  v_mov_b32 v48, 0
  v_lshlrev_b32 v47, 2, v0
  v_cmp_gt_u32 vcc, 128, v0
  s_and_saveexec_b64 s[50:51], vcc
  ds_write_b32 v47, v48 offset:2560
  s_mov_b64 exec, s[50:51]
  v_mov_b32 v48, 0
  v_mov_b32 v49, 0
  v_mov_b32 v50, 0
  v_mov_b32 v51, 0
  v_mov_b32 v52, 0x1f000000
  v_mov_b32 v53, 0x1f000000
  v_mov_b32 v54, 0x1f000000
  v_mov_b32 v55, 0x1f000000
  v_mov_b32 v60, 0x9b009b0
  v_mov_b32 v61, 0x9b009b0
  v_mov_b32 v62, 0x9b009b0
  v_mov_b32 v63, 0x9b009b0
  ds_write_b128 v3, v[48:51] offset:40960
  ds_write_b128 v3, v[52:55] offset:49664
  v_cmp_gt_u32 vcc, 272, v0
  s_and_saveexec_b64 s[50:51], vcc
  ds_write_b128 v3, v[60:63] offset:58368
  s_mov_b64 exec, s[50:51]
  v_add_u32 v47, 8192, v3
  v_cmp_gt_u32 vcc, 32, v0
  s_and_saveexec_b64 s[50:51], vcc
  ds_write_b128 v47, v[48:51] offset:40960
  ds_write_b128 v47, v[52:55] offset:49664
  v_lshlrev_b32 v57, 2, v0
  ds_write_b32 v57, v48 offset:2048
  ds_write_b32 v57, v48 offset:2176
  v_cmp_gt_u32 vcc, 9, v0
  s_and_b64 exec, exec, vcc
  ds_write_b32 v57, v48 offset:3072
  s_mov_b64 exec, s[50:51]
  v_lshrrev_b32 v44, 1, v0
  s_cmp_eq_u32 s44, 1
  s_cbranch_scc0 V_CF1
  v_mov_b32 v44, s43
V_CF1:
  v_lshlrev_b32 v56, 3, v44
  s_lshl_b32 s48, s2, 11
  s_add_u32 s48, s48, 0x1100000
  s_mov_b32 s52, 0
  v_mov_b32 v103, 0
  s_waitcnt vmcnt(8)
  s_barrier
  s_mul_i32 s50, s37, 24
  s_min_u32 s52, s37, 1
  s_add_u32 s50, s50, s52
  v_add_u32 v60, s50, v41
  v_min_u32 v60, 97, v60
  v_and_b32 v61, 15, v60
  v_xor_b32 v61, v61, v6
  v_lshlrev_b32 v61, 4, v61
  v_lshl_add_u32 v60, v60, 8, v61
  v_add_u32 v60, 6400, v60
  v_xor_b32 v48, 0, v60
  v_xor_b32 v49, 32, v60
  v_xor_b32 v50, 64, v60
  v_xor_b32 v51, 96, v60
  v_xor_b32 v52, 128, v60
  v_xor_b32 v53, 160, v60
  v_xor_b32 v54, 192, v60
  v_xor_b32 v55, 224, v60
  ds_read_b128 v[160:163], v48
  ds_read_b128 v[164:167], v49
  ds_read_b128 v[168:171], v50
  ds_read_b128 v[172:175], v51
  ds_read_b128 v[176:179], v52
  ds_read_b128 v[180:183], v53
  ds_read_b128 v[184:187], v54
  ds_read_b128 v[188:191], v55
  v_and_b32 v60, 3, v1
  v_bfe_u32 v61, v1, 2, 2
  v_add_u32 v62, s39, v39
  v_xor_b32 v63, 0, v60
  v_lshlrev_b32 v63, 3, v63
  v_lshlrev_b32 v57, 4, v61
  v_or_b32 v100, v62, v63
  v_xor_b32 v100, v100, v57
  v_xor_b32 v63, 1, v60
  v_lshlrev_b32 v63, 3, v63
  v_lshlrev_b32 v57, 4, v61
  v_or_b32 v101, v62, v63
  v_xor_b32 v101, v101, v57
  v_xor_b32 v63, 2, v60
  v_lshlrev_b32 v63, 3, v63
  v_lshlrev_b32 v57, 4, v61
  v_or_b32 v102, v62, v63
  v_xor_b32 v102, v102, v57
  v_xor_b32 v63, 3, v60
  v_lshlrev_b32 v63, 3, v63
  v_lshlrev_b32 v57, 4, v61
  v_or_b32 v103, v62, v63
  v_xor_b32 v103, v103, v57
  s_waitcnt lgkmcnt(0)
  ds_read_b64_tr_b16 v[192:193], v100 offset:0
  ds_read_b64_tr_b16 v[194:195], v100 offset:2048
  ds_read_b64_tr_b16 v[196:197], v100 offset:8192
  ds_read_b64_tr_b16 v[198:199], v100 offset:10240
  ds_read_b64_tr_b16 v[200:201], v100 offset:16384
  ds_read_b64_tr_b16 v[202:203], v100 offset:18432
  ds_read_b64_tr_b16 v[204:205], v100 offset:24576
  ds_read_b64_tr_b16 v[206:207], v100 offset:26624
  ds_read_b64_tr_b16 v[208:209], v100 offset:32768
  ds_read_b64_tr_b16 v[210:211], v100 offset:34816
  ds_read_b64_tr_b16 v[212:213], v100 offset:40960
  ds_read_b64_tr_b16 v[214:215], v100 offset:43008
  ds_read_b64_tr_b16 v[216:217], v100 offset:49152
  ds_read_b64_tr_b16 v[218:219], v100 offset:51200
  ds_read_b64_tr_b16 v[220:221], v100 offset:57344
  ds_read_b64_tr_b16 v[222:223], v100 offset:59392
  s_mov_b32 s51, 0xbfb8aa3b
  v_mov_b32 v47, 0
  s_waitcnt lgkmcnt(0)
  v_mfma_f32_32x32x16_bf16 v[112:127], v[160:163], v[192:195], 0
  v_mfma_f32_32x32x16_bf16 v[112:127], v[164:167], v[196:199], v[112:127]
  v_mfma_f32_32x32x16_bf16 v[112:127], v[168:171], v[200:203], v[112:127]
  v_mfma_f32_32x32x16_bf16 v[112:127], v[172:175], v[204:207], v[112:127]
  v_mfma_f32_32x32x16_bf16 v[112:127], v[176:179], v[208:211], v[112:127]
  v_mfma_f32_32x32x16_bf16 v[112:127], v[180:183], v[212:215], v[112:127]
  v_mfma_f32_32x32x16_bf16 v[112:127], v[184:187], v[216:219], v[112:127]
  v_mfma_f32_32x32x16_bf16 v[112:127], v[188:191], v[220:223], v[112:127]
  ds_read_b64_tr_b16 v[192:193], v101 offset:0
  ds_read_b64_tr_b16 v[194:195], v101 offset:2048
  ds_read_b64_tr_b16 v[196:197], v101 offset:8192
  ds_read_b64_tr_b16 v[198:199], v101 offset:10240
  ds_read_b64_tr_b16 v[200:201], v101 offset:16384
  ds_read_b64_tr_b16 v[202:203], v101 offset:18432
  ds_read_b64_tr_b16 v[204:205], v101 offset:24576
  ds_read_b64_tr_b16 v[206:207], v101 offset:26624
  ds_read_b64_tr_b16 v[208:209], v101 offset:32768
  ds_read_b64_tr_b16 v[210:211], v101 offset:34816
  ds_read_b64_tr_b16 v[212:213], v101 offset:40960
  ds_read_b64_tr_b16 v[214:215], v101 offset:43008
  ds_read_b64_tr_b16 v[216:217], v101 offset:49152
  ds_read_b64_tr_b16 v[218:219], v101 offset:51200
  ds_read_b64_tr_b16 v[220:221], v101 offset:57344
  ds_read_b64_tr_b16 v[222:223], v101 offset:59392
  s_waitcnt lgkmcnt(0)
  v_mfma_f32_32x32x16_bf16 v[12:27], v[160:163], v[192:195], 0
  v_mfma_f32_32x32x16_bf16 v[12:27], v[164:167], v[196:199], v[12:27]
  v_mfma_f32_32x32x16_bf16 v[12:27], v[168:171], v[200:203], v[12:27]
  v_mfma_f32_32x32x16_bf16 v[12:27], v[172:175], v[204:207], v[12:27]
  v_mfma_f32_32x32x16_bf16 v[12:27], v[176:179], v[208:211], v[12:27]
  v_mfma_f32_32x32x16_bf16 v[12:27], v[180:183], v[212:215], v[12:27]
  v_mfma_f32_32x32x16_bf16 v[12:27], v[184:187], v[216:219], v[12:27]
  v_mfma_f32_32x32x16_bf16 v[12:27], v[188:191], v[220:223], v[12:27]
  ds_read_b64_tr_b16 v[192:193], v102 offset:0
  ds_read_b64_tr_b16 v[194:195], v102 offset:2048
  ds_read_b64_tr_b16 v[196:197], v102 offset:8192
  ds_read_b64_tr_b16 v[198:199], v102 offset:10240
  ds_read_b64_tr_b16 v[200:201], v102 offset:16384
  ds_read_b64_tr_b16 v[202:203], v102 offset:18432
  ds_read_b64_tr_b16 v[204:205], v102 offset:24576
  ds_read_b64_tr_b16 v[206:207], v102 offset:26624
  ds_read_b64_tr_b16 v[208:209], v102 offset:32768
  ds_read_b64_tr_b16 v[210:211], v102 offset:34816
  ds_read_b64_tr_b16 v[212:213], v102 offset:40960
  ds_read_b64_tr_b16 v[214:215], v102 offset:43008
  ds_read_b64_tr_b16 v[216:217], v102 offset:49152
  ds_read_b64_tr_b16 v[218:219], v102 offset:51200
  ds_read_b64_tr_b16 v[220:221], v102 offset:57344
  ds_read_b64_tr_b16 v[222:223], v102 offset:59392
  v_lshlrev_b32 v8, 16, v8
  v_mul_f32 v8, s51, v8
  v_fma_f32 v112, v112, s51, v8
  v_fma_f32 v113, v113, s51, v8
  v_fma_f32 v114, v114, s51, v8
  v_fma_f32 v115, v115, s51, v8
  v_fma_f32 v116, v116, s51, v8
  v_fma_f32 v117, v117, s51, v8
  v_fma_f32 v118, v118, s51, v8
  v_fma_f32 v119, v119, s51, v8
  v_fma_f32 v120, v120, s51, v8
  v_fma_f32 v121, v121, s51, v8
  v_fma_f32 v122, v122, s51, v8
  v_fma_f32 v123, v123, s51, v8
  v_fma_f32 v124, v124, s51, v8
  v_fma_f32 v125, v125, s51, v8
  v_fma_f32 v126, v126, s51, v8
  v_fma_f32 v127, v127, s51, v8
  v_cvt_pk_bf16_f32 v128, v112, v113
  v_max3_f32 v47, |v112|, |v113|, v47
  v_cvt_pk_bf16_f32 v129, v114, v115
  v_max3_f32 v47, |v114|, |v115|, v47
  v_cvt_pk_bf16_f32 v130, v116, v117
  v_max3_f32 v47, |v116|, |v117|, v47
  v_cvt_pk_bf16_f32 v131, v118, v119
  v_max3_f32 v47, |v118|, |v119|, v47
  v_cvt_pk_bf16_f32 v132, v120, v121
  v_max3_f32 v47, |v120|, |v121|, v47
  v_cvt_pk_bf16_f32 v133, v122, v123
  v_max3_f32 v47, |v122|, |v123|, v47
  v_cvt_pk_bf16_f32 v134, v124, v125
  v_max3_f32 v47, |v124|, |v125|, v47
  v_cvt_pk_bf16_f32 v135, v126, v127
  v_max3_f32 v47, |v126|, |v127|, v47
  s_waitcnt lgkmcnt(0)
  v_mfma_f32_32x32x16_bf16 v[112:127], v[160:163], v[192:195], 0
  v_mfma_f32_32x32x16_bf16 v[112:127], v[164:167], v[196:199], v[112:127]
  v_mfma_f32_32x32x16_bf16 v[112:127], v[168:171], v[200:203], v[112:127]
  v_mfma_f32_32x32x16_bf16 v[112:127], v[172:175], v[204:207], v[112:127]
  v_mfma_f32_32x32x16_bf16 v[112:127], v[176:179], v[208:211], v[112:127]
  v_mfma_f32_32x32x16_bf16 v[112:127], v[180:183], v[212:215], v[112:127]
  v_mfma_f32_32x32x16_bf16 v[112:127], v[184:187], v[216:219], v[112:127]
  v_mfma_f32_32x32x16_bf16 v[112:127], v[188:191], v[220:223], v[112:127]
  ds_read_b64_tr_b16 v[192:193], v103 offset:0
  ds_read_b64_tr_b16 v[194:195], v103 offset:2048
  ds_read_b64_tr_b16 v[196:197], v103 offset:8192
  ds_read_b64_tr_b16 v[198:199], v103 offset:10240
  ds_read_b64_tr_b16 v[200:201], v103 offset:16384
  ds_read_b64_tr_b16 v[202:203], v103 offset:18432
  ds_read_b64_tr_b16 v[204:205], v103 offset:24576
  ds_read_b64_tr_b16 v[206:207], v103 offset:26624
  ds_read_b64_tr_b16 v[208:209], v103 offset:32768
  ds_read_b64_tr_b16 v[210:211], v103 offset:34816
  ds_read_b64_tr_b16 v[212:213], v103 offset:40960
  ds_read_b64_tr_b16 v[214:215], v103 offset:43008
  ds_read_b64_tr_b16 v[216:217], v103 offset:49152
  ds_read_b64_tr_b16 v[218:219], v103 offset:51200
  ds_read_b64_tr_b16 v[220:221], v103 offset:57344
  ds_read_b64_tr_b16 v[222:223], v103 offset:59392
  buffer_load_dwordx2 v[58:59], v56, s[28:31], s48 offen sc1
  v_lshlrev_b32 v9, 16, v9
  v_mul_f32 v9, s51, v9
  v_fma_f32 v12, v12, s51, v9
  v_fma_f32 v13, v13, s51, v9
  v_fma_f32 v14, v14, s51, v9
  v_fma_f32 v15, v15, s51, v9
  v_fma_f32 v16, v16, s51, v9
  v_fma_f32 v17, v17, s51, v9
  v_fma_f32 v18, v18, s51, v9
  v_fma_f32 v19, v19, s51, v9
  v_fma_f32 v20, v20, s51, v9
  v_fma_f32 v21, v21, s51, v9
  v_fma_f32 v22, v22, s51, v9
  v_fma_f32 v23, v23, s51, v9
  v_fma_f32 v24, v24, s51, v9
  v_fma_f32 v25, v25, s51, v9
  v_fma_f32 v26, v26, s51, v9
  v_fma_f32 v27, v27, s51, v9
  v_cvt_pk_bf16_f32 v136, v12, v13
  v_max3_f32 v47, |v12|, |v13|, v47
  v_cvt_pk_bf16_f32 v137, v14, v15
  v_max3_f32 v47, |v14|, |v15|, v47
  v_cvt_pk_bf16_f32 v138, v16, v17
  v_max3_f32 v47, |v16|, |v17|, v47
  v_cvt_pk_bf16_f32 v139, v18, v19
  v_max3_f32 v47, |v18|, |v19|, v47
  v_cvt_pk_bf16_f32 v140, v20, v21
  v_max3_f32 v47, |v20|, |v21|, v47
  v_cvt_pk_bf16_f32 v141, v22, v23
  v_max3_f32 v47, |v22|, |v23|, v47
  v_cvt_pk_bf16_f32 v142, v24, v25
  v_max3_f32 v47, |v24|, |v25|, v47
  v_cvt_pk_bf16_f32 v143, v26, v27
  v_max3_f32 v47, |v26|, |v27|, v47
  s_waitcnt lgkmcnt(0)
  v_mfma_f32_32x32x16_bf16 v[12:27], v[160:163], v[192:195], 0
  v_mfma_f32_32x32x16_bf16 v[12:27], v[164:167], v[196:199], v[12:27]
  v_mfma_f32_32x32x16_bf16 v[12:27], v[168:171], v[200:203], v[12:27]
  v_mfma_f32_32x32x16_bf16 v[12:27], v[172:175], v[204:207], v[12:27]
  v_mfma_f32_32x32x16_bf16 v[12:27], v[176:179], v[208:211], v[12:27]
  v_mfma_f32_32x32x16_bf16 v[12:27], v[180:183], v[212:215], v[12:27]
  v_mfma_f32_32x32x16_bf16 v[12:27], v[184:187], v[216:219], v[12:27]
  v_mfma_f32_32x32x16_bf16 v[12:27], v[188:191], v[220:223], v[12:27]
  v_lshlrev_b32 v10, 16, v10
  v_mul_f32 v10, s51, v10
  v_fma_f32 v112, v112, s51, v10
  v_fma_f32 v113, v113, s51, v10
  v_fma_f32 v114, v114, s51, v10
  v_fma_f32 v115, v115, s51, v10
  v_fma_f32 v116, v116, s51, v10
  v_fma_f32 v117, v117, s51, v10
  v_fma_f32 v118, v118, s51, v10
  v_fma_f32 v119, v119, s51, v10
  v_fma_f32 v120, v120, s51, v10
  v_fma_f32 v121, v121, s51, v10
  v_fma_f32 v122, v122, s51, v10
  v_fma_f32 v123, v123, s51, v10
  v_fma_f32 v124, v124, s51, v10
  v_fma_f32 v125, v125, s51, v10
  v_fma_f32 v126, v126, s51, v10
  v_fma_f32 v127, v127, s51, v10
  v_cvt_pk_bf16_f32 v144, v112, v113
  v_max3_f32 v47, |v112|, |v113|, v47
  v_cvt_pk_bf16_f32 v145, v114, v115
  v_max3_f32 v47, |v114|, |v115|, v47
  v_cvt_pk_bf16_f32 v146, v116, v117
  v_max3_f32 v47, |v116|, |v117|, v47
  v_cvt_pk_bf16_f32 v147, v118, v119
  v_max3_f32 v47, |v118|, |v119|, v47
  v_cvt_pk_bf16_f32 v148, v120, v121
  v_max3_f32 v47, |v120|, |v121|, v47
  v_cvt_pk_bf16_f32 v149, v122, v123
  v_max3_f32 v47, |v122|, |v123|, v47
  v_cvt_pk_bf16_f32 v150, v124, v125
  v_max3_f32 v47, |v124|, |v125|, v47
  v_cvt_pk_bf16_f32 v151, v126, v127
  v_max3_f32 v47, |v126|, |v127|, v47
  s_nop 15
  v_lshlrev_b32 v11, 16, v11
  v_mul_f32 v11, s51, v11
  v_fma_f32 v12, v12, s51, v11
  v_fma_f32 v13, v13, s51, v11
  v_fma_f32 v14, v14, s51, v11
  v_fma_f32 v15, v15, s51, v11
  v_fma_f32 v16, v16, s51, v11
  v_fma_f32 v17, v17, s51, v11
  v_fma_f32 v18, v18, s51, v11
  v_fma_f32 v19, v19, s51, v11
  v_fma_f32 v20, v20, s51, v11
  v_fma_f32 v21, v21, s51, v11
  v_fma_f32 v22, v22, s51, v11
  v_fma_f32 v23, v23, s51, v11
  v_fma_f32 v24, v24, s51, v11
  v_fma_f32 v25, v25, s51, v11
  v_fma_f32 v26, v26, s51, v11
  v_fma_f32 v27, v27, s51, v11
  v_cvt_pk_bf16_f32 v152, v12, v13
  v_max3_f32 v47, |v12|, |v13|, v47
  v_cvt_pk_bf16_f32 v153, v14, v15
  v_max3_f32 v47, |v14|, |v15|, v47
  v_cvt_pk_bf16_f32 v154, v16, v17
  v_max3_f32 v47, |v16|, |v17|, v47
  v_cvt_pk_bf16_f32 v155, v18, v19
  v_max3_f32 v47, |v18|, |v19|, v47
  v_cvt_pk_bf16_f32 v156, v20, v21
  v_max3_f32 v47, |v20|, |v21|, v47
  v_cvt_pk_bf16_f32 v157, v22, v23
  v_max3_f32 v47, |v22|, |v23|, v47
  v_cvt_pk_bf16_f32 v158, v24, v25
  v_max3_f32 v47, |v24|, |v25|, v47
  v_cvt_pk_bf16_f32 v159, v26, v27
  v_max3_f32 v47, |v26|, |v27|, v47
  v_cmp_le_f32 vcc, 0x42800000, v47
  s_nop 3
  s_cmp_lg_u64 vcc, 0
  s_cselect_b32 s45, 1, 0
  v_add_u32 v60, s41, v35
  v_xor_b32 v8, 0, v60
  v_xor_b32 v9, 32, v60
  v_xor_b32 v10, 64, v60
  v_xor_b32 v11, 96, v60
  v_add_u32 v38, 2048, v36
  v_add_u32 v39, 1024, v37
  v_add_u32 v36, 4096, v36
  v_add_u32 v37, 3072, v37
  s_mov_b32 s52, 0
  v_mov_b32 v103, 0
  v_mov_b32 v102, s47
  s_branch V_POLLW
V_REDO:
  v_mov_b32 v48, 0
  v_lshlrev_b32 v47, 2, v0
  v_cmp_gt_u32 vcc, 128, v0
  s_and_saveexec_b64 s[50:51], vcc
  ds_write_b32 v47, v48 offset:2560
  s_mov_b64 exec, s[50:51]
V_BATCH:
  v_mov_b32 v48, 0
  v_mov_b32 v49, 0
  v_mov_b32 v50, 0
  v_mov_b32 v51, 0
  v_mov_b32 v52, 0x1f000000
  v_mov_b32 v53, 0x1f000000
  v_mov_b32 v54, 0x1f000000
  v_mov_b32 v55, 0x1f000000
  v_mov_b32 v60, 0x9b009b0
  v_mov_b32 v61, 0x9b009b0
  v_mov_b32 v62, 0x9b009b0
  v_mov_b32 v63, 0x9b009b0
  ds_write_b128 v3, v[48:51] offset:40960
  ds_write_b128 v3, v[52:55] offset:49664
  v_cmp_gt_u32 vcc, 272, v0
  s_and_saveexec_b64 s[50:51], vcc
  ds_write_b128 v3, v[60:63] offset:58368
  s_mov_b64 exec, s[50:51]
  v_add_u32 v47, 8192, v3
  v_cmp_gt_u32 vcc, 32, v0
  s_and_saveexec_b64 s[50:51], vcc
  ds_write_b128 v47, v[48:51] offset:40960
  ds_write_b128 v47, v[52:55] offset:49664
  v_lshlrev_b32 v57, 2, v0
  ds_write_b32 v57, v48 offset:2048
  ds_write_b32 v57, v48 offset:2176
  v_cmp_gt_u32 vcc, 9, v0
  s_and_b64 exec, exec, vcc
  ds_write_b32 v57, v48 offset:3072
  s_mov_b64 exec, s[50:51]
  v_lshrrev_b32 v44, 1, v0
  s_cmp_eq_u32 s44, 1
  s_cbranch_scc0 V_CF
  v_mov_b32 v44, s43
V_CF:
  v_lshlrev_b32 v56, 3, v44
  s_lshl_b32 s48, s2, 11
  s_add_u32 s48, s48, 0x1100000
  s_mov_b32 s52, 0
  v_mov_b32 v103, 0
V_POLL:
  buffer_load_dwordx2 v[58:59], v56, s[28:31], s48 offen sc1
  global_load_dword v102, v103, s[82:83] sc1
V_POLLW:
  s_waitcnt vmcnt(0) lgkmcnt(0)
  s_cmp_lg_u32 s62, 0
  s_cbranch_scc1 V_FLAGGED
  s_mov_b32 s62, 1
  s_barrier
  s_cmp_lg_u32 s3, 7
  s_cbranch_scc1 V_NOFLAG
  s_mov_b32 s53, 0
V_NRT:
  v_readfirstlane_b32 s47, v102
  s_nop 3
  s_cmp_lg_u32 s47, 0
  s_cbranch_scc1 V_NRD
  s_add_u32 s53, s53, 1
  s_cmp_gt_u32 s53, 0x4000
  s_cbranch_scc1 V_NRD
  global_load_dword v102, v103, s[82:83] sc1
  s_waitcnt vmcnt(0)
  s_branch V_NRT
V_NRD:
  v_mov_b32 v62, 0
  ds_read_b32 v63, v62 offset:3108
  s_waitcnt lgkmcnt(0)
  v_add_u32 v63, 0xffff, v63
  v_and_b32 v63, 0xffff0000, v63
  v_or_b32 v60, s98, v63
  v_xor_b32 v61, s47, v60
  s_lshl_b32 s49, s2, 3
  s_add_u32 s49, s49, 0x1190000
  s_mov_b64 exec, 1
  buffer_store_dwordx2 v[60:61], v62, s[28:31], s49 offen sc1
  s_mov_b64 exec, -1
V_NOFLAG:
V_FLAGGED:
  v_readfirstlane_b32 s47, v102
  s_nop 3
  v_xor_b32 v59, v58, v59
  v_cmp_ne_u32 vcc, s47, v59
  s_cmp_eq_u32 s47, 0
  s_cbranch_scc1 V_POLL2
  s_cmp_eq_u64 vcc, 0
  s_cbranch_scc1 V_POLLED
V_POLL2:
  s_add_u32 s52, s52, 1
  s_cmp_gt_u32 s52, 0x4000
  s_cbranch_scc0 V_POLL
V_POLLED:
  v_and_b32 v47, 0xffff, v58
  v_lshrrev_b32 v45, 16, v58
  v_and_b32 v56, 1, v0
  s_cmp_eq_u32 s44, 1
  s_cbranch_scc0 V_FAST
  s_barrier
  v_lshrrev_b32 v57, 1, v0
  v_lshlrev_b32 v57, 3, v57
  v_add_u32 v47, v47, v57
  v_sub_u32 v45, v45, v57
  v_max_i32 v45, 0, v45
  v_min_u32 v45, 8, v45
  s_branch V_GO
V_FAST:
  s_cmp_gt_u32 s62, 1
  s_cbranch_scc0 V_FAST2
  s_barrier
V_FAST2:
  v_cmp_lt_u32 vcc, 24, v45
  s_cmp_eq_u64 vcc, 0
  s_cbranch_scc1 V_GO
  v_mov_b32 v57, 1
  v_mov_b32 v60, 0
  ds_write_b32 v60, v57 offset:3104
V_GO:
  s_movk_i32 s49, 1564
  v_mad_u32_u24 v57, v44, s49, v47
  v_lshl_add_u32 v57, v56, 1, v57
  v_lshlrev_b32 v57, 3, v57
  s_mov_b32 s48, 0xd00000
  v_lshlrev_b32 v56, 1, v56
  v_sub_u32 v45, v45, v56
  v_cmp_lt_i32 vcc, 0, v45
  s_mov_b64 exec, vcc
  s_cbranch_execz V_RL0
  buffer_load_dwordx4 v[64:67], v57, s[28:31], s48 offen offset:0 sc1
V_RL0:
  v_cmp_lt_i32 vcc, 4, v45
  s_mov_b64 exec, vcc
  s_cbranch_execz V_RL1
  buffer_load_dwordx4 v[68:71], v57, s[28:31], s48 offen offset:32 sc1
V_RL1:
  v_cmp_lt_i32 vcc, 8, v45
  s_mov_b64 exec, vcc
  s_cbranch_execz V_RL2
  buffer_load_dwordx4 v[72:75], v57, s[28:31], s48 offen offset:64 sc1
V_RL2:
  v_cmp_lt_i32 vcc, 12, v45
  s_mov_b64 exec, vcc
  s_cbranch_execz V_RL3
  buffer_load_dwordx4 v[76:79], v57, s[28:31], s48 offen offset:96 sc1
V_RL3:
  s_mov_b64 exec, -1
  v_cmp_lt_i32 vcc, 16, v45
  s_mov_b32 s63, 0
  s_cmp_eq_u64 vcc, 0
  s_cbranch_scc1 V_NO3
  s_mov_b32 s63, 1
  buffer_load_dwordx4 v[80:83], v57, s[28:31], s48 offen offset:128 sc1
  buffer_load_dwordx4 v[84:87], v57, s[28:31], s48 offen offset:160 sc1
V_NO3:
  s_cmp_lg_u32 s62, 1
  s_cbranch_scc1 V_NOLUT
  s_add_u32 s56, s4, 9216
  s_addc_u32 s57, s5, 0
  s_mov_b32 s58, s3
  s_lshr_b32 s50, s2, 3
  s_lshl_b32 s50, s50, 1
V_LUTL:
  s_add_u32 s52, s58, s50
  s_cmp_ge_u32 s52, 68
  s_cselect_b32 s53, 68, 0
  s_sub_u32 s52, s52, s53
  s_cmp_ge_u32 s52, 34
  s_cselect_b32 s53, 34, 0
  s_sub_u32 s53, s52, s53
  s_cmp_ge_u32 s52, 34
  s_cselect_b32 s54, 0x10000, 0
  s_add_u32 s54, s54, 6400
  s_lshl_b32 s55, s53, 10
  s_add_u32 m0, s54, s55
  s_lshl_b32 s55, s52, 10
  v_add_u32 v60, s55, v4
  s_cmp_eq_u32 s53, 33
  s_cselect_b32 exec_hi, 0xffff, -1
  global_load_lds_dwordx4 v60, s[56:57]
  s_mov_b32 exec_hi, -1
  s_add_u32 s58, s58, 8
  s_cmp_lt_u32 s58, 68
  s_cbranch_scc1 V_LUTL
V_NOLUT:
  s_cmp_lg_u32 s43, 0
  s_cbranch_scc1 V_NOZ
  v_mov_b32 v48, 0
  v_mov_b32 v49, 0
  v_mov_b32 v50, 0
  v_mov_b32 v51, 0
  v_mov_b32 v16, 0
  s_nop 1
  v_mfma_f32_32x32x16_bf16 v[192:207], v[48:51], v[48:51], 0
  v_mfma_f32_32x32x16_bf16 v[208:223], v[48:51], v[48:51], 0
  v_mfma_f32_32x32x16_bf16 v[224:239], v[48:51], v[48:51], 0
  v_mfma_f32_32x32x16_bf16 v[240:255], v[48:51], v[48:51], 0
V_NOZ:
  v_mov_b32 v46, 1
  s_cmp_lg_u32 s62, 1
  s_cbranch_scc1 V_WR0
  s_waitcnt vmcnt(8)
  s_branch V_WR1
V_WR0:
  s_waitcnt vmcnt(0)
V_WR1:
  v_cmp_lt_i32 vcc, 0, v45
  s_mov_b64 exec, vcc
  v_lshlrev_b32_sdwa v48, 2, v65 dst_sel:DWORD dst_unused:UNUSED_PAD src0_sel:DWORD src1_sel:BYTE_3
  v_lshlrev_b32_sdwa v49, 2, v64 dst_sel:DWORD dst_unused:UNUSED_PAD src0_sel:DWORD src1_sel:BYTE_3
  ds_add_rtn_u32 v88, v48, v46 offset:2048
  ds_add_u32 v49, v46 offset:2560
  v_cmp_lt_i32 vcc, 1, v45
  s_mov_b64 exec, vcc
  v_lshlrev_b32_sdwa v50, 2, v67 dst_sel:DWORD dst_unused:UNUSED_PAD src0_sel:DWORD src1_sel:BYTE_3
  v_lshlrev_b32_sdwa v51, 2, v66 dst_sel:DWORD dst_unused:UNUSED_PAD src0_sel:DWORD src1_sel:BYTE_3
  ds_add_rtn_u32 v89, v50, v46 offset:2048
  ds_add_u32 v51, v46 offset:2560
  v_cmp_lt_i32 vcc, 4, v45
  s_mov_b64 exec, vcc
  v_lshlrev_b32_sdwa v52, 2, v69 dst_sel:DWORD dst_unused:UNUSED_PAD src0_sel:DWORD src1_sel:BYTE_3
  v_lshlrev_b32_sdwa v53, 2, v68 dst_sel:DWORD dst_unused:UNUSED_PAD src0_sel:DWORD src1_sel:BYTE_3
  ds_add_rtn_u32 v90, v52, v46 offset:2048
  ds_add_u32 v53, v46 offset:2560
  v_cmp_lt_i32 vcc, 5, v45
  s_mov_b64 exec, vcc
  v_lshlrev_b32_sdwa v54, 2, v71 dst_sel:DWORD dst_unused:UNUSED_PAD src0_sel:DWORD src1_sel:BYTE_3
  v_lshlrev_b32_sdwa v55, 2, v70 dst_sel:DWORD dst_unused:UNUSED_PAD src0_sel:DWORD src1_sel:BYTE_3
  ds_add_rtn_u32 v91, v54, v46 offset:2048
  ds_add_u32 v55, v46 offset:2560
  v_cmp_lt_i32 vcc, 8, v45
  s_mov_b64 exec, vcc
  v_lshlrev_b32_sdwa v48, 2, v73 dst_sel:DWORD dst_unused:UNUSED_PAD src0_sel:DWORD src1_sel:BYTE_3
  v_lshlrev_b32_sdwa v49, 2, v72 dst_sel:DWORD dst_unused:UNUSED_PAD src0_sel:DWORD src1_sel:BYTE_3
  ds_add_rtn_u32 v92, v48, v46 offset:2048
  ds_add_u32 v49, v46 offset:2560
  v_cmp_lt_i32 vcc, 9, v45
  s_mov_b64 exec, vcc
  v_lshlrev_b32_sdwa v50, 2, v75 dst_sel:DWORD dst_unused:UNUSED_PAD src0_sel:DWORD src1_sel:BYTE_3
  v_lshlrev_b32_sdwa v51, 2, v74 dst_sel:DWORD dst_unused:UNUSED_PAD src0_sel:DWORD src1_sel:BYTE_3
  ds_add_rtn_u32 v93, v50, v46 offset:2048
  ds_add_u32 v51, v46 offset:2560
  v_cmp_lt_i32 vcc, 12, v45
  s_mov_b64 exec, vcc
  v_lshlrev_b32_sdwa v52, 2, v77 dst_sel:DWORD dst_unused:UNUSED_PAD src0_sel:DWORD src1_sel:BYTE_3
  v_lshlrev_b32_sdwa v53, 2, v76 dst_sel:DWORD dst_unused:UNUSED_PAD src0_sel:DWORD src1_sel:BYTE_3
  ds_add_rtn_u32 v94, v52, v46 offset:2048
  ds_add_u32 v53, v46 offset:2560
  v_cmp_lt_i32 vcc, 13, v45
  s_mov_b64 exec, vcc
  v_lshlrev_b32_sdwa v54, 2, v79 dst_sel:DWORD dst_unused:UNUSED_PAD src0_sel:DWORD src1_sel:BYTE_3
  v_lshlrev_b32_sdwa v55, 2, v78 dst_sel:DWORD dst_unused:UNUSED_PAD src0_sel:DWORD src1_sel:BYTE_3
  ds_add_rtn_u32 v95, v54, v46 offset:2048
  ds_add_u32 v55, v46 offset:2560
  s_mov_b64 exec, -1
  s_cmp_eq_u32 s63, 0
  s_cbranch_scc1 V_NO3B
  v_cmp_lt_i32 vcc, 16, v45
  s_mov_b64 exec, vcc
  v_lshlrev_b32_sdwa v48, 2, v81 dst_sel:DWORD dst_unused:UNUSED_PAD src0_sel:DWORD src1_sel:BYTE_3
  v_lshlrev_b32_sdwa v49, 2, v80 dst_sel:DWORD dst_unused:UNUSED_PAD src0_sel:DWORD src1_sel:BYTE_3
  ds_add_rtn_u32 v96, v48, v46 offset:2048
  ds_add_u32 v49, v46 offset:2560
  v_cmp_lt_i32 vcc, 17, v45
  s_mov_b64 exec, vcc
  v_lshlrev_b32_sdwa v50, 2, v83 dst_sel:DWORD dst_unused:UNUSED_PAD src0_sel:DWORD src1_sel:BYTE_3
  v_lshlrev_b32_sdwa v51, 2, v82 dst_sel:DWORD dst_unused:UNUSED_PAD src0_sel:DWORD src1_sel:BYTE_3
  ds_add_rtn_u32 v97, v50, v46 offset:2048
  ds_add_u32 v51, v46 offset:2560
  v_cmp_lt_i32 vcc, 20, v45
  s_mov_b64 exec, vcc
  v_lshlrev_b32_sdwa v52, 2, v85 dst_sel:DWORD dst_unused:UNUSED_PAD src0_sel:DWORD src1_sel:BYTE_3
  v_lshlrev_b32_sdwa v53, 2, v84 dst_sel:DWORD dst_unused:UNUSED_PAD src0_sel:DWORD src1_sel:BYTE_3
  ds_add_rtn_u32 v98, v52, v46 offset:2048
  ds_add_u32 v53, v46 offset:2560
  v_cmp_lt_i32 vcc, 21, v45
  s_mov_b64 exec, vcc
  v_lshlrev_b32_sdwa v54, 2, v87 dst_sel:DWORD dst_unused:UNUSED_PAD src0_sel:DWORD src1_sel:BYTE_3
  v_lshlrev_b32_sdwa v55, 2, v86 dst_sel:DWORD dst_unused:UNUSED_PAD src0_sel:DWORD src1_sel:BYTE_3
  ds_add_rtn_u32 v99, v54, v46 offset:2048
  ds_add_u32 v55, v46 offset:2560
  s_mov_b64 exec, -1
V_NO3B:
  s_waitcnt lgkmcnt(0)
  s_barrier
  s_cmp_lg_u32 s3, 0
  s_cbranch_scc1 V_NOPFX
  v_lshlrev_b32 v60, 2, v1
  ds_read_b32 v61, v60 offset:2048
  s_waitcnt lgkmcnt(0)
  v_mov_b32 v62, v61
  s_nop 1
  v_add_u32_dpp v62, v62, v62 row_shr:1 row_mask:0xf bank_mask:0xf bound_ctrl:0
  s_nop 1
  v_add_u32_dpp v62, v62, v62 row_shr:2 row_mask:0xf bank_mask:0xf bound_ctrl:0
  s_nop 1
  v_add_u32_dpp v62, v62, v62 row_shr:4 row_mask:0xf bank_mask:0xf bound_ctrl:0
  s_nop 1
  v_add_u32_dpp v62, v62, v62 row_shr:8 row_mask:0xf bank_mask:0xf bound_ctrl:0
  s_nop 0
  v_readlane_b32 s50, v62, 15
  v_readlane_b32 s51, v62, 31
  v_readlane_b32 s52, v62, 47
  v_readlane_b32 s53, v62, 63
  s_nop 3
  s_add_u32 s58, s50, s51
  s_add_u32 s58, s58, s52
  s_add_u32 s58, s58, s53
  s_add_u32 s50, s50, 31
  s_lshr_b32 s50, s50, 5
  s_add_u32 s51, s51, 31
  s_lshr_b32 s51, s51, 5
  s_add_u32 s52, s52, 31
  s_lshr_b32 s52, s52, 5
  s_add_u32 s53, s53, 31
  s_lshr_b32 s53, s53, 5
  s_mov_b32 s54, 0
  s_mov_b32 s55, s50
  s_add_u32 s56, s55, s51
  s_add_u32 s57, s56, s52
  v_sub_u32 v62, v62, v61
  v_mov_b32 v63, 0
  s_lshl_b32 s59, s55, 5
  v_mov_b32 v48, s59
  v_cmp_le_u32 vcc, 16, v1
  s_nop 1
  v_cndmask_b32 v63, v63, v48, vcc
  s_lshl_b32 s59, s56, 5
  v_mov_b32 v48, s59
  v_cmp_le_u32 vcc, 32, v1
  s_nop 1
  v_cndmask_b32 v63, v63, v48, vcc
  s_lshl_b32 s59, s57, 5
  v_mov_b32 v48, s59
  v_cmp_le_u32 vcc, 48, v1
  s_nop 1
  v_cndmask_b32 v63, v63, v48, vcc
  v_add_u32 v62, v62, v63
  ds_write_b32 v60, v62 offset:2304
  s_mov_b64 exec, 1
  v_mov_b32 v48, s50
  v_mov_b32 v49, s51
  v_mov_b32 v50, s52
  v_mov_b32 v51, s53
  v_mov_b32 v52, s54
  v_mov_b32 v53, s55
  v_mov_b32 v54, s56
  v_mov_b32 v55, s57
  v_mov_b32 v60, 0
  ds_write_b128 v60, v[48:51] offset:3072
  ds_write_b128 v60, v[52:55] offset:3088
  s_cmp_gt_u32 s58, 1920
  s_cbranch_scc0 V_NOOVF
  v_mov_b32 v61, 1
  ds_write_b32 v60, v61 offset:3104
V_NOOVF:
  s_mov_b64 exec, -1
V_NOPFX:
  s_waitcnt lgkmcnt(0)
  s_barrier
  s_lshl_b32 s50, s37, 2
  v_mov_b32 v60, s50
  v_mov_b32 v48, 0
  ds_read_b32 v61, v48 offset:3104
  ds_read_b32 v62, v60 offset:3072
  ds_read_b32 v63, v60 offset:3088
  v_lshlrev_b32_sdwa v48, 2, v65 dst_sel:DWORD dst_unused:UNUSED_PAD src0_sel:DWORD src1_sel:BYTE_3
  ds_read_b32 v160, v48 offset:2304
  v_lshlrev_b32_sdwa v49, 2, v67 dst_sel:DWORD dst_unused:UNUSED_PAD src0_sel:DWORD src1_sel:BYTE_3
  ds_read_b32 v161, v49 offset:2304
  v_lshlrev_b32_sdwa v50, 2, v69 dst_sel:DWORD dst_unused:UNUSED_PAD src0_sel:DWORD src1_sel:BYTE_3
  ds_read_b32 v162, v50 offset:2304
  v_lshlrev_b32_sdwa v51, 2, v71 dst_sel:DWORD dst_unused:UNUSED_PAD src0_sel:DWORD src1_sel:BYTE_3
  ds_read_b32 v163, v51 offset:2304
  v_lshlrev_b32_sdwa v52, 2, v73 dst_sel:DWORD dst_unused:UNUSED_PAD src0_sel:DWORD src1_sel:BYTE_3
  ds_read_b32 v164, v52 offset:2304
  v_lshlrev_b32_sdwa v53, 2, v75 dst_sel:DWORD dst_unused:UNUSED_PAD src0_sel:DWORD src1_sel:BYTE_3
  ds_read_b32 v165, v53 offset:2304
  v_lshlrev_b32_sdwa v54, 2, v77 dst_sel:DWORD dst_unused:UNUSED_PAD src0_sel:DWORD src1_sel:BYTE_3
  ds_read_b32 v166, v54 offset:2304
  v_lshlrev_b32_sdwa v55, 2, v79 dst_sel:DWORD dst_unused:UNUSED_PAD src0_sel:DWORD src1_sel:BYTE_3
  ds_read_b32 v167, v55 offset:2304
  s_waitcnt lgkmcnt(8)
  v_readfirstlane_b32 s50, v61
  v_readfirstlane_b32 s42, v62
  v_readfirstlane_b32 s51, v63
  s_nop 3
  s_cmp_eq_u32 s50, 0
  s_cbranch_scc1 V_FIT
  s_cmp_eq_u32 s44, 1
  s_cbranch_scc1 V_FIT
  s_mov_b32 s44, 1
  s_mov_b32 s43, 0
  s_max_u32 s62, s62, 2
  s_waitcnt lgkmcnt(0)
  s_barrier
  s_branch V_REDO
V_FIT:
  s_min_u32 s42, s42, 66
  s_min_u32 s59, s51, 66
  s_cmp_ge_u32 s62, 4
  s_cbranch_scc1 V_NOFL1
  v_lshlrev_b32 v60, 3, v1
  s_and_b32 s52, s3, 3
  s_lshl_b32 s52, s52, 9
  s_add_u32 s52, s52, 0x1190000
  buffer_load_dwordx2 v[62:63], v60, s[28:31], s52 offen sc1
V_NOFL1:
  s_waitcnt lgkmcnt(0)
  v_cmp_lt_i32 vcc, 0, v45
  s_mov_b64 exec, vcc
  v_add_u32 v160, v160, v88
  v_lshlrev_b32 v48, 2, v160
  v_bfi_b32 v49, s46, v65, v64
  v_bfe_u32 v50, v64, 24, 5
  v_mul_u32_u24 v50, 80, v50
  v_and_b32 v51, s46, v64
  v_lshlrev_b32 v160, 1, v160
  ds_write_b32 v48, v51 offset:40960
  ds_write_b32 v48, v49 offset:49664
  ds_write_b16 v160, v50 offset:58368
  v_cmp_lt_i32 vcc, 1, v45
  s_mov_b64 exec, vcc
  v_add_u32 v161, v161, v89
  v_lshlrev_b32 v52, 2, v161
  v_bfi_b32 v53, s46, v67, v66
  v_bfe_u32 v54, v66, 24, 5
  v_mul_u32_u24 v54, 80, v54
  v_and_b32 v55, s46, v66
  v_lshlrev_b32 v161, 1, v161
  ds_write_b32 v52, v55 offset:40960
  ds_write_b32 v52, v53 offset:49664
  ds_write_b16 v161, v54 offset:58368
  v_cmp_lt_i32 vcc, 4, v45
  s_mov_b64 exec, vcc
  v_add_u32 v162, v162, v90
  v_lshlrev_b32 v48, 2, v162
  v_bfi_b32 v49, s46, v69, v68
  v_bfe_u32 v50, v68, 24, 5
  v_mul_u32_u24 v50, 80, v50
  v_and_b32 v51, s46, v68
  v_lshlrev_b32 v162, 1, v162
  ds_write_b32 v48, v51 offset:40960
  ds_write_b32 v48, v49 offset:49664
  ds_write_b16 v162, v50 offset:58368
  v_cmp_lt_i32 vcc, 5, v45
  s_mov_b64 exec, vcc
  v_add_u32 v163, v163, v91
  v_lshlrev_b32 v52, 2, v163
  v_bfi_b32 v53, s46, v71, v70
  v_bfe_u32 v54, v70, 24, 5
  v_mul_u32_u24 v54, 80, v54
  v_and_b32 v55, s46, v70
  v_lshlrev_b32 v163, 1, v163
  ds_write_b32 v52, v55 offset:40960
  ds_write_b32 v52, v53 offset:49664
  ds_write_b16 v163, v54 offset:58368
  v_cmp_lt_i32 vcc, 8, v45
  s_mov_b64 exec, vcc
  v_add_u32 v164, v164, v92
  v_lshlrev_b32 v48, 2, v164
  v_bfi_b32 v49, s46, v73, v72
  v_bfe_u32 v50, v72, 24, 5
  v_mul_u32_u24 v50, 80, v50
  v_and_b32 v51, s46, v72
  v_lshlrev_b32 v164, 1, v164
  ds_write_b32 v48, v51 offset:40960
  ds_write_b32 v48, v49 offset:49664
  ds_write_b16 v164, v50 offset:58368
  v_cmp_lt_i32 vcc, 9, v45
  s_mov_b64 exec, vcc
  v_add_u32 v165, v165, v93
  v_lshlrev_b32 v52, 2, v165
  v_bfi_b32 v53, s46, v75, v74
  v_bfe_u32 v54, v74, 24, 5
  v_mul_u32_u24 v54, 80, v54
  v_and_b32 v55, s46, v74
  v_lshlrev_b32 v165, 1, v165
  ds_write_b32 v52, v55 offset:40960
  ds_write_b32 v52, v53 offset:49664
  ds_write_b16 v165, v54 offset:58368
  v_cmp_lt_i32 vcc, 12, v45
  s_mov_b64 exec, vcc
  v_add_u32 v166, v166, v94
  v_lshlrev_b32 v48, 2, v166
  v_bfi_b32 v49, s46, v77, v76
  v_bfe_u32 v50, v76, 24, 5
  v_mul_u32_u24 v50, 80, v50
  v_and_b32 v51, s46, v76
  v_lshlrev_b32 v166, 1, v166
  ds_write_b32 v48, v51 offset:40960
  ds_write_b32 v48, v49 offset:49664
  ds_write_b16 v166, v50 offset:58368
  v_cmp_lt_i32 vcc, 13, v45
  s_mov_b64 exec, vcc
  v_add_u32 v167, v167, v95
  v_lshlrev_b32 v52, 2, v167
  v_bfi_b32 v53, s46, v79, v78
  v_bfe_u32 v54, v78, 24, 5
  v_mul_u32_u24 v54, 80, v54
  v_and_b32 v55, s46, v78
  v_lshlrev_b32 v167, 1, v167
  ds_write_b32 v52, v55 offset:40960
  ds_write_b32 v52, v53 offset:49664
  ds_write_b16 v167, v54 offset:58368
  s_mov_b64 exec, -1
  s_cmp_eq_u32 s63, 0
  s_cbranch_scc1 V_NO3C
  v_lshlrev_b32_sdwa v56, 2, v81 dst_sel:DWORD dst_unused:UNUSED_PAD src0_sel:DWORD src1_sel:BYTE_3
  ds_read_b32 v168, v56 offset:2304
  v_lshlrev_b32_sdwa v57, 2, v83 dst_sel:DWORD dst_unused:UNUSED_PAD src0_sel:DWORD src1_sel:BYTE_3
  ds_read_b32 v169, v57 offset:2304
  v_lshlrev_b32_sdwa v56, 2, v85 dst_sel:DWORD dst_unused:UNUSED_PAD src0_sel:DWORD src1_sel:BYTE_3
  ds_read_b32 v170, v56 offset:2304
  v_lshlrev_b32_sdwa v57, 2, v87 dst_sel:DWORD dst_unused:UNUSED_PAD src0_sel:DWORD src1_sel:BYTE_3
  ds_read_b32 v171, v57 offset:2304
  s_waitcnt lgkmcnt(0)
  v_cmp_lt_i32 vcc, 16, v45
  s_mov_b64 exec, vcc
  v_add_u32 v168, v168, v96
  v_lshlrev_b32 v48, 2, v168
  v_bfi_b32 v49, s46, v81, v80
  v_bfe_u32 v50, v80, 24, 5
  v_mul_u32_u24 v50, 80, v50
  v_and_b32 v51, s46, v80
  v_lshlrev_b32 v168, 1, v168
  ds_write_b32 v48, v51 offset:40960
  ds_write_b32 v48, v49 offset:49664
  ds_write_b16 v168, v50 offset:58368
  v_cmp_lt_i32 vcc, 17, v45
  s_mov_b64 exec, vcc
  v_add_u32 v169, v169, v97
  v_lshlrev_b32 v52, 2, v169
  v_bfi_b32 v53, s46, v83, v82
  v_bfe_u32 v54, v82, 24, 5
  v_mul_u32_u24 v54, 80, v54
  v_and_b32 v55, s46, v82
  v_lshlrev_b32 v169, 1, v169
  ds_write_b32 v52, v55 offset:40960
  ds_write_b32 v52, v53 offset:49664
  ds_write_b16 v169, v54 offset:58368
  v_cmp_lt_i32 vcc, 20, v45
  s_mov_b64 exec, vcc
  v_add_u32 v170, v170, v98
  v_lshlrev_b32 v48, 2, v170
  v_bfi_b32 v49, s46, v85, v84
  v_bfe_u32 v50, v84, 24, 5
  v_mul_u32_u24 v50, 80, v50
  v_and_b32 v51, s46, v84
  v_lshlrev_b32 v170, 1, v170
  ds_write_b32 v48, v51 offset:40960
  ds_write_b32 v48, v49 offset:49664
  ds_write_b16 v170, v50 offset:58368
  v_cmp_lt_i32 vcc, 21, v45
  s_mov_b64 exec, vcc
  v_add_u32 v171, v171, v99
  v_lshlrev_b32 v52, 2, v171
  v_bfi_b32 v53, s46, v87, v86
  v_bfe_u32 v54, v86, 24, 5
  v_mul_u32_u24 v54, 80, v54
  v_and_b32 v55, s46, v86
  v_lshlrev_b32 v171, 1, v171
  ds_write_b32 v52, v55 offset:40960
  ds_write_b32 v52, v53 offset:49664
  ds_write_b16 v171, v54 offset:58368
  s_mov_b64 exec, -1
V_NO3C:
  s_cmp_ge_u32 s62, 4
  s_cbranch_scc1 V_AOK
  s_mov_b32 s62, 4
  v_lshlrev_b32 v60, 3, v1
  s_and_b32 s52, s3, 3
  s_lshl_b32 s52, s52, 9
  s_add_u32 s52, s52, 0x1190000
  s_mov_b32 s53, 0
  s_branch V_APOLL1
V_APOLL:
  buffer_load_dwordx2 v[62:63], v60, s[28:31], s52 offen sc1
V_APOLL1:
  s_waitcnt vmcnt(0)
  v_xor_b32 v63, v62, v63
  v_cmp_ne_u32 vcc, s47, v63
  s_cmp_eq_u64 vcc, 0
  s_cbranch_scc1 V_APOLLED
  s_add_u32 s53, s53, 1
  s_cmp_gt_u32 s53, 0x4000
  s_cbranch_scc0 V_APOLL
V_APOLLED:
  v_mov_b32 v63, v62
  s_nop 1
  s_nop 1
  v_mov_b32_dpp v61, v63 row_shr:1 row_mask:0xf bank_mask:0xf bound_ctrl:0
  v_pk_max_u16 v63, v63, v61
  s_nop 1
  v_mov_b32_dpp v61, v63 row_shr:2 row_mask:0xf bank_mask:0xf bound_ctrl:0
  v_pk_max_u16 v63, v63, v61
  s_nop 1
  v_mov_b32_dpp v61, v63 row_shr:4 row_mask:0xf bank_mask:0xf bound_ctrl:0
  v_pk_max_u16 v63, v63, v61
  s_nop 1
  v_mov_b32_dpp v61, v63 row_shr:8 row_mask:0xf bank_mask:0xf bound_ctrl:0
  v_pk_max_u16 v63, v63, v61
  s_nop 1
  v_mov_b32 v61, 0
  s_nop 1
  v_mov_b32_dpp v61, v63 row_bcast:15 row_mask:0xa bank_mask:0xf
  v_pk_max_u16 v63, v63, v61
  v_mov_b32 v61, 0
  s_nop 1
  v_mov_b32_dpp v61, v63 row_bcast:31 row_mask:0xc bank_mask:0xf
  v_pk_max_u16 v63, v63, v61
  s_nop 0
  v_readlane_b32 s52, v63, 63
  s_nop 3
  s_and_b32 s53, s52, 0xffff
  s_lshr_b32 s52, s52, 16
  v_mov_b32 v60, 0
  v_mov_b32 v61, s52
  v_mov_b32 v62, s53
  s_mov_b64 exec, 1
  ds_max_u32 v60, v61 offset:3116
  ds_max_u32 v60, v62 offset:3120
  s_mov_b64 exec, -1
  s_waitcnt vmcnt(0) lgkmcnt(0)
  s_barrier
  s_lshl_b32 s52, s38, 12
  s_add_u32 s52, s52, 0x1194000
  buffer_load_dwordx4 v[112:115], v4, s[28:31], s52 offen offset:0 sc1
  buffer_load_dwordx4 v[116:119], v4, s[28:31], s52 offen offset:1024 sc1
  buffer_load_dwordx4 v[120:123], v4, s[28:31], s52 offen offset:2048 sc1
  buffer_load_dwordx4 v[124:127], v4, s[28:31], s52 offen offset:3072 sc1
  v_mov_b32 v60, 0
  ds_read_b32 v61, v60 offset:3116
  ds_read_b32 v62, v60 offset:3120
  s_waitcnt lgkmcnt(0)
  v_lshlrev_b32 v62, 16, v62
  v_rcp_f32 v62, v62
  s_nop 0
  v_mul_f32 v62, 0x40f00000, v62
  v_min_f32 v62, 0x7f000000, v62
  v_lshrrev_b32 v62, 16, v62
  s_nop 0
  v_readfirstlane_b32 s99, v62
  v_readfirstlane_b32 s52, v61
  s_nop 3
  s_cmp_ge_u32 s52, 0x4280
  s_cselect_b32 s45, 1, s45
  s_branch V_LISTS
V_AOK:
  s_waitcnt lgkmcnt(0)
  s_barrier
V_LISTS:
  s_cmp_eq_u32 s42, 0
  s_cbranch_scc1 V_LOOP_DONE
  s_lshl_b32 s51, s59, 7
  v_add_u32 v18, s51, v32
  v_add_u32 v19, s51, v33
  s_lshl_b32 s51, s59, 6
  v_add_u32 v20, s51, v34
  ds_read_b128 v[12:15], v18
  ds_read_b32 v21, v19
  s_waitcnt lgkmcnt(0)
  v_add_u32 v12, v12, v36
  v_add_u32 v13, v13, v37
  v_add_u32 v14, v14, v38
  v_add_u32 v15, v15, v39
  v_and_or_b32 v22, v21, s46, v28
  v_bfe_u32 v21, v21, 24, 5
  v_mad_u32_u24 v23, v21, v31, v30
  s_add_u32 m0, s41, 0
  s_nop 0
  buffer_load_dwordx4 v12, s[24:27], s39 offen offset:0 sc1 lds
  buffer_load_dwordx4 v13, s[24:27], s39 offen offset:1024 sc1 lds
  buffer_load_dwordx4 v14, s[24:27], s39 offen offset:2048 sc1 lds
  buffer_load_dwordx4 v15, s[24:27], s39 offen offset:3072 sc1 lds
  buffer_load_dwordx4 v[84:87], v22, s[12:15], 0 offen
  ds_read_b128 v[40:43], v18 offset:128
  ds_read_b128 v[72:75], v23
  ds_read_b128 v[76:79], v23 offset:32
  ds_read_b32 v21, v19 offset:128
  s_waitcnt lgkmcnt(0)
  v_and_or_b32 v22, v21, s46, v28
  v_bfe_u32 v21, v21, 24, 5
  v_mad_u32_u24 v23, v21, v31, v30
  ds_read_b64 v[26:27], v20 offset:0
  v_add_u32 v18, 256, v18
  v_add_u32 v19, 256, v19
  v_add_u32 v20, 64, v20
  v_mov_b32 v56, 0
  v_mov_b32 v64, 0
  v_mov_b32 v57, 0
  v_mov_b32 v65, 0
  v_mov_b32 v58, 0
  v_mov_b32 v66, 0
  v_mov_b32 v59, 0
  v_mov_b32 v67, 0
  v_mov_b32 v60, 0
  v_mov_b32 v68, 0
  v_mov_b32 v61, 0
  v_mov_b32 v69, 0
  v_mov_b32 v62, 0
  v_mov_b32 v70, 0
  v_mov_b32 v63, 0
  v_mov_b32 v71, 0
  s_waitcnt lgkmcnt(0)
  v_add_u32_sdwa v24, v29, v26 dst_sel:DWORD dst_unused:UNUSED_PAD src0_sel:DWORD src1_sel:WORD_0
  v_add_u32_sdwa v25, v29, v26 dst_sel:DWORD dst_unused:UNUSED_PAD src0_sel:DWORD src1_sel:WORD_1
  v_add_u32_sdwa v26, v29, v27 dst_sel:DWORD dst_unused:UNUSED_PAD src0_sel:DWORD src1_sel:WORD_0
  v_add_u32_sdwa v27, v29, v27 dst_sel:DWORD dst_unused:UNUSED_PAD src0_sel:DWORD src1_sel:WORD_1
  s_waitcnt vmcnt(0)
  ds_read_b128 v[88:91], v8 offset:0
  ds_read_b128 v[92:95], v9 offset:0
  ds_read_b128 v[96:99], v10 offset:0
  ds_read_b128 v[100:103], v11 offset:0
  v_mov_b32 v80, v84
  v_mov_b32 v81, v85
  v_mov_b32 v82, v86
  v_mov_b32 v83, v87
  v_and_b32 v21, v5, v80
  v_pk_max_u16 v16, v16, v21
  v_and_b32 v21, v5, v81
  v_pk_max_u16 v16, v16, v21
  v_and_b32 v21, v5, v82
  v_pk_max_u16 v16, v16, v21
  v_and_b32 v21, v5, v83
  v_pk_max_u16 v16, v16, v21
  s_add_u32 m0, s41, 4096
  s_nop 0
  buffer_load_dwordx4 v12, s[24:27], s40 offen offset:0 sc1 lds
  buffer_load_dwordx4 v13, s[24:27], s40 offen offset:1024 sc1 lds
  buffer_load_dwordx4 v14, s[24:27], s40 offen offset:2048 sc1 lds
  buffer_load_dwordx4 v15, s[24:27], s40 offen offset:3072 sc1 lds
  v_add_u32 v12, v40, v36
  v_add_u32 v13, v41, v37
  v_add_u32 v14, v42, v38
  v_add_u32 v15, v43, v39
  s_waitcnt lgkmcnt(0)
  s_add_u32 m0, s41, 0
  s_nop 0
  buffer_load_dwordx4 v12, s[24:27], s39 offen offset:0 sc1 lds
  buffer_load_dwordx4 v13, s[24:27], s39 offen offset:1024 sc1 lds
  buffer_load_dwordx4 v14, s[24:27], s39 offen offset:2048 sc1 lds
  buffer_load_dwordx4 v15, s[24:27], s39 offen offset:3072 sc1 lds
  buffer_load_dwordx4 v[84:87], v22, s[12:15], 0 offen
  v_mfma_f32_32x32x16_bf16 v[160:175], v[80:83], v[112:115], 0
  v_mfma_f32_32x32x16_bf16 v[160:175], v[72:75], v[128:131], v[160:175]
  v_mfma_f32_32x32x16_bf16 v[160:175], v[76:79], v[132:135], v[160:175]
  v_mfma_f32_32x32x16_bf16 v[160:175], v[88:91], v[104:107], v[160:175]
  v_mfma_f32_32x32x16_bf16 v[160:175], v[92:95], v[108:111], v[160:175]
  s_nop 15
  s_lshl_b32 s58, s3, 2
  s_add_u32 s58, s58, 3200
  v_mov_b32 v2, s58
  s_cmp_lg_u32 s45, 0
  s_cbranch_scc1 V_SLOOP
  .p2align 6
V_LOOP:
  s_nop 1
  v_mfma_f32_32x32x16_bf16 v[240:255], v[56:59], v[64:67], v[240:255]
  ds_read_b64_tr_b16 v[64:65], v24
  ds_read_b64_tr_b16 v[66:67], v25
  v_lshlrev_b32_sdwa v40, 1, v160 dst_sel:DWORD dst_unused:UNUSED_PAD src0_sel:DWORD src1_sel:WORD_1
  ds_read_u16_d16 v40, v40 offset:6400
  v_lshlrev_b32_sdwa v41, 1, v161 dst_sel:DWORD dst_unused:UNUSED_PAD src0_sel:DWORD src1_sel:WORD_1
  ds_read_u16_d16_hi v41, v41 offset:6400
  v_mov_b32 v17, s42
  ds_write2_b32 v2, v17, v17 offset0:0 offset1:8
  v_lshlrev_b32_sdwa v42, 1, v168 dst_sel:DWORD dst_unused:UNUSED_PAD src0_sel:DWORD src1_sel:WORD_1
  ds_read_u16_d16 v42, v42 offset:6400
  v_lshlrev_b32_sdwa v43, 1, v169 dst_sel:DWORD dst_unused:UNUSED_PAD src0_sel:DWORD src1_sel:WORD_1
  v_mfma_f32_32x32x16_bf16 v[240:255], v[60:63], v[68:71], v[240:255]
  ds_read_b64_tr_b16 v[68:69], v26
  ds_read_b64_tr_b16 v[70:71], v27
  ds_read_u16_d16_hi v43, v43 offset:6400
  v_lshlrev_b32_sdwa v44, 1, v162 dst_sel:DWORD dst_unused:UNUSED_PAD src0_sel:DWORD src1_sel:WORD_1
  ds_read_u16_d16 v44, v44 offset:6400
  v_lshlrev_b32_sdwa v45, 1, v163 dst_sel:DWORD dst_unused:UNUSED_PAD src0_sel:DWORD src1_sel:WORD_1
  ds_read_u16_d16_hi v45, v45 offset:6400
  ds_read_b32 v17, v2 offset:16
  v_lshlrev_b32_sdwa v46, 1, v170 dst_sel:DWORD dst_unused:UNUSED_PAD src0_sel:DWORD src1_sel:WORD_1
  ds_read_u16_d16 v46, v46 offset:6400
  v_lshlrev_b32_sdwa v47, 1, v171 dst_sel:DWORD dst_unused:UNUSED_PAD src0_sel:DWORD src1_sel:WORD_1
  v_mfma_f32_32x32x16_bf16 v[176:191], v[80:83], v[116:119], 0
  ds_read_u16_d16_hi v47, v47 offset:6400
  v_lshlrev_b32_sdwa v48, 1, v164 dst_sel:DWORD dst_unused:UNUSED_PAD src0_sel:DWORD src1_sel:WORD_1
  ds_read_u16_d16 v48, v48 offset:6400
  v_lshlrev_b32_sdwa v49, 1, v165 dst_sel:DWORD dst_unused:UNUSED_PAD src0_sel:DWORD src1_sel:WORD_1
  ds_read_u16_d16_hi v49, v49 offset:6400
  v_exp_f32 v50, v166
  v_mfma_f32_32x32x16_bf16 v[176:191], v[72:75], v[136:139], v[176:191]
  v_exp_f32 v51, v167
  v_exp_f32 v52, v172
  v_exp_f32 v53, v173
  v_exp_f32 v54, v174
  v_exp_f32 v55, v175
  v_add_f32 v50, 1.0, v50
  v_add_f32 v51, 1.0, v51
  v_mfma_f32_32x32x16_bf16 v[176:191], v[76:79], v[140:143], v[176:191]
  v_add_f32 v52, 1.0, v52
  v_add_f32 v53, 1.0, v53
  v_add_f32 v54, 1.0, v54
  v_add_f32 v55, 1.0, v55
  v_rcp_f32 v50, v50
  v_rcp_f32 v51, v51
  v_mfma_f32_32x32x16_bf16 v[176:191], v[96:99], v[104:107], v[176:191]
  v_rcp_f32 v52, v52
  v_rcp_f32 v53, v53
  v_rcp_f32 v54, v54
  v_rcp_f32 v55, v55
  v_mul_f32 v50, v50, v166
  v_mul_f32 v51, v51, v167
  v_mul_f32 v52, v52, v172
  v_mfma_f32_32x32x16_bf16 v[176:191], v[100:103], v[108:111], v[176:191]
  v_mul_f32 v53, v53, v173
  v_mul_f32 v54, v54, v174
  v_mul_f32 v55, v55, v175
  v_cvt_pk_bf16_f32 v59, v50, v51
  v_cvt_pk_bf16_f32 v62, v52, v53
  v_cvt_pk_bf16_f32 v63, v54, v55
  s_waitcnt lgkmcnt(0)
  v_or_b32 v56, v40, v41
  v_or_b32 v60, v42, v43
  v_or_b32 v57, v44, v45
  v_or_b32 v61, v46, v47
  v_or_b32 v58, v48, v49
  s_waitcnt vmcnt(5)
  ds_read_b128 v[88:91], v8 offset:4096
  ds_read_b128 v[92:95], v9 offset:4096
  ds_read_b128 v[96:99], v10 offset:4096
  ds_read_b128 v[100:103], v11 offset:4096
  s_waitcnt lgkmcnt(12)
  v_mfma_f32_32x32x16_bf16 v[192:207], v[56:59], v[64:67], v[192:207]
  v_lshlrev_b32_sdwa v40, 1, v176 dst_sel:DWORD dst_unused:UNUSED_PAD src0_sel:DWORD src1_sel:WORD_1
  ds_read_u16_d16 v40, v40 offset:6400
  v_lshlrev_b32_sdwa v41, 1, v177 dst_sel:DWORD dst_unused:UNUSED_PAD src0_sel:DWORD src1_sel:WORD_1
  ds_read_u16_d16_hi v41, v41 offset:6400
  v_lshlrev_b32_sdwa v42, 1, v184 dst_sel:DWORD dst_unused:UNUSED_PAD src0_sel:DWORD src1_sel:WORD_1
  ds_read_u16_d16 v42, v42 offset:6400
  v_lshlrev_b32_sdwa v43, 1, v185 dst_sel:DWORD dst_unused:UNUSED_PAD src0_sel:DWORD src1_sel:WORD_1
  v_mfma_f32_32x32x16_bf16 v[192:207], v[60:63], v[68:71], v[192:207]
  ds_read_u16_d16_hi v43, v43 offset:6400
  v_lshlrev_b32_sdwa v44, 1, v178 dst_sel:DWORD dst_unused:UNUSED_PAD src0_sel:DWORD src1_sel:WORD_1
  ds_read_u16_d16 v44, v44 offset:6400
  v_lshlrev_b32_sdwa v45, 1, v179 dst_sel:DWORD dst_unused:UNUSED_PAD src0_sel:DWORD src1_sel:WORD_1
  ds_read_u16_d16_hi v45, v45 offset:6400
  s_waitcnt lgkmcnt(14)
  v_readfirstlane_b32 s58, v17
  s_nop 3
  s_cmp_gt_u32 s42, s58
  s_cbranch_scc1 PRH_1
  s_setprio 0
  s_branch PRD_1
PRH_1:
  s_setprio 1
PRD_1:
  v_lshlrev_b32_sdwa v46, 1, v186 dst_sel:DWORD dst_unused:UNUSED_PAD src0_sel:DWORD src1_sel:WORD_1
  ds_read_u16_d16 v46, v46 offset:6400
  s_waitcnt lgkmcnt(7)
  s_add_u32 m0, s41, 4096
  s_nop 0
  buffer_load_dwordx4 v12, s[24:27], s40 offen offset:0 sc1 lds
  v_lshlrev_b32_sdwa v47, 1, v187 dst_sel:DWORD dst_unused:UNUSED_PAD src0_sel:DWORD src1_sel:WORD_1
  v_mfma_f32_32x32x16_bf16 v[160:175], v[80:83], v[120:123], 0
  ds_read_u16_d16_hi v47, v47 offset:6400
  v_lshlrev_b32_sdwa v48, 1, v180 dst_sel:DWORD dst_unused:UNUSED_PAD src0_sel:DWORD src1_sel:WORD_1
  ds_read_u16_d16 v48, v48 offset:6400
  v_lshlrev_b32_sdwa v49, 1, v181 dst_sel:DWORD dst_unused:UNUSED_PAD src0_sel:DWORD src1_sel:WORD_1
  ds_read_u16_d16_hi v49, v49 offset:6400
  buffer_load_dwordx4 v13, s[24:27], s40 offen offset:1024 sc1 lds
  v_exp_f32 v50, v182
  v_mfma_f32_32x32x16_bf16 v[160:175], v[72:75], v[144:147], v[160:175]
  v_exp_f32 v51, v183
  v_exp_f32 v52, v188
  v_exp_f32 v53, v189
  v_exp_f32 v54, v190
  v_exp_f32 v55, v191
  buffer_load_dwordx4 v14, s[24:27], s40 offen offset:2048 sc1 lds
  v_add_f32 v50, 1.0, v50
  v_add_f32 v51, 1.0, v51
  v_mfma_f32_32x32x16_bf16 v[160:175], v[76:79], v[148:151], v[160:175]
  v_add_f32 v52, 1.0, v52
  v_add_f32 v53, 1.0, v53
  v_add_f32 v54, 1.0, v54
  v_add_f32 v55, 1.0, v55
  buffer_load_dwordx4 v15, s[24:27], s40 offen offset:3072 sc1 lds
  v_rcp_f32 v50, v50
  ds_read_b128 v[12:15], v18
  v_rcp_f32 v51, v51
  v_mfma_f32_32x32x16_bf16 v[160:175], v[88:91], v[104:107], v[160:175]
  v_rcp_f32 v52, v52
  v_rcp_f32 v53, v53
  v_rcp_f32 v54, v54
  v_rcp_f32 v55, v55
  v_mul_f32 v50, v50, v182
  v_mul_f32 v51, v51, v183
  v_mul_f32 v52, v52, v188
  v_mfma_f32_32x32x16_bf16 v[160:175], v[92:95], v[108:111], v[160:175]
  v_mul_f32 v53, v53, v189
  v_mul_f32 v54, v54, v190
  v_mul_f32 v55, v55, v191
  v_cvt_pk_bf16_f32 v59, v50, v51
  v_cvt_pk_bf16_f32 v62, v52, v53
  v_cvt_pk_bf16_f32 v63, v54, v55
  s_waitcnt lgkmcnt(1)
  v_or_b32 v56, v40, v41
  v_or_b32 v60, v42, v43
  v_or_b32 v57, v44, v45
  v_or_b32 v61, v46, v47
  v_or_b32 v58, v48, v49
  s_waitcnt lgkmcnt(0)
  v_add_u32 v12, v12, v36
  v_add_u32 v13, v13, v37
  v_add_u32 v14, v14, v38
  v_add_u32 v15, v15, v39
  v_mfma_f32_32x32x16_bf16 v[208:223], v[56:59], v[64:67], v[208:223]
  v_lshlrev_b32_sdwa v40, 1, v160 dst_sel:DWORD dst_unused:UNUSED_PAD src0_sel:DWORD src1_sel:WORD_1
  ds_read_u16_d16 v40, v40 offset:6400
  v_lshlrev_b32_sdwa v41, 1, v161 dst_sel:DWORD dst_unused:UNUSED_PAD src0_sel:DWORD src1_sel:WORD_1
  ds_read_u16_d16_hi v41, v41 offset:6400
  v_lshlrev_b32_sdwa v42, 1, v168 dst_sel:DWORD dst_unused:UNUSED_PAD src0_sel:DWORD src1_sel:WORD_1
  ds_read_u16_d16 v42, v42 offset:6400
  v_lshlrev_b32_sdwa v43, 1, v169 dst_sel:DWORD dst_unused:UNUSED_PAD src0_sel:DWORD src1_sel:WORD_1
  v_mfma_f32_32x32x16_bf16 v[208:223], v[60:63], v[68:71], v[208:223]
  ds_read_u16_d16_hi v43, v43 offset:6400
  v_lshlrev_b32_sdwa v44, 1, v162 dst_sel:DWORD dst_unused:UNUSED_PAD src0_sel:DWORD src1_sel:WORD_1
  ds_read_u16_d16 v44, v44 offset:6400
  v_lshlrev_b32_sdwa v45, 1, v163 dst_sel:DWORD dst_unused:UNUSED_PAD src0_sel:DWORD src1_sel:WORD_1
  ds_read_u16_d16_hi v45, v45 offset:6400
  v_lshlrev_b32_sdwa v46, 1, v170 dst_sel:DWORD dst_unused:UNUSED_PAD src0_sel:DWORD src1_sel:WORD_1
  ds_read_u16_d16 v46, v46 offset:6400
  v_lshlrev_b32_sdwa v47, 1, v171 dst_sel:DWORD dst_unused:UNUSED_PAD src0_sel:DWORD src1_sel:WORD_1
  v_mfma_f32_32x32x16_bf16 v[176:191], v[80:83], v[124:127], 0
  ds_read_u16_d16_hi v47, v47 offset:6400
  v_lshlrev_b32_sdwa v48, 1, v164 dst_sel:DWORD dst_unused:UNUSED_PAD src0_sel:DWORD src1_sel:WORD_1
  ds_read_u16_d16 v48, v48 offset:6400
  v_lshlrev_b32_sdwa v49, 1, v165 dst_sel:DWORD dst_unused:UNUSED_PAD src0_sel:DWORD src1_sel:WORD_1
  ds_read_u16_d16_hi v49, v49 offset:6400
  v_exp_f32 v50, v166
  v_mfma_f32_32x32x16_bf16 v[176:191], v[72:75], v[152:155], v[176:191]
  v_exp_f32 v51, v167
  v_exp_f32 v52, v172
  v_exp_f32 v53, v173
  v_exp_f32 v54, v174
  v_exp_f32 v55, v175
  v_add_f32 v50, 1.0, v50
  v_add_f32 v51, 1.0, v51
  v_mfma_f32_32x32x16_bf16 v[176:191], v[76:79], v[156:159], v[176:191]
  v_add_f32 v52, 1.0, v52
  v_add_f32 v53, 1.0, v53
  ds_read_b128 v[72:75], v23
  ds_read_b128 v[76:79], v23 offset:32
  ds_read_b32 v21, v19
  v_add_f32 v54, 1.0, v54
  v_add_f32 v55, 1.0, v55
  v_rcp_f32 v50, v50
  v_rcp_f32 v51, v51
  v_mfma_f32_32x32x16_bf16 v[176:191], v[96:99], v[104:107], v[176:191]
  v_rcp_f32 v52, v52
  v_rcp_f32 v53, v53
  v_rcp_f32 v54, v54
  v_rcp_f32 v55, v55
  v_mul_f32 v50, v50, v166
  v_mul_f32 v51, v51, v167
  v_mul_f32 v52, v52, v172
  s_waitcnt lgkmcnt(0)
  v_and_or_b32 v22, v21, s46, v28
  v_bfe_u32 v21, v21, 24, 5
  v_mad_u32_u24 v23, v21, v31, v30
  v_mfma_f32_32x32x16_bf16 v[176:191], v[100:103], v[108:111], v[176:191]
  v_mul_f32 v53, v53, v173
  v_mul_f32 v54, v54, v174
  v_mul_f32 v55, v55, v175
  v_cvt_pk_bf16_f32 v59, v50, v51
  v_cvt_pk_bf16_f32 v62, v52, v53
  v_cvt_pk_bf16_f32 v63, v54, v55
  s_waitcnt lgkmcnt(3)
  v_or_b32 v56, v40, v41
  v_or_b32 v60, v42, v43
  v_or_b32 v57, v44, v45
  v_or_b32 v61, v46, v47
  v_or_b32 v58, v48, v49
  s_waitcnt vmcnt(4)
  ds_read_b128 v[88:91], v8 offset:0
  ds_read_b128 v[92:95], v9 offset:0
  ds_read_b128 v[96:99], v10 offset:0
  ds_read_b128 v[100:103], v11 offset:0
  v_mov_b32 v80, v84
  v_mov_b32 v81, v85
  v_mov_b32 v82, v86
  v_mov_b32 v83, v87
  v_mfma_f32_32x32x16_bf16 v[224:239], v[56:59], v[64:67], v[224:239]
  v_lshlrev_b32_sdwa v40, 1, v176 dst_sel:DWORD dst_unused:UNUSED_PAD src0_sel:DWORD src1_sel:WORD_1
  ds_read_u16_d16 v40, v40 offset:6400
  v_lshlrev_b32_sdwa v41, 1, v177 dst_sel:DWORD dst_unused:UNUSED_PAD src0_sel:DWORD src1_sel:WORD_1
  ds_read_u16_d16_hi v41, v41 offset:6400
  v_lshlrev_b32_sdwa v42, 1, v184 dst_sel:DWORD dst_unused:UNUSED_PAD src0_sel:DWORD src1_sel:WORD_1
  ds_read_u16_d16 v42, v42 offset:6400
  v_lshlrev_b32_sdwa v43, 1, v185 dst_sel:DWORD dst_unused:UNUSED_PAD src0_sel:DWORD src1_sel:WORD_1
  v_mfma_f32_32x32x16_bf16 v[224:239], v[60:63], v[68:71], v[224:239]
  ds_read_u16_d16_hi v43, v43 offset:6400
  v_lshlrev_b32_sdwa v44, 1, v178 dst_sel:DWORD dst_unused:UNUSED_PAD src0_sel:DWORD src1_sel:WORD_1
  ds_read_u16_d16 v44, v44 offset:6400
  v_lshlrev_b32_sdwa v45, 1, v179 dst_sel:DWORD dst_unused:UNUSED_PAD src0_sel:DWORD src1_sel:WORD_1
  ds_read_u16_d16_hi v45, v45 offset:6400
  v_lshlrev_b32_sdwa v46, 1, v186 dst_sel:DWORD dst_unused:UNUSED_PAD src0_sel:DWORD src1_sel:WORD_1
  ds_read_u16_d16 v46, v46 offset:6400
  s_waitcnt lgkmcnt(7)
  s_add_u32 m0, s41, 0
  s_nop 0
  buffer_load_dwordx4 v12, s[24:27], s39 offen offset:0 sc1 lds
  v_lshlrev_b32_sdwa v47, 1, v187 dst_sel:DWORD dst_unused:UNUSED_PAD src0_sel:DWORD src1_sel:WORD_1
  s_waitcnt lgkmcnt(12)
  v_mfma_f32_32x32x16_bf16 v[160:175], v[80:83], v[112:115], 0
  ds_read_u16_d16_hi v47, v47 offset:6400
  v_lshlrev_b32_sdwa v48, 1, v180 dst_sel:DWORD dst_unused:UNUSED_PAD src0_sel:DWORD src1_sel:WORD_1
  ds_read_u16_d16 v48, v48 offset:6400
  v_lshlrev_b32_sdwa v49, 1, v181 dst_sel:DWORD dst_unused:UNUSED_PAD src0_sel:DWORD src1_sel:WORD_1
  ds_read_u16_d16_hi v49, v49 offset:6400
  buffer_load_dwordx4 v13, s[24:27], s39 offen offset:1024 sc1 lds
  v_exp_f32 v50, v182
  v_mfma_f32_32x32x16_bf16 v[160:175], v[72:75], v[128:131], v[160:175]
  v_exp_f32 v51, v183
  v_exp_f32 v52, v188
  v_exp_f32 v53, v189
  v_exp_f32 v54, v190
  v_exp_f32 v55, v191
  buffer_load_dwordx4 v14, s[24:27], s39 offen offset:2048 sc1 lds
  v_add_f32 v50, 1.0, v50
  v_add_f32 v51, 1.0, v51
  ds_read_b64 v[26:27], v20 offset:0
  v_mfma_f32_32x32x16_bf16 v[160:175], v[76:79], v[132:135], v[160:175]
  v_add_f32 v52, 1.0, v52
  v_add_f32 v53, 1.0, v53
  v_add_f32 v54, 1.0, v54
  v_add_f32 v55, 1.0, v55
  buffer_load_dwordx4 v15, s[24:27], s39 offen offset:3072 sc1 lds
  v_rcp_f32 v50, v50
  v_rcp_f32 v51, v51
  buffer_load_dwordx4 v[84:87], v22, s[12:15], 0 offen
  v_mfma_f32_32x32x16_bf16 v[160:175], v[88:91], v[104:107], v[160:175]
  v_rcp_f32 v52, v52
  v_rcp_f32 v53, v53
  v_rcp_f32 v54, v54
  v_rcp_f32 v55, v55
  v_mul_f32 v50, v50, v182
  v_mul_f32 v51, v51, v183
  v_mul_f32 v52, v52, v188
  v_mfma_f32_32x32x16_bf16 v[160:175], v[92:95], v[108:111], v[160:175]
  v_mul_f32 v53, v53, v189
  v_mul_f32 v54, v54, v190
  s_waitcnt lgkmcnt(0)
  v_add_u32_sdwa v24, v29, v26 dst_sel:DWORD dst_unused:UNUSED_PAD src0_sel:DWORD src1_sel:WORD_0
  v_add_u32_sdwa v25, v29, v26 dst_sel:DWORD dst_unused:UNUSED_PAD src0_sel:DWORD src1_sel:WORD_1
  v_add_u32_sdwa v26, v29, v27 dst_sel:DWORD dst_unused:UNUSED_PAD src0_sel:DWORD src1_sel:WORD_0
  v_add_u32_sdwa v27, v29, v27 dst_sel:DWORD dst_unused:UNUSED_PAD src0_sel:DWORD src1_sel:WORD_1
  v_add_u32 v18, 128, v18
  v_add_u32 v19, 128, v19
  v_add_u32 v20, 64, v20
  v_and_b32 v21, v5, v80
  v_pk_max_u16 v16, v16, v21
  v_and_b32 v21, v5, v81
  v_pk_max_u16 v16, v16, v21
  v_and_b32 v21, v5, v82
  v_pk_max_u16 v16, v16, v21
  v_and_b32 v21, v5, v83
  v_pk_max_u16 v16, v16, v21
  v_mul_f32 v55, v55, v191
  v_cvt_pk_bf16_f32 v59, v50, v51
  v_cvt_pk_bf16_f32 v62, v52, v53
  v_cvt_pk_bf16_f32 v63, v54, v55
  s_waitcnt lgkmcnt(1)
  v_or_b32 v56, v40, v41
  v_or_b32 v60, v42, v43
  v_or_b32 v57, v44, v45
  v_or_b32 v61, v46, v47
  v_or_b32 v58, v48, v49
  s_sub_u32 s42, s42, 1
  s_cmp_lg_u32 s42, 0
  s_cbranch_scc1 V_LOOP
  s_branch V_LOOP_TAIL
  .p2align 6
V_SLOOP:
  s_nop 1
  v_mfma_f32_32x32x16_bf16 v[240:255], v[56:59], v[64:67], v[240:255]
  ds_read_b64_tr_b16 v[64:65], v24
  ds_read_b64_tr_b16 v[66:67], v25
  v_exp_f32 v40, v160
  v_exp_f32 v41, v161
  v_exp_f32 v42, v162
  v_exp_f32 v43, v163
  v_mov_b32 v17, s42
  ds_write2_b32 v2, v17, v17 offset0:0 offset1:8
  v_exp_f32 v44, v164
  v_exp_f32 v45, v165
  v_exp_f32 v46, v166
  v_exp_f32 v47, v167
  v_add_f32 v40, 1.0, v40
  v_mfma_f32_32x32x16_bf16 v[240:255], v[60:63], v[68:71], v[240:255]
  ds_read_b64_tr_b16 v[68:69], v26
  ds_read_b64_tr_b16 v[70:71], v27
  v_add_f32 v41, 1.0, v41
  v_add_f32 v42, 1.0, v42
  v_add_f32 v43, 1.0, v43
  ds_read_b32 v17, v2 offset:16
  v_add_f32 v44, 1.0, v44
  v_add_f32 v45, 1.0, v45
  v_add_f32 v46, 1.0, v46
  v_add_f32 v47, 1.0, v47
  v_rcp_f32 v40, v40
  v_rcp_f32 v41, v41
  v_mfma_f32_32x32x16_bf16 v[176:191], v[80:83], v[116:119], 0
  v_rcp_f32 v42, v42
  v_rcp_f32 v43, v43
  v_rcp_f32 v44, v44
  v_rcp_f32 v45, v45
  v_rcp_f32 v46, v46
  v_rcp_f32 v47, v47
  v_mul_f32 v40, v40, v160
  v_mul_f32 v41, v41, v161
  v_mul_f32 v42, v42, v162
  v_mfma_f32_32x32x16_bf16 v[176:191], v[72:75], v[136:139], v[176:191]
  v_mul_f32 v43, v43, v163
  v_mul_f32 v44, v44, v164
  v_mul_f32 v45, v45, v165
  v_mul_f32 v46, v46, v166
  v_mul_f32 v47, v47, v167
  v_cvt_pk_bf16_f32 v56, v40, v41
  v_cvt_pk_bf16_f32 v57, v42, v43
  v_cvt_pk_bf16_f32 v58, v44, v45
  v_cvt_pk_bf16_f32 v59, v46, v47
  v_mfma_f32_32x32x16_bf16 v[176:191], v[76:79], v[140:143], v[176:191]
  v_exp_f32 v48, v168
  v_exp_f32 v49, v169
  v_exp_f32 v50, v170
  v_exp_f32 v51, v171
  v_exp_f32 v52, v172
  v_exp_f32 v53, v173
  v_exp_f32 v54, v174
  v_exp_f32 v55, v175
  v_add_f32 v48, 1.0, v48
  v_mfma_f32_32x32x16_bf16 v[176:191], v[96:99], v[104:107], v[176:191]
  v_add_f32 v49, 1.0, v49
  v_add_f32 v50, 1.0, v50
  v_add_f32 v51, 1.0, v51
  v_add_f32 v52, 1.0, v52
  v_add_f32 v53, 1.0, v53
  v_add_f32 v54, 1.0, v54
  v_add_f32 v55, 1.0, v55
  v_rcp_f32 v48, v48
  v_rcp_f32 v49, v49
  v_mfma_f32_32x32x16_bf16 v[176:191], v[100:103], v[108:111], v[176:191]
  v_rcp_f32 v50, v50
  v_rcp_f32 v51, v51
  v_rcp_f32 v52, v52
  v_rcp_f32 v53, v53
  v_rcp_f32 v54, v54
  v_rcp_f32 v55, v55
  v_mul_f32 v48, v48, v168
  v_mul_f32 v49, v49, v169
  v_mul_f32 v50, v50, v170
  v_mul_f32 v51, v51, v171
  v_mul_f32 v52, v52, v172
  v_mul_f32 v53, v53, v173
  v_mul_f32 v54, v54, v174
  v_mul_f32 v55, v55, v175
  v_cvt_pk_bf16_f32 v60, v48, v49
  v_cvt_pk_bf16_f32 v61, v50, v51
  v_cvt_pk_bf16_f32 v62, v52, v53
  v_cvt_pk_bf16_f32 v63, v54, v55
  s_waitcnt vmcnt(5)
  ds_read_b128 v[88:91], v8 offset:4096
  ds_read_b128 v[92:95], v9 offset:4096
  ds_read_b128 v[96:99], v10 offset:4096
  ds_read_b128 v[100:103], v11 offset:4096
  s_waitcnt lgkmcnt(5)
  v_mfma_f32_32x32x16_bf16 v[192:207], v[56:59], v[64:67], v[192:207]
  v_exp_f32 v40, v176
  v_exp_f32 v41, v177
  v_exp_f32 v42, v178
  v_exp_f32 v43, v179
  v_exp_f32 v44, v180
  v_exp_f32 v45, v181
  v_exp_f32 v46, v182
  v_exp_f32 v47, v183
  v_add_f32 v40, 1.0, v40
  v_mfma_f32_32x32x16_bf16 v[192:207], v[60:63], v[68:71], v[192:207]
  v_add_f32 v41, 1.0, v41
  v_add_f32 v42, 1.0, v42
  v_add_f32 v43, 1.0, v43
  s_waitcnt lgkmcnt(4)
  v_readfirstlane_b32 s58, v17
  s_nop 3
  s_cmp_gt_u32 s42, s58
  s_cbranch_scc1 PRH_0
  s_setprio 0
  s_branch PRD_0
PRH_0:
  s_setprio 1
PRD_0:
  v_add_f32 v44, 1.0, v44
  v_add_f32 v45, 1.0, v45
  v_add_f32 v46, 1.0, v46
  v_add_f32 v47, 1.0, v47
  s_waitcnt lgkmcnt(0)
  s_add_u32 m0, s41, 4096
  s_nop 0
  buffer_load_dwordx4 v12, s[24:27], s40 offen offset:0 sc1 lds
  v_rcp_f32 v40, v40
  v_rcp_f32 v41, v41
  v_mfma_f32_32x32x16_bf16 v[160:175], v[80:83], v[120:123], 0
  v_rcp_f32 v42, v42
  v_rcp_f32 v43, v43
  v_rcp_f32 v44, v44
  v_rcp_f32 v45, v45
  buffer_load_dwordx4 v13, s[24:27], s40 offen offset:1024 sc1 lds
  v_rcp_f32 v46, v46
  v_rcp_f32 v47, v47
  v_mul_f32 v40, v40, v176
  v_mul_f32 v41, v41, v177
  v_mul_f32 v42, v42, v178
  v_mfma_f32_32x32x16_bf16 v[160:175], v[72:75], v[144:147], v[160:175]
  v_mul_f32 v43, v43, v179
  buffer_load_dwordx4 v14, s[24:27], s40 offen offset:2048 sc1 lds
  v_mul_f32 v44, v44, v180
  v_mul_f32 v45, v45, v181
  v_mul_f32 v46, v46, v182
  v_mul_f32 v47, v47, v183
  v_cvt_pk_bf16_f32 v56, v40, v41
  v_cvt_pk_bf16_f32 v57, v42, v43
  buffer_load_dwordx4 v15, s[24:27], s40 offen offset:3072 sc1 lds
  v_cvt_pk_bf16_f32 v58, v44, v45
  ds_read_b128 v[12:15], v18
  v_cvt_pk_bf16_f32 v59, v46, v47
  v_mfma_f32_32x32x16_bf16 v[160:175], v[76:79], v[148:151], v[160:175]
  v_exp_f32 v48, v184
  v_exp_f32 v49, v185
  v_exp_f32 v50, v186
  v_exp_f32 v51, v187
  v_exp_f32 v52, v188
  v_exp_f32 v53, v189
  v_exp_f32 v54, v190
  v_exp_f32 v55, v191
  v_add_f32 v48, 1.0, v48
  v_mfma_f32_32x32x16_bf16 v[160:175], v[88:91], v[104:107], v[160:175]
  v_add_f32 v49, 1.0, v49
  v_add_f32 v50, 1.0, v50
  v_add_f32 v51, 1.0, v51
  v_add_f32 v52, 1.0, v52
  v_add_f32 v53, 1.0, v53
  v_add_f32 v54, 1.0, v54
  v_add_f32 v55, 1.0, v55
  v_rcp_f32 v48, v48
  v_rcp_f32 v49, v49
  v_mfma_f32_32x32x16_bf16 v[160:175], v[92:95], v[108:111], v[160:175]
  v_rcp_f32 v50, v50
  v_rcp_f32 v51, v51
  v_rcp_f32 v52, v52
  v_rcp_f32 v53, v53
  v_rcp_f32 v54, v54
  v_rcp_f32 v55, v55
  v_mul_f32 v48, v48, v184
  v_mul_f32 v49, v49, v185
  v_mul_f32 v50, v50, v186
  v_mul_f32 v51, v51, v187
  v_mul_f32 v52, v52, v188
  v_mul_f32 v53, v53, v189
  v_mul_f32 v54, v54, v190
  v_mul_f32 v55, v55, v191
  v_cvt_pk_bf16_f32 v60, v48, v49
  v_cvt_pk_bf16_f32 v61, v50, v51
  v_cvt_pk_bf16_f32 v62, v52, v53
  v_cvt_pk_bf16_f32 v63, v54, v55
  s_waitcnt lgkmcnt(0)
  v_add_u32 v12, v12, v36
  v_add_u32 v13, v13, v37
  v_add_u32 v14, v14, v38
  v_add_u32 v15, v15, v39
  v_mfma_f32_32x32x16_bf16 v[208:223], v[56:59], v[64:67], v[208:223]
  v_exp_f32 v40, v160
  v_exp_f32 v41, v161
  v_exp_f32 v42, v162
  v_exp_f32 v43, v163
  v_exp_f32 v44, v164
  v_exp_f32 v45, v165
  v_exp_f32 v46, v166
  v_exp_f32 v47, v167
  v_add_f32 v40, 1.0, v40
  v_mfma_f32_32x32x16_bf16 v[208:223], v[60:63], v[68:71], v[208:223]
  v_add_f32 v41, 1.0, v41
  v_add_f32 v42, 1.0, v42
  v_add_f32 v43, 1.0, v43
  v_add_f32 v44, 1.0, v44
  v_add_f32 v45, 1.0, v45
  v_add_f32 v46, 1.0, v46
  v_add_f32 v47, 1.0, v47
  v_rcp_f32 v40, v40
  v_rcp_f32 v41, v41
  v_mfma_f32_32x32x16_bf16 v[176:191], v[80:83], v[124:127], 0
  v_rcp_f32 v42, v42
  v_rcp_f32 v43, v43
  v_rcp_f32 v44, v44
  v_rcp_f32 v45, v45
  v_rcp_f32 v46, v46
  v_rcp_f32 v47, v47
  v_mul_f32 v40, v40, v160
  v_mul_f32 v41, v41, v161
  v_mul_f32 v42, v42, v162
  v_mfma_f32_32x32x16_bf16 v[176:191], v[72:75], v[152:155], v[176:191]
  v_mul_f32 v43, v43, v163
  v_mul_f32 v44, v44, v164
  v_mul_f32 v45, v45, v165
  v_mul_f32 v46, v46, v166
  v_mul_f32 v47, v47, v167
  v_cvt_pk_bf16_f32 v56, v40, v41
  v_cvt_pk_bf16_f32 v57, v42, v43
  v_cvt_pk_bf16_f32 v58, v44, v45
  v_cvt_pk_bf16_f32 v59, v46, v47
  v_mfma_f32_32x32x16_bf16 v[176:191], v[76:79], v[156:159], v[176:191]
  v_exp_f32 v48, v168
  v_exp_f32 v49, v169
  ds_read_b128 v[72:75], v23
  ds_read_b128 v[76:79], v23 offset:32
  ds_read_b32 v21, v19
  v_exp_f32 v50, v170
  v_exp_f32 v51, v171
  v_exp_f32 v52, v172
  v_exp_f32 v53, v173
  v_exp_f32 v54, v174
  v_exp_f32 v55, v175
  s_waitcnt lgkmcnt(0)
  v_and_or_b32 v22, v21, s46, v28
  v_bfe_u32 v21, v21, 24, 5
  v_mad_u32_u24 v23, v21, v31, v30
  v_add_f32 v48, 1.0, v48
  v_mfma_f32_32x32x16_bf16 v[176:191], v[96:99], v[104:107], v[176:191]
  v_add_f32 v49, 1.0, v49
  v_add_f32 v50, 1.0, v50
  v_add_f32 v51, 1.0, v51
  v_add_f32 v52, 1.0, v52
  v_add_f32 v53, 1.0, v53
  v_add_f32 v54, 1.0, v54
  v_add_f32 v55, 1.0, v55
  v_rcp_f32 v48, v48
  v_rcp_f32 v49, v49
  v_mfma_f32_32x32x16_bf16 v[176:191], v[100:103], v[108:111], v[176:191]
  v_rcp_f32 v50, v50
  v_rcp_f32 v51, v51
  v_rcp_f32 v52, v52
  v_rcp_f32 v53, v53
  v_rcp_f32 v54, v54
  v_rcp_f32 v55, v55
  v_mul_f32 v48, v48, v168
  v_mul_f32 v49, v49, v169
  v_mul_f32 v50, v50, v170
  v_mul_f32 v51, v51, v171
  v_mul_f32 v52, v52, v172
  v_mul_f32 v53, v53, v173
  v_mul_f32 v54, v54, v174
  v_mul_f32 v55, v55, v175
  v_cvt_pk_bf16_f32 v60, v48, v49
  v_cvt_pk_bf16_f32 v61, v50, v51
  v_cvt_pk_bf16_f32 v62, v52, v53
  v_cvt_pk_bf16_f32 v63, v54, v55
  s_waitcnt vmcnt(4)
  ds_read_b128 v[88:91], v8 offset:0
  ds_read_b128 v[92:95], v9 offset:0
  ds_read_b128 v[96:99], v10 offset:0
  ds_read_b128 v[100:103], v11 offset:0
  v_mov_b32 v80, v84
  v_mov_b32 v81, v85
  v_mov_b32 v82, v86
  v_mov_b32 v83, v87
  v_mfma_f32_32x32x16_bf16 v[224:239], v[56:59], v[64:67], v[224:239]
  v_exp_f32 v40, v176
  v_exp_f32 v41, v177
  v_exp_f32 v42, v178
  v_exp_f32 v43, v179
  v_exp_f32 v44, v180
  v_exp_f32 v45, v181
  v_exp_f32 v46, v182
  v_exp_f32 v47, v183
  v_add_f32 v40, 1.0, v40
  v_mfma_f32_32x32x16_bf16 v[224:239], v[60:63], v[68:71], v[224:239]
  v_add_f32 v41, 1.0, v41
  v_add_f32 v42, 1.0, v42
  v_add_f32 v43, 1.0, v43
  v_add_f32 v44, 1.0, v44
  v_add_f32 v45, 1.0, v45
  v_add_f32 v46, 1.0, v46
  v_add_f32 v47, 1.0, v47
  s_waitcnt lgkmcnt(0)
  s_add_u32 m0, s41, 0
  s_nop 0
  buffer_load_dwordx4 v12, s[24:27], s39 offen offset:0 sc1 lds
  v_rcp_f32 v40, v40
  v_rcp_f32 v41, v41
  s_waitcnt lgkmcnt(5)
  v_mfma_f32_32x32x16_bf16 v[160:175], v[80:83], v[112:115], 0
  v_rcp_f32 v42, v42
  v_rcp_f32 v43, v43
  v_rcp_f32 v44, v44
  v_rcp_f32 v45, v45
  buffer_load_dwordx4 v13, s[24:27], s39 offen offset:1024 sc1 lds
  v_rcp_f32 v46, v46
  v_rcp_f32 v47, v47
  v_mul_f32 v40, v40, v176
  v_mul_f32 v41, v41, v177
  ds_read_b64 v[26:27], v20 offset:0
  v_mul_f32 v42, v42, v178
  v_mfma_f32_32x32x16_bf16 v[160:175], v[72:75], v[128:131], v[160:175]
  v_mul_f32 v43, v43, v179
  buffer_load_dwordx4 v14, s[24:27], s39 offen offset:2048 sc1 lds
  v_mul_f32 v44, v44, v180
  v_mul_f32 v45, v45, v181
  v_mul_f32 v46, v46, v182
  v_mul_f32 v47, v47, v183
  v_cvt_pk_bf16_f32 v56, v40, v41
  v_cvt_pk_bf16_f32 v57, v42, v43
  buffer_load_dwordx4 v15, s[24:27], s39 offen offset:3072 sc1 lds
  v_cvt_pk_bf16_f32 v58, v44, v45
  v_cvt_pk_bf16_f32 v59, v46, v47
  buffer_load_dwordx4 v[84:87], v22, s[12:15], 0 offen
  v_mfma_f32_32x32x16_bf16 v[160:175], v[76:79], v[132:135], v[160:175]
  v_exp_f32 v48, v184
  v_exp_f32 v49, v185
  v_exp_f32 v50, v186
  v_exp_f32 v51, v187
  v_exp_f32 v52, v188
  v_exp_f32 v53, v189
  v_exp_f32 v54, v190
  v_exp_f32 v55, v191
  v_add_f32 v48, 1.0, v48
  v_mfma_f32_32x32x16_bf16 v[160:175], v[88:91], v[104:107], v[160:175]
  v_add_f32 v49, 1.0, v49
  v_add_f32 v50, 1.0, v50
  v_add_f32 v51, 1.0, v51
  v_add_f32 v52, 1.0, v52
  v_add_f32 v53, 1.0, v53
  s_waitcnt lgkmcnt(0)
  v_add_u32_sdwa v24, v29, v26 dst_sel:DWORD dst_unused:UNUSED_PAD src0_sel:DWORD src1_sel:WORD_0
  v_add_u32_sdwa v25, v29, v26 dst_sel:DWORD dst_unused:UNUSED_PAD src0_sel:DWORD src1_sel:WORD_1
  v_add_u32_sdwa v26, v29, v27 dst_sel:DWORD dst_unused:UNUSED_PAD src0_sel:DWORD src1_sel:WORD_0
  v_add_u32_sdwa v27, v29, v27 dst_sel:DWORD dst_unused:UNUSED_PAD src0_sel:DWORD src1_sel:WORD_1
  v_add_u32 v18, 128, v18
  v_add_u32 v19, 128, v19
  v_add_u32 v20, 64, v20
  v_add_f32 v54, 1.0, v54
  v_add_f32 v55, 1.0, v55
  v_rcp_f32 v48, v48
  v_rcp_f32 v49, v49
  v_mfma_f32_32x32x16_bf16 v[160:175], v[92:95], v[108:111], v[160:175]
  v_rcp_f32 v50, v50
  v_rcp_f32 v51, v51
  v_rcp_f32 v52, v52
  v_rcp_f32 v53, v53
  v_rcp_f32 v54, v54
  v_rcp_f32 v55, v55
  v_mul_f32 v48, v48, v184
  v_mul_f32 v49, v49, v185
  v_mul_f32 v50, v50, v186
  v_mul_f32 v51, v51, v187
  v_mul_f32 v52, v52, v188
  v_mul_f32 v53, v53, v189
  v_mul_f32 v54, v54, v190
  v_mul_f32 v55, v55, v191
  v_cvt_pk_bf16_f32 v60, v48, v49
  v_cvt_pk_bf16_f32 v61, v50, v51
  v_cvt_pk_bf16_f32 v62, v52, v53
  v_cvt_pk_bf16_f32 v63, v54, v55
  s_sub_u32 s42, s42, 1
  s_cmp_lg_u32 s42, 0
  s_cbranch_scc1 V_SLOOP
V_LOOP_TAIL:
  s_nop 1
  v_mfma_f32_32x32x16_bf16 v[240:255], v[56:59], v[64:67], v[240:255]
  v_mfma_f32_32x32x16_bf16 v[240:255], v[60:63], v[68:71], v[240:255]
V_LOOP_DONE:
  s_setprio 0
  s_waitcnt vmcnt(0) lgkmcnt(0)
  s_add_u32 s43, s43, s44
  s_cmp_lt_u32 s43, 256
  s_cbranch_scc0 V_EPI
  s_barrier
  s_branch V_BATCH
V_EPI:
  s_cmp_lg_u32 s45, 0
  s_cbranch_scc1 V_GOK
  v_lshrrev_b32 v60, 16, v16
  v_and_b32 v61, 0xffff, v16
  v_max_u32 v60, v60, v61
  v_cmp_le_u32 vcc, s99, v60
  s_cmp_eq_u64 vcc, 0
  s_cbranch_scc1 V_GOK
  v_mov_b32 v60, 0
  v_mov_b32 v61, 1
  ds_write_b32 v60, v61 offset:3112
  s_waitcnt lgkmcnt(0)
V_GOK:
  s_and_b32 s50, s3, 3
  s_lshl_b32 s51, s50, 14
  s_add_u32 s51, s51, 0x11a0000
  s_add_u32 s52, s51, 0
  buffer_load_dwordx4 v[64:67], v4, s[28:31], s52 offen offset:0 sc1
  buffer_load_dwordx4 v[68:71], v4, s[28:31], s52 offen offset:1024 sc1
  buffer_load_dwordx4 v[72:75], v4, s[28:31], s52 offen offset:2048 sc1
  buffer_load_dwordx4 v[76:79], v4, s[28:31], s52 offen offset:3072 sc1
  s_add_u32 s52, s51, 4096
  buffer_load_dwordx4 v[80:83], v4, s[28:31], s52 offen offset:0 sc1
  buffer_load_dwordx4 v[84:87], v4, s[28:31], s52 offen offset:1024 sc1
  buffer_load_dwordx4 v[88:91], v4, s[28:31], s52 offen offset:2048 sc1
  buffer_load_dwordx4 v[92:95], v4, s[28:31], s52 offen offset:3072 sc1
  s_add_u32 s52, s51, 8192
  buffer_load_dwordx4 v[96:99], v4, s[28:31], s52 offen offset:0 sc1
  buffer_load_dwordx4 v[100:103], v4, s[28:31], s52 offen offset:1024 sc1
  buffer_load_dwordx4 v[160:163], v4, s[28:31], s52 offen offset:2048 sc1
  buffer_load_dwordx4 v[164:167], v4, s[28:31], s52 offen offset:3072 sc1
  s_add_u32 s52, s51, 12288
  buffer_load_dwordx4 v[168:171], v4, s[28:31], s52 offen offset:0 sc1
  buffer_load_dwordx4 v[172:175], v4, s[28:31], s52 offen offset:1024 sc1
  buffer_load_dwordx4 v[176:179], v4, s[28:31], s52 offen offset:2048 sc1
  buffer_load_dwordx4 v[180:183], v4, s[28:31], s52 offen offset:3072 sc1
  s_mov_b32 s32, s78
  s_mov_b32 s33, s79
  s_mov_b32 s34, 0x100
  s_mov_b32 s35, 0x00020000
  v_lshlrev_b32 v18, 3, v6
  s_lshl_b32 s52, s50, 6
  buffer_load_dwordx2 v[20:21], v18, s[32:35], s52 offen offset:0
  buffer_load_dwordx2 v[22:23], v18, s[32:35], s52 offen offset:16
  buffer_load_dwordx2 v[24:25], v18, s[32:35], s52 offen offset:32
  buffer_load_dwordx2 v[26:27], v18, s[32:35], s52 offen offset:48
  s_mov_b32 s54, 0xbf317218
  s_mov_b32 s55, 0xbf317218
  s_nop 7
  v_pk_mul_f32 v[192:193], v[192:193], s[54:55]
  v_pk_mul_f32 v[194:195], v[194:195], s[54:55]
  v_pk_mul_f32 v[196:197], v[196:197], s[54:55]
  v_pk_mul_f32 v[198:199], v[198:199], s[54:55]
  v_pk_mul_f32 v[200:201], v[200:201], s[54:55]
  v_pk_mul_f32 v[202:203], v[202:203], s[54:55]
  v_pk_mul_f32 v[204:205], v[204:205], s[54:55]
  v_pk_mul_f32 v[206:207], v[206:207], s[54:55]
  v_cvt_pk_bf16_f32 v40, v192, v193
  v_cvt_pk_bf16_f32 v41, v194, v195
  v_cvt_pk_bf16_f32 v42, v196, v197
  v_cvt_pk_bf16_f32 v43, v198, v199
  v_cvt_pk_bf16_f32 v44, v200, v201
  v_cvt_pk_bf16_f32 v45, v202, v203
  v_cvt_pk_bf16_f32 v46, v204, v205
  v_cvt_pk_bf16_f32 v47, v206, v207
  v_pk_mul_f32 v[208:209], v[208:209], s[54:55]
  v_pk_mul_f32 v[210:211], v[210:211], s[54:55]
  v_pk_mul_f32 v[212:213], v[212:213], s[54:55]
  v_pk_mul_f32 v[214:215], v[214:215], s[54:55]
  v_pk_mul_f32 v[216:217], v[216:217], s[54:55]
  v_pk_mul_f32 v[218:219], v[218:219], s[54:55]
  v_pk_mul_f32 v[220:221], v[220:221], s[54:55]
  v_pk_mul_f32 v[222:223], v[222:223], s[54:55]
  v_cvt_pk_bf16_f32 v48, v208, v209
  v_cvt_pk_bf16_f32 v49, v210, v211
  v_cvt_pk_bf16_f32 v50, v212, v213
  v_cvt_pk_bf16_f32 v51, v214, v215
  v_cvt_pk_bf16_f32 v52, v216, v217
  v_cvt_pk_bf16_f32 v53, v218, v219
  v_cvt_pk_bf16_f32 v54, v220, v221
  v_cvt_pk_bf16_f32 v55, v222, v223
  v_pk_mul_f32 v[224:225], v[224:225], s[54:55]
  v_pk_mul_f32 v[226:227], v[226:227], s[54:55]
  v_pk_mul_f32 v[228:229], v[228:229], s[54:55]
  v_pk_mul_f32 v[230:231], v[230:231], s[54:55]
  v_pk_mul_f32 v[232:233], v[232:233], s[54:55]
  v_pk_mul_f32 v[234:235], v[234:235], s[54:55]
  v_pk_mul_f32 v[236:237], v[236:237], s[54:55]
  v_pk_mul_f32 v[238:239], v[238:239], s[54:55]
  v_cvt_pk_bf16_f32 v56, v224, v225
  v_cvt_pk_bf16_f32 v57, v226, v227
  v_cvt_pk_bf16_f32 v58, v228, v229
  v_cvt_pk_bf16_f32 v59, v230, v231
  v_cvt_pk_bf16_f32 v60, v232, v233
  v_cvt_pk_bf16_f32 v61, v234, v235
  v_cvt_pk_bf16_f32 v62, v236, v237
  v_cvt_pk_bf16_f32 v63, v238, v239
  v_pk_mul_f32 v[240:241], v[240:241], s[54:55]
  v_pk_mul_f32 v[242:243], v[242:243], s[54:55]
  v_pk_mul_f32 v[244:245], v[244:245], s[54:55]
  v_pk_mul_f32 v[246:247], v[246:247], s[54:55]
  v_pk_mul_f32 v[248:249], v[248:249], s[54:55]
  v_pk_mul_f32 v[250:251], v[250:251], s[54:55]
  v_pk_mul_f32 v[252:253], v[252:253], s[54:55]
  v_pk_mul_f32 v[254:255], v[254:255], s[54:55]
  v_cvt_pk_bf16_f32 v184, v240, v241
  v_cvt_pk_bf16_f32 v185, v242, v243
  v_cvt_pk_bf16_f32 v186, v244, v245
  v_cvt_pk_bf16_f32 v187, v246, v247
  v_cvt_pk_bf16_f32 v188, v248, v249
  v_cvt_pk_bf16_f32 v189, v250, v251
  v_cvt_pk_bf16_f32 v190, v252, v253
  v_cvt_pk_bf16_f32 v191, v254, v255
  v_add_u32 v19, s41, v4
  ds_write_b128 v19, v[40:43] offset:0
  ds_write_b128 v19, v[44:47] offset:1024
  ds_write_b128 v19, v[48:51] offset:2048
  ds_write_b128 v19, v[52:55] offset:3072
  ds_write_b128 v19, v[56:59] offset:4096
  ds_write_b128 v19, v[60:63] offset:5120
  ds_write_b128 v19, v[184:187] offset:6144
  ds_write_b128 v19, v[188:191] offset:7168
  s_waitcnt lgkmcnt(0)
  s_barrier
  v_mov_b32 v16, 0
  ds_read_b32 v17, v16 offset:3112
  s_waitcnt lgkmcnt(0)
  v_readfirstlane_b32 s53, v17
  s_nop 3
  s_cmp_eq_u32 s53, 0
  s_cbranch_scc1 V_EPI2
  s_cmp_eq_u32 s45, 2
  s_cbranch_scc1 V_EPI2
  s_mov_b32 s45, 2
  s_mov_b32 s43, 0
  s_waitcnt vmcnt(0)
  s_barrier
  s_branch V_REDO
V_EPI2:
  v_mov_b32 v5, v18
  s_lshr_b32 s55, s3, 2
  s_lshl_b32 s56, s55, 1
  s_add_u32 s56, s56, 0
  s_lshl_b32 s57, s56, 14
  s_add_u32 s57, s57, 106496
  v_add_u32 v8, s57, v4
  s_add_u32 s57, s57, 8192
  s_cmp_eq_u32 s56, 3
  s_cselect_b32 s57, 62720, s57
  v_add_u32 v9, s57, v4
  s_lshl_b32 s58, s56, 7
  v_lshlrev_b32 v14, 2, v7
  v_add_u32 v14, s58, v14
  ds_read_b32 v12, v14 offset:2560
  s_lshl_b32 s56, s55, 1
  s_add_u32 s56, s56, 1
  s_lshl_b32 s57, s56, 14
  s_add_u32 s57, s57, 106496
  v_add_u32 v10, s57, v4
  s_add_u32 s57, s57, 8192
  s_cmp_eq_u32 s56, 3
  s_cselect_b32 s57, 62720, s57
  v_add_u32 v11, s57, v4
  s_lshl_b32 s58, s56, 7
  v_lshlrev_b32 v15, 2, v7
  v_add_u32 v15, s58, v15
  ds_read_b32 v13, v15 offset:2560
  ds_read_b128 v[192:195], v8 offset:0
  ds_read_b128 v[104:107], v10 offset:0
  ds_read_b128 v[196:199], v8 offset:1024
  ds_read_b128 v[108:111], v10 offset:1024
  ds_read_b128 v[200:203], v8 offset:2048
  ds_read_b128 v[112:115], v10 offset:2048
  ds_read_b128 v[204:207], v8 offset:3072
  ds_read_b128 v[116:119], v10 offset:3072
  ds_read_b128 v[208:211], v8 offset:4096
  ds_read_b128 v[120:123], v10 offset:4096
  ds_read_b128 v[212:215], v8 offset:5120
  ds_read_b128 v[124:127], v10 offset:5120
  s_waitcnt vmcnt(0)
  s_waitcnt lgkmcnt(10)
  v_mfma_f32_32x32x16_bf16 v[32:47], v[64:67], v[192:195], 0
  v_mfma_f32_32x32x16_bf16 v[48:63], v[64:67], v[104:107], 0
  ds_read_b128 v[216:219], v8 offset:6144
  ds_read_b128 v[128:131], v10 offset:6144
  s_waitcnt lgkmcnt(10)
  v_mfma_f32_32x32x16_bf16 v[32:47], v[68:71], v[196:199], v[32:47]
  v_mfma_f32_32x32x16_bf16 v[48:63], v[68:71], v[108:111], v[48:63]
  ds_read_b128 v[220:223], v8 offset:7168
  ds_read_b128 v[132:135], v10 offset:7168
  s_waitcnt lgkmcnt(10)
  v_mfma_f32_32x32x16_bf16 v[32:47], v[72:75], v[200:203], v[32:47]
  v_mfma_f32_32x32x16_bf16 v[48:63], v[72:75], v[112:115], v[48:63]
  ds_read_b128 v[224:227], v9 offset:0
  ds_read_b128 v[136:139], v11 offset:0
  s_waitcnt lgkmcnt(10)
  v_mfma_f32_32x32x16_bf16 v[32:47], v[76:79], v[204:207], v[32:47]
  v_mfma_f32_32x32x16_bf16 v[48:63], v[76:79], v[116:119], v[48:63]
  ds_read_b128 v[228:231], v9 offset:1024
  ds_read_b128 v[140:143], v11 offset:1024
  s_waitcnt lgkmcnt(10)
  v_mfma_f32_32x32x16_bf16 v[32:47], v[80:83], v[208:211], v[32:47]
  v_mfma_f32_32x32x16_bf16 v[48:63], v[80:83], v[120:123], v[48:63]
  ds_read_b128 v[232:235], v9 offset:2048
  ds_read_b128 v[144:147], v11 offset:2048
  s_waitcnt lgkmcnt(10)
  v_mfma_f32_32x32x16_bf16 v[32:47], v[84:87], v[212:215], v[32:47]
  v_mfma_f32_32x32x16_bf16 v[48:63], v[84:87], v[124:127], v[48:63]
  ds_read_b128 v[236:239], v9 offset:3072
  ds_read_b128 v[148:151], v11 offset:3072
  s_waitcnt lgkmcnt(10)
  v_mfma_f32_32x32x16_bf16 v[32:47], v[88:91], v[216:219], v[32:47]
  v_mfma_f32_32x32x16_bf16 v[48:63], v[88:91], v[128:131], v[48:63]
  ds_read_b128 v[240:243], v9 offset:4096
  ds_read_b128 v[152:155], v11 offset:4096
  s_waitcnt lgkmcnt(10)
  v_mfma_f32_32x32x16_bf16 v[32:47], v[92:95], v[220:223], v[32:47]
  v_mfma_f32_32x32x16_bf16 v[48:63], v[92:95], v[132:135], v[48:63]
  ds_read_b128 v[244:247], v9 offset:5120
  ds_read_b128 v[156:159], v11 offset:5120
  s_waitcnt lgkmcnt(10)
  v_mfma_f32_32x32x16_bf16 v[32:47], v[96:99], v[224:227], v[32:47]
  v_mfma_f32_32x32x16_bf16 v[48:63], v[96:99], v[136:139], v[48:63]
  ds_read_b128 v[248:251], v9 offset:6144
  ds_read_b128 v[184:187], v11 offset:6144
  s_waitcnt lgkmcnt(10)
  v_mfma_f32_32x32x16_bf16 v[32:47], v[100:103], v[228:231], v[32:47]
  v_mfma_f32_32x32x16_bf16 v[48:63], v[100:103], v[140:143], v[48:63]
  ds_read_b128 v[252:255], v9 offset:7168
  ds_read_b128 v[188:191], v11 offset:7168
  s_waitcnt lgkmcnt(10)
  v_mfma_f32_32x32x16_bf16 v[32:47], v[160:163], v[232:235], v[32:47]
  v_mfma_f32_32x32x16_bf16 v[48:63], v[160:163], v[144:147], v[48:63]
  s_waitcnt lgkmcnt(8)
  v_mfma_f32_32x32x16_bf16 v[32:47], v[164:167], v[236:239], v[32:47]
  v_mfma_f32_32x32x16_bf16 v[48:63], v[164:167], v[148:151], v[48:63]
  s_waitcnt lgkmcnt(6)
  v_mfma_f32_32x32x16_bf16 v[32:47], v[168:171], v[240:243], v[32:47]
  v_mfma_f32_32x32x16_bf16 v[48:63], v[168:171], v[152:155], v[48:63]
  s_waitcnt lgkmcnt(4)
  v_mfma_f32_32x32x16_bf16 v[32:47], v[172:175], v[244:247], v[32:47]
  v_mfma_f32_32x32x16_bf16 v[48:63], v[172:175], v[156:159], v[48:63]
  s_waitcnt lgkmcnt(2)
  v_mfma_f32_32x32x16_bf16 v[32:47], v[176:179], v[248:251], v[32:47]
  v_mfma_f32_32x32x16_bf16 v[48:63], v[176:179], v[184:187], v[48:63]
  s_waitcnt lgkmcnt(0)
  v_mfma_f32_32x32x16_bf16 v[32:47], v[180:183], v[252:255], v[32:47]
  v_mfma_f32_32x32x16_bf16 v[48:63], v[180:183], v[188:191], v[48:63]
  s_nop 3
  v_lshlrev_b32 v80, 16, v20
  v_and_b32 v81, 0xffff0000, v20
  v_lshlrev_b32 v82, 16, v21
  v_and_b32 v83, 0xffff0000, v21
  v_lshlrev_b32 v84, 16, v22
  v_and_b32 v85, 0xffff0000, v22
  v_lshlrev_b32 v86, 16, v23
  v_and_b32 v87, 0xffff0000, v23
  v_lshlrev_b32 v88, 16, v24
  v_and_b32 v89, 0xffff0000, v24
  v_lshlrev_b32 v90, 16, v25
  v_and_b32 v91, 0xffff0000, v25
  v_lshlrev_b32 v92, 16, v26
  v_and_b32 v93, 0xffff0000, v26
  v_lshlrev_b32 v94, 16, v27
  v_and_b32 v95, 0xffff0000, v27
  s_and_b32 s50, s3, 3
  s_lshl_b32 s50, s50, 6
  s_lshl_b32 s56, s55, 1
  s_add_u32 s56, s56, 0
  s_mul_i32 s58, s56, 24
  s_min_u32 s57, s56, 1
  s_add_u32 s58, s58, s57
  s_add_u32 s57, s56, 3
  s_and_b32 s57, s57, 3
  s_cmp_lt_u32 s57, 2
  s_cselect_b32 s57, 24, 25
  v_cvt_f32_u32 v12, v12
  v_fma_f32 v32, v12, v80, v32
  v_fma_f32 v33, v12, v81, v33
  v_fma_f32 v34, v12, v82, v34
  v_fma_f32 v35, v12, v83, v35
  v_fma_f32 v36, v12, v84, v36
  v_fma_f32 v37, v12, v85, v37
  v_fma_f32 v38, v12, v86, v38
  v_fma_f32 v39, v12, v87, v39
  v_fma_f32 v40, v12, v88, v40
  v_fma_f32 v41, v12, v89, v41
  v_fma_f32 v42, v12, v90, v42
  v_fma_f32 v43, v12, v91, v43
  v_fma_f32 v44, v12, v92, v44
  v_fma_f32 v45, v12, v93, v45
  v_fma_f32 v46, v12, v94, v46
  v_fma_f32 v47, v12, v95, v47
  v_cvt_pk_bf16_f32 v64, v32, v33
  v_cvt_pk_bf16_f32 v65, v34, v35
  v_cvt_pk_bf16_f32 v66, v36, v37
  v_cvt_pk_bf16_f32 v67, v38, v39
  v_cvt_pk_bf16_f32 v68, v40, v41
  v_cvt_pk_bf16_f32 v69, v42, v43
  v_cvt_pk_bf16_f32 v70, v44, v45
  v_cvt_pk_bf16_f32 v71, v46, v47
  v_add_u32 v14, s58, v7
  v_mul_u32_u24 v14, 272, v14
  v_add3_u32 v14, v14, v5, s50
  v_cmp_gt_u32 vcc, s57, v7
  s_and_saveexec_b64 s[58:59], vcc
  ds_write_b64 v14, v[64:65] offset:6400
  ds_write_b64 v14, v[66:67] offset:6416
  ds_write_b64 v14, v[68:69] offset:6432
  ds_write_b64 v14, v[70:71] offset:6448
  s_mov_b64 exec, s[58:59]
  s_lshl_b32 s56, s55, 1
  s_add_u32 s56, s56, 1
  s_mul_i32 s58, s56, 24
  s_min_u32 s57, s56, 1
  s_add_u32 s58, s58, s57
  s_add_u32 s57, s56, 3
  s_and_b32 s57, s57, 3
  s_cmp_lt_u32 s57, 2
  s_cselect_b32 s57, 24, 25
  v_cvt_f32_u32 v13, v13
  v_fma_f32 v48, v13, v80, v48
  v_fma_f32 v49, v13, v81, v49
  v_fma_f32 v50, v13, v82, v50
  v_fma_f32 v51, v13, v83, v51
  v_fma_f32 v52, v13, v84, v52
  v_fma_f32 v53, v13, v85, v53
  v_fma_f32 v54, v13, v86, v54
  v_fma_f32 v55, v13, v87, v55
  v_fma_f32 v56, v13, v88, v56
  v_fma_f32 v57, v13, v89, v57
  v_fma_f32 v58, v13, v90, v58
  v_fma_f32 v59, v13, v91, v59
  v_fma_f32 v60, v13, v92, v60
  v_fma_f32 v61, v13, v93, v61
  v_fma_f32 v62, v13, v94, v62
  v_fma_f32 v63, v13, v95, v63
  v_cvt_pk_bf16_f32 v72, v48, v49
  v_cvt_pk_bf16_f32 v73, v50, v51
  v_cvt_pk_bf16_f32 v74, v52, v53
  v_cvt_pk_bf16_f32 v75, v54, v55
  v_cvt_pk_bf16_f32 v76, v56, v57
  v_cvt_pk_bf16_f32 v77, v58, v59
  v_cvt_pk_bf16_f32 v78, v60, v61
  v_cvt_pk_bf16_f32 v79, v62, v63
  v_add_u32 v14, s58, v7
  v_mul_u32_u24 v14, 272, v14
  v_add3_u32 v14, v14, v5, s50
  v_cmp_gt_u32 vcc, s57, v7
  s_and_saveexec_b64 s[58:59], vcc
  ds_write_b64 v14, v[72:73] offset:6400
  ds_write_b64 v14, v[74:75] offset:6416
  ds_write_b64 v14, v[76:77] offset:6432
  ds_write_b64 v14, v[78:79] offset:6448
  s_mov_b64 exec, s[58:59]
  s_waitcnt lgkmcnt(0)
  s_barrier
  s_add_u32 s60, s36, 98
  s_min_u32 s60, s60, 25000
  s_lshl_b32 s60, s60, 8
  s_mov_b32 s22, s60
  v_lshrrev_b32 v14, 4, v0
  v_and_b32 v15, 15, v0
  v_lshlrev_b32 v15, 4, v15
  v_mul_u32_u24 v16, 272, v14
  v_add_u32 v16, v16, v15
  v_lshl_add_u32 v17, v14, 8, v15
  s_lshl_b32 s61, s36, 8
  ds_read_b128 v[64:67], v16 offset:6400
  ds_read_b128 v[68:71], v16 offset:15104
  ds_read_b128 v[72:75], v16 offset:23808
  ds_read_b128 v[76:79], v16 offset:32512
  s_waitcnt lgkmcnt(3)
  buffer_store_dwordx4 v[64:67], v17, s[20:23], s61 offen sc1
  s_add_u32 s61, s61, 8192
  s_waitcnt lgkmcnt(2)
  buffer_store_dwordx4 v[68:71], v17, s[20:23], s61 offen sc1
  s_add_u32 s61, s61, 8192
  s_waitcnt lgkmcnt(1)
  buffer_store_dwordx4 v[72:75], v17, s[20:23], s61 offen sc1
  s_add_u32 s61, s61, 8192
  s_waitcnt lgkmcnt(0)
  buffer_store_dwordx4 v[76:79], v17, s[20:23], s61 offen sc1
V_END:
  s_endpgm
  .p2align 8
  .type V_TAB,@object
V_TAB:
  .long 0x3f80, 0x0, 0x0, 0x0, 0x0, 0x0, 0x0, 0x0
  .long 0x0, 0x0, 0x0, 0x0, 0x0, 0x0, 0x0, 0x0
  .long 0x3f800000, 0x0, 0x0, 0x0, 0x0, 0x0, 0x0, 0x0
  .long 0x0, 0x0, 0x0, 0x0, 0x0, 0x0, 0x0, 0x0
  .long 0x0, 0x3f80, 0x0, 0x0, 0x0, 0x0, 0x0, 0x0
  .long 0x0, 0x0, 0x0, 0x0, 0x0, 0x0, 0x0, 0x0
  .long 0x0, 0x3f800000, 0x0, 0x0, 0x0, 0x0, 0x0, 0x0
  .long 0x0, 0x0, 0x0, 0x0, 0x0, 0x0, 0x0, 0x0
  .long 0x0, 0x0, 0x3f80, 0x0, 0x0, 0x0, 0x0, 0x0
  .long 0x0, 0x0, 0x0, 0x0, 0x0, 0x0, 0x0, 0x0
  .long 0x0, 0x0, 0x3f800000, 0x0, 0x0, 0x0, 0x0, 0x0
  .long 0x0, 0x0, 0x0, 0x0, 0x0, 0x0, 0x0, 0x0
  .long 0x0, 0x0, 0x0, 0x3f80, 0x0, 0x0, 0x0, 0x0
  .long 0x0, 0x0, 0x0, 0x0, 0x0, 0x0, 0x0, 0x0
  .long 0x0, 0x0, 0x0, 0x3f800000, 0x0, 0x0, 0x0, 0x0
  .long 0x0, 0x0, 0x0, 0x0, 0x0, 0x0, 0x0, 0x0
  .long 0x0, 0x0, 0x0, 0x0, 0x3f80, 0x0, 0x0, 0x0
  .long 0x0, 0x0, 0x0, 0x0, 0x0, 0x0, 0x0, 0x0
  .long 0x0, 0x0, 0x0, 0x0, 0x3f800000, 0x0, 0x0, 0x0
  .long 0x0, 0x0, 0x0, 0x0, 0x0, 0x0, 0x0, 0x0
  .long 0x0, 0x0, 0x0, 0x0, 0x0, 0x3f80, 0x0, 0x0
  .long 0x0, 0x0, 0x0, 0x0, 0x0, 0x0, 0x0, 0x0
  .long 0x0, 0x0, 0x0, 0x0, 0x0, 0x3f800000, 0x0, 0x0
  .long 0x0, 0x0, 0x0, 0x0, 0x0, 0x0, 0x0, 0x0
  .long 0x0, 0x0, 0x0, 0x0, 0x0, 0x0, 0x3f80, 0x0
  .long 0x0, 0x0, 0x0, 0x0, 0x0, 0x0, 0x0, 0x0
  .long 0x0, 0x0, 0x0, 0x0, 0x0, 0x0, 0x3f800000, 0x0
  .long 0x0, 0x0, 0x0, 0x0, 0x0, 0x0, 0x0, 0x0
  .long 0x0, 0x0, 0x0, 0x0, 0x0, 0x0, 0x0, 0x3f80
  .long 0x0, 0x0, 0x0, 0x0, 0x0, 0x0, 0x0, 0x0
  .long 0x0, 0x0, 0x0, 0x0, 0x0, 0x0, 0x0, 0x3f800000
  .long 0x0, 0x0, 0x0, 0x0, 0x0, 0x0, 0x0, 0x0
  .long 0x0, 0x0, 0x0, 0x0, 0x0, 0x0, 0x0, 0x0
  .long 0x3f80, 0x0, 0x0, 0x0, 0x0, 0x0, 0x0, 0x0
  .long 0x0, 0x0, 0x0, 0x0, 0x0, 0x0, 0x0, 0x0
  .long 0x3f800000, 0x0, 0x0, 0x0, 0x0, 0x0, 0x0, 0x0
  .long 0x0, 0x0, 0x0, 0x0, 0x0, 0x0, 0x0, 0x0
  .long 0x0, 0x3f80, 0x0, 0x0, 0x0, 0x0, 0x0, 0x0
  .long 0x0, 0x0, 0x0, 0x0, 0x0, 0x0, 0x0, 0x0
  .long 0x0, 0x3f800000, 0x0, 0x0, 0x0, 0x0, 0x0, 0x0
  .long 0x0, 0x0, 0x0, 0x0, 0x0, 0x0, 0x0, 0x0
  .long 0x0, 0x0, 0x3f80, 0x0, 0x0, 0x0, 0x0, 0x0
  .long 0x0, 0x0, 0x0, 0x0, 0x0, 0x0, 0x0, 0x0
  .long 0x0, 0x0, 0x3f800000, 0x0, 0x0, 0x0, 0x0, 0x0
  .long 0x0, 0x0, 0x0, 0x0, 0x0, 0x0, 0x0, 0x0
  .long 0x0, 0x0, 0x0, 0x3f80, 0x0, 0x0, 0x0, 0x0
  .long 0x0, 0x0, 0x0, 0x0, 0x0, 0x0, 0x0, 0x0
  .long 0x0, 0x0, 0x0, 0x3f800000, 0x0, 0x0, 0x0, 0x0
  .long 0x0, 0x0, 0x0, 0x0, 0x0, 0x0, 0x0, 0x0
  .long 0x0, 0x0, 0x0, 0x0, 0x3f80, 0x0, 0x0, 0x0
  .long 0x0, 0x0, 0x0, 0x0, 0x0, 0x0, 0x0, 0x0
  .long 0x0, 0x0, 0x0, 0x0, 0x3f800000, 0x0, 0x0, 0x0
  .long 0x0, 0x0, 0x0, 0x0, 0x0, 0x0, 0x0, 0x0
  .long 0x0, 0x0, 0x0, 0x0, 0x0, 0x3f80, 0x0, 0x0
  .long 0x0, 0x0, 0x0, 0x0, 0x0, 0x0, 0x0, 0x0
  .long 0x0, 0x0, 0x0, 0x0, 0x0, 0x3f800000, 0x0, 0x0
  .long 0x0, 0x0, 0x0, 0x0, 0x0, 0x0, 0x0, 0x0
  .long 0x0, 0x0, 0x0, 0x0, 0x0, 0x0, 0x3f80, 0x0
  .long 0x0, 0x0, 0x0, 0x0, 0x0, 0x0, 0x0, 0x0
  .long 0x0, 0x0, 0x0, 0x0, 0x0, 0x0, 0x3f800000, 0x0
  .long 0x0, 0x0, 0x0, 0x0, 0x0, 0x0, 0x0, 0x0
  .long 0x0, 0x0, 0x0, 0x0, 0x0, 0x0, 0x0, 0x3f80
  .long 0x0, 0x0, 0x0, 0x0, 0x0, 0x0, 0x0, 0x0
  .long 0x0, 0x0, 0x0, 0x0, 0x0, 0x0, 0x0, 0x3f800000
  .long 0xa000, 0xc200, 0xe400, 0x0, 0xa000, 0xc210, 0xe400, 0x80
  .long 0xa000, 0xc220, 0xe400, 0x110, 0xa000, 0xc230, 0xe400, 0x190
  .long 0xa000, 0xc240, 0xe408, 0x220, 0xa000, 0xc250, 0xe408, 0x2a0
  .long 0xa000, 0xc260, 0xe408, 0x330, 0xa000, 0xc270, 0xe408, 0x3b0
  .long 0xa010, 0xc204, 0xe410, 0x440, 0xa010, 0xc214, 0xe410, 0x4c0
  .long 0xa010, 0xc224, 0xe410, 0x550, 0xa010, 0xc234, 0xe410, 0x5d0
  .long 0xa010, 0xc244, 0xe418, 0x660, 0xa010, 0xc254, 0xe418, 0x6e0
  .long 0xa010, 0xc264, 0xe418, 0x770, 0xa010, 0xc274, 0xe418, 0x7f0
  .long 0xa020, 0xc208, 0xe400, 0x800, 0xa020, 0xc218, 0xe400, 0x880
  .long 0xa020, 0xc228, 0xe400, 0x910, 0xa020, 0xc238, 0xe400, 0x990
  .long 0xa020, 0xc248, 0xe408, 0xa20, 0xa020, 0xc258, 0xe408, 0xaa0
  .long 0xa020, 0xc268, 0xe408, 0xb30, 0xa020, 0xc278, 0xe408, 0xbb0
  .long 0xa030, 0xc20c, 0xe410, 0xc40, 0xa030, 0xc21c, 0xe410, 0xcc0
  .long 0xa030, 0xc22c, 0xe410, 0xd50, 0xa030, 0xc23c, 0xe410, 0xdd0
  .long 0xa030, 0xc24c, 0xe418, 0xe60, 0xa030, 0xc25c, 0xe418, 0xee0
  .long 0xa030, 0xc26c, 0xe418, 0xf70, 0xa030, 0xc27c, 0xe418, 0xff0
  .long 0xa040, 0xc200, 0xe420, 0x10, 0xa040, 0xc210, 0xe420, 0x90
  .long 0xa040, 0xc220, 0xe420, 0x100, 0xa040, 0xc230, 0xe420, 0x180
  .long 0xa040, 0xc240, 0xe428, 0x230, 0xa040, 0xc250, 0xe428, 0x2b0
  .long 0xa040, 0xc260, 0xe428, 0x320, 0xa040, 0xc270, 0xe428, 0x3a0
  .long 0xa050, 0xc204, 0xe430, 0x450, 0xa050, 0xc214, 0xe430, 0x4d0
  .long 0xa050, 0xc224, 0xe430, 0x540, 0xa050, 0xc234, 0xe430, 0x5c0
  .long 0xa050, 0xc244, 0xe438, 0x670, 0xa050, 0xc254, 0xe438, 0x6f0
  .long 0xa050, 0xc264, 0xe438, 0x760, 0xa050, 0xc274, 0xe438, 0x7e0
  .long 0xa060, 0xc208, 0xe420, 0x810, 0xa060, 0xc218, 0xe420, 0x890
  .long 0xa060, 0xc228, 0xe420, 0x900, 0xa060, 0xc238, 0xe420, 0x980
  .long 0xa060, 0xc248, 0xe428, 0xa30, 0xa060, 0xc258, 0xe428, 0xab0
  .long 0xa060, 0xc268, 0xe428, 0xb20, 0xa060, 0xc278, 0xe428, 0xba0
  .long 0xa070, 0xc20c, 0xe430, 0xc50, 0xa070, 0xc21c, 0xe430, 0xcd0
  .long 0xa070, 0xc22c, 0xe430, 0xd40, 0xa070, 0xc23c, 0xe430, 0xdc0
  .long 0xa070, 0xc24c, 0xe438, 0xe70, 0xa070, 0xc25c, 0xe438, 0xef0
  .long 0xa070, 0xc26c, 0xe438, 0xf60, 0xa070, 0xc27c, 0xe438, 0xfe0
  .long 0x0, 0xd00, 0xd00, 0x50, 0x0, 0xd08, 0xd00, 0x50
  .long 0x0, 0xd10, 0xd00, 0x50, 0x0, 0xd18, 0xd00, 0x50
  .long 0x0, 0xd00, 0xd00, 0x50, 0x0, 0xd08, 0xd00, 0x50
  .long 0x0, 0xd10, 0xd00, 0x50, 0x0, 0xd18, 0xd00, 0x50
  .long 0x0, 0xd00, 0xd00, 0x50, 0x0, 0xd08, 0xd00, 0x50
  .long 0x0, 0xd10, 0xd00, 0x50, 0x0, 0xd18, 0xd00, 0x50
  .long 0x0, 0xd00, 0xd00, 0x50, 0x0, 0xd08, 0xd00, 0x50
  .long 0x0, 0xd10, 0xd00, 0x50, 0x0, 0xd18, 0xd00, 0x50
  .long 0x0, 0xd20, 0xd00, 0x50, 0x0, 0xd28, 0xd00, 0x50
  .long 0x0, 0xd30, 0xd00, 0x50, 0x0, 0xd38, 0xd00, 0x50
  .long 0x0, 0xd20, 0xd00, 0x50, 0x0, 0xd28, 0xd00, 0x50
  .long 0x0, 0xd30, 0xd00, 0x50, 0x0, 0xd38, 0xd00, 0x50
  .long 0x0, 0xd20, 0xd00, 0x50, 0x0, 0xd28, 0xd00, 0x50
  .long 0x0, 0xd30, 0xd00, 0x50, 0x0, 0xd38, 0xd00, 0x50
  .long 0x0, 0xd20, 0xd00, 0x50, 0x0, 0xd28, 0xd00, 0x50
  .long 0x0, 0xd30, 0xd00, 0x50, 0x0, 0xd38, 0xd00, 0x50
  .long 0x10, 0xd00, 0xd10, 0x50, 0x10, 0xd08, 0xd10, 0x50
  .long 0x10, 0xd10, 0xd10, 0x50, 0x10, 0xd18, 0xd10, 0x50
  .long 0x10, 0xd00, 0xd10, 0x50, 0x10, 0xd08, 0xd10, 0x50
  .long 0x10, 0xd10, 0xd10, 0x50, 0x10, 0xd18, 0xd10, 0x50
  .long 0x10, 0xd00, 0xd10, 0x50, 0x10, 0xd08, 0xd10, 0x50
  .long 0x10, 0xd10, 0xd10, 0x50, 0x10, 0xd18, 0xd10, 0x50
  .long 0x10, 0xd00, 0xd10, 0x50, 0x10, 0xd08, 0xd10, 0x50
  .long 0x10, 0xd10, 0xd10, 0x50, 0x10, 0xd18, 0xd10, 0x50
  .long 0x10, 0xd20, 0xd10, 0x50, 0x10, 0xd28, 0xd10, 0x50
  .long 0x10, 0xd30, 0xd10, 0x50, 0x10, 0xd38, 0xd10, 0x50
  .long 0x10, 0xd20, 0xd10, 0x50, 0x10, 0xd28, 0xd10, 0x50
  .long 0x10, 0xd30, 0xd10, 0x50, 0x10, 0xd38, 0xd10, 0x50
  .long 0x10, 0xd20, 0xd10, 0x50, 0x10, 0xd28, 0xd10, 0x50
  .long 0x10, 0xd30, 0xd10, 0x50, 0x10, 0xd38, 0xd10, 0x50
  .long 0x10, 0xd20, 0xd10, 0x50, 0x10, 0xd28, 0xd10, 0x50
  .long 0x10, 0xd30, 0xd10, 0x50, 0x10, 0xd38, 0xd10, 0x50
  .long 0x0, 0x40, 0x7d00, 0x17d00, 0x10, 0x50, 0x7d08, 0x17d20
  .long 0x20, 0x60, 0x7d10, 0x17d40, 0x30, 0x70, 0x7d18, 0x17d60
  .long 0x40, 0x0, 0x7f20, 0x17f00, 0x50, 0x10, 0x7f28, 0x17f20
  .long 0x60, 0x20, 0x7f30, 0x17f40, 0x70, 0x30, 0x7f38, 0x17f60
  .long 0x0, 0x40, 0x8140, 0x18100, 0x10, 0x50, 0x8148, 0x18120
  .long 0x20, 0x60, 0x8150, 0x18140, 0x30, 0x70, 0x8158, 0x18160
  .long 0x40, 0x0, 0x8360, 0x18300, 0x50, 0x10, 0x8368, 0x18320
  .long 0x60, 0x20, 0x8370, 0x18340, 0x70, 0x30, 0x8378, 0x18360
  .long 0x10, 0x50, 0x8d80, 0x17d80, 0x0, 0x40, 0x8d88, 0x17da0
  .long 0x30, 0x70, 0x8d90, 0x17dc0, 0x20, 0x60, 0x8d98, 0x17de0
  .long 0x50, 0x10, 0x8fa0, 0x17f80, 0x40, 0x0, 0x8fa8, 0x17fa0
  .long 0x70, 0x30, 0x8fb0, 0x17fc0, 0x60, 0x20, 0x8fb8, 0x17fe0
  .long 0x10, 0x50, 0x91c0, 0x18180, 0x0, 0x40, 0x91c8, 0x181a0
  .long 0x30, 0x70, 0x91d0, 0x181c0, 0x20, 0x60, 0x91d8, 0x181e0
  .long 0x50, 0x10, 0x93e0, 0x18380, 0x40, 0x0, 0x93e8, 0x183a0
  .long 0x70, 0x30, 0x93f0, 0x183c0, 0x60, 0x20, 0x93f8, 0x183e0
  .long 0x20, 0x60, 0x9d00, 0x18d00, 0x30, 0x70, 0x9d08, 0x18d20
  .long 0x0, 0x40, 0x9d10, 0x18d40, 0x10, 0x50, 0x9d18, 0x18d60
  .long 0x60, 0x20, 0x9f20, 0x18f00, 0x70, 0x30, 0x9f28, 0x18f20
  .long 0x40, 0x0, 0x9f30, 0x18f40, 0x50, 0x10, 0x9f38, 0x18f60
  .long 0x20, 0x60, 0xa140, 0x19100, 0x30, 0x70, 0xa148, 0x19120
  .long 0x0, 0x40, 0xa150, 0x19140, 0x10, 0x50, 0xa158, 0x19160
  .long 0x60, 0x20, 0xa360, 0x19300, 0x70, 0x30, 0xa368, 0x19320
  .long 0x40, 0x0, 0xa370, 0x19340, 0x50, 0x10, 0xa378, 0x19360
  .long 0x30, 0x70, 0xad80, 0x18d80, 0x20, 0x60, 0xad88, 0x18da0
  .long 0x10, 0x50, 0xad90, 0x18dc0, 0x0, 0x40, 0xad98, 0x18de0
  .long 0x70, 0x30, 0xafa0, 0x18f80, 0x60, 0x20, 0xafa8, 0x18fa0
  .long 0x50, 0x10, 0xafb0, 0x18fc0, 0x40, 0x0, 0xafb8, 0x18fe0
  .long 0x30, 0x70, 0xb1c0, 0x19180, 0x20, 0x60, 0xb1c8, 0x191a0
  .long 0x10, 0x50, 0xb1d0, 0x191c0, 0x0, 0x40, 0xb1d8, 0x191e0
  .long 0x70, 0x30, 0xb3e0, 0x19380, 0x60, 0x20, 0xb3e8, 0x193a0
  .long 0x50, 0x10, 0xb3f0, 0x193c0, 0x40, 0x0, 0xb3f8, 0x193e0
  .long 0x1900, 0x0, 0x0, 0x0, 0x1a10, 0x1, 0x2, 0x0
  .long 0x1b20, 0x2, 0x4, 0x0, 0x1c30, 0x3, 0x6, 0x0
  .long 0x1d40, 0x8, 0x20, 0x8, 0x1e50, 0x9, 0x22, 0x8
  .long 0x1f60, 0xa, 0x24, 0x8, 0x2070, 0xb, 0x26, 0x8
  .long 0x2180, 0x4, 0x40, 0x10, 0x2290, 0x5, 0x42, 0x10
  .long 0x23a0, 0x6, 0x44, 0x10, 0x24b0, 0x7, 0x46, 0x10
  .long 0x25c0, 0xc, 0x60, 0x18, 0x26d0, 0xd, 0x62, 0x18
  .long 0x27e0, 0xe, 0x64, 0x18, 0x28f0, 0xf, 0x66, 0x18
  .long 0x1910, 0x10, 0x80, 0x0, 0x1a00, 0x11, 0x82, 0x0
  .long 0x1b30, 0x12, 0x84, 0x0, 0x1c20, 0x13, 0x86, 0x0
  .long 0x1d50, 0x18, 0xa0, 0x8, 0x1e40, 0x19, 0xa2, 0x8
  .long 0x1f70, 0x1a, 0xa4, 0x8, 0x2060, 0x1b, 0xa6, 0x8
  .long 0x2190, 0x14, 0xc0, 0x10, 0x2280, 0x15, 0xc2, 0x10
  .long 0x23b0, 0x16, 0xc4, 0x10, 0x24a0, 0x17, 0xc6, 0x10
  .long 0x25d0, 0x1c, 0xe0, 0x18, 0x26c0, 0x1d, 0xe2, 0x18
  .long 0x27f0, 0x1e, 0xe4, 0x18, 0x28e0, 0x1f, 0xe6, 0x18
  .long 0x1920, 0x0, 0x0, 0x0, 0x1a30, 0x1, 0x2, 0x0
  .long 0x1b00, 0x2, 0x4, 0x0, 0x1c10, 0x3, 0x6, 0x0
  .long 0x1d60, 0x8, 0x20, 0x8, 0x1e70, 0x9, 0x22, 0x8
  .long 0x1f40, 0xa, 0x24, 0x8, 0x2050, 0xb, 0x26, 0x8
  .long 0x21a0, 0x4, 0x40, 0x10, 0x22b0, 0x5, 0x42, 0x10
  .long 0x2380, 0x6, 0x44, 0x10, 0x2490, 0x7, 0x46, 0x10
  .long 0x25e0, 0xc, 0x60, 0x18, 0x26f0, 0xd, 0x62, 0x18
  .long 0x27c0, 0xe, 0x64, 0x18, 0x28d0, 0xf, 0x66, 0x18
  .long 0x1930, 0x10, 0x80, 0x0, 0x1a20, 0x11, 0x82, 0x0
  .long 0x1b10, 0x12, 0x84, 0x0, 0x1c00, 0x13, 0x86, 0x0
  .long 0x1d70, 0x18, 0xa0, 0x8, 0x1e60, 0x19, 0xa2, 0x8
  .long 0x1f50, 0x1a, 0xa4, 0x8, 0x2040, 0x1b, 0xa6, 0x8
  .long 0x21b0, 0x14, 0xc0, 0x10, 0x22a0, 0x15, 0xc2, 0x10
  .long 0x2390, 0x16, 0xc4, 0x10, 0x2480, 0x17, 0xc6, 0x10
  .long 0x25f0, 0x1c, 0xe0, 0x18, 0x26e0, 0x1d, 0xe2, 0x18
  .long 0x27d0, 0x1e, 0xe4, 0x18, 0x28c0, 0x1f, 0xe6, 0x18
  .long 0x3f80, 0x0, 0x0, 0x0, 0x0, 0x0, 0x0, 0x0
  .long 0x0, 0x0, 0x0, 0x0, 0x0, 0x0, 0x0, 0x0
  .long 0x0, 0x0, 0x0, 0x0, 0x3f800000, 0x0, 0x0, 0x0
  .long 0x0, 0x0, 0x0, 0x0, 0x0, 0x0, 0x0, 0x0
  .long 0x0, 0x0, 0x0, 0x0, 0x0, 0x0, 0x0, 0x0
  .long 0x0, 0x3f80, 0x0, 0x0, 0x0, 0x0, 0x0, 0x0
  .long 0x0, 0x0, 0x0, 0x0, 0x0, 0x0, 0x0, 0x0
  .long 0x0, 0x0, 0x0, 0x0, 0x0, 0x3f800000, 0x0, 0x0
  .long 0x0, 0x0, 0x0, 0x0, 0x0, 0x0, 0x0, 0x0
  .long 0x0, 0x0, 0x0, 0x0, 0x0, 0x0, 0x0, 0x0
  .long 0x0, 0x0, 0x3f80, 0x0, 0x0, 0x0, 0x0, 0x0
  .long 0x0, 0x0, 0x0, 0x0, 0x0, 0x0, 0x0, 0x0
  .long 0x0, 0x0, 0x0, 0x0, 0x0, 0x0, 0x3f800000, 0x0
  .long 0x0, 0x0, 0x0, 0x0, 0x0, 0x0, 0x0, 0x0
  .long 0x0, 0x0, 0x0, 0x0, 0x0, 0x0, 0x0, 0x0
  .long 0x0, 0x0, 0x0, 0x3f80, 0x0, 0x0, 0x0, 0x0
  .long 0x0, 0x0, 0x0, 0x0, 0x0, 0x0, 0x0, 0x0
  .long 0x0, 0x0, 0x0, 0x0, 0x0, 0x0, 0x0, 0x3f800000
  .long 0x0, 0x0, 0x0, 0x0, 0x0, 0x0, 0x0, 0x0
  .long 0x0, 0x0, 0x0, 0x0, 0x0, 0x0, 0x0, 0x0
  .long 0x0, 0x0, 0x0, 0x0, 0x3f80, 0x0, 0x0, 0x0
  .long 0x0, 0x0, 0x0, 0x0, 0x0, 0x0, 0x0, 0x0
  .long 0x0, 0x0, 0x0, 0x0, 0x0, 0x0, 0x0, 0x0
  .long 0x3f800000, 0x0, 0x0, 0x0, 0x0, 0x0, 0x0, 0x0
  .long 0x0, 0x0, 0x0, 0x0, 0x0, 0x0, 0x0, 0x0
  .long 0x0, 0x0, 0x0, 0x0, 0x0, 0x3f80, 0x0, 0x0
  .long 0x0, 0x0, 0x0, 0x0, 0x0, 0x0, 0x0, 0x0
  .long 0x0, 0x0, 0x0, 0x0, 0x0, 0x0, 0x0, 0x0
  .long 0x0, 0x3f800000, 0x0, 0x0, 0x0, 0x0, 0x0, 0x0
  .long 0x0, 0x0, 0x0, 0x0, 0x0, 0x0, 0x0, 0x0
  .long 0x0, 0x0, 0x0, 0x0, 0x0, 0x0, 0x3f80, 0x0
  .long 0x0, 0x0, 0x0, 0x0, 0x0, 0x0, 0x0, 0x0
  .long 0x0, 0x0, 0x0, 0x0, 0x0, 0x0, 0x0, 0x0
  .long 0x0, 0x0, 0x3f800000, 0x0, 0x0, 0x0, 0x0, 0x0
  .long 0x0, 0x0, 0x0, 0x0, 0x0, 0x0, 0x0, 0x0
  .long 0x0, 0x0, 0x0, 0x0, 0x0, 0x0, 0x0, 0x3f80
  .long 0x0, 0x0, 0x0, 0x0, 0x0, 0x0, 0x0, 0x0
  .long 0x0, 0x0, 0x0, 0x0, 0x0, 0x0, 0x0, 0x0
  .long 0x0, 0x0, 0x0, 0x3f800000, 0x0, 0x0, 0x0, 0x0
  .long 0x0, 0x0, 0x0, 0x0, 0x0, 0x0, 0x0, 0x0
  .long 0x0, 0x0, 0x0, 0x0, 0x0, 0x0, 0x0, 0x0
  .long 0x3f80, 0x0, 0x0, 0x0, 0x0, 0x0, 0x0, 0x0
  .long 0x0, 0x0, 0x0, 0x0, 0x0, 0x0, 0x0, 0x0
  .long 0x0, 0x0, 0x0, 0x0, 0x3f800000, 0x0, 0x0, 0x0
  .long 0x0, 0x0, 0x0, 0x0, 0x0, 0x0, 0x0, 0x0
  .long 0x0, 0x0, 0x0, 0x0, 0x0, 0x0, 0x0, 0x0
  .long 0x0, 0x3f80, 0x0, 0x0, 0x0, 0x0, 0x0, 0x0
  .long 0x0, 0x0, 0x0, 0x0, 0x0, 0x0, 0x0, 0x0
  .long 0x0, 0x0, 0x0, 0x0, 0x0, 0x3f800000, 0x0, 0x0
  .long 0x0, 0x0, 0x0, 0x0, 0x0, 0x0, 0x0, 0x0
  .long 0x0, 0x0, 0x0, 0x0, 0x0, 0x0, 0x0, 0x0
  .long 0x0, 0x0, 0x3f80, 0x0, 0x0, 0x0, 0x0, 0x0
  .long 0x0, 0x0, 0x0, 0x0, 0x0, 0x0, 0x0, 0x0
  .long 0x0, 0x0, 0x0, 0x0, 0x0, 0x0, 0x3f800000, 0x0
  .long 0x0, 0x0, 0x0, 0x0, 0x0, 0x0, 0x0, 0x0
  .long 0x0, 0x0, 0x0, 0x0, 0x0, 0x0, 0x0, 0x0
  .long 0x0, 0x0, 0x0, 0x3f80, 0x0, 0x0, 0x0, 0x0
  .long 0x0, 0x0, 0x0, 0x0, 0x0, 0x0, 0x0, 0x0
  .long 0x0, 0x0, 0x0, 0x0, 0x0, 0x0, 0x0, 0x3f800000
  .long 0x0, 0x0, 0x0, 0x0, 0x0, 0x0, 0x0, 0x0
  .long 0x0, 0x0, 0x0, 0x0, 0x0, 0x0, 0x0, 0x0
  .long 0x0, 0x0, 0x0, 0x0, 0x3f80, 0x0, 0x0, 0x0
  .long 0x0, 0x0, 0x0, 0x0, 0x0, 0x0, 0x0, 0x0
  .long 0x0, 0x0, 0x0, 0x0, 0x0, 0x0, 0x0, 0x0
  .long 0x3f800000, 0x0, 0x0, 0x0, 0x0, 0x0, 0x0, 0x0
  .long 0x0, 0x0, 0x0, 0x0, 0x0, 0x0, 0x0, 0x0
  .long 0x0, 0x0, 0x0, 0x0, 0x0, 0x3f80, 0x0, 0x0
  .long 0x0, 0x0, 0x0, 0x0, 0x0, 0x0, 0x0, 0x0
  .long 0x0, 0x0, 0x0, 0x0, 0x0, 0x0, 0x0, 0x0
  .long 0x0, 0x3f800000, 0x0, 0x0, 0x0, 0x0, 0x0, 0x0
  .long 0x0, 0x0, 0x0, 0x0, 0x0, 0x0, 0x0, 0x0
  .long 0x0, 0x0, 0x0, 0x0, 0x0, 0x0, 0x3f80, 0x0
  .long 0x0, 0x0, 0x0, 0x0, 0x0, 0x0, 0x0, 0x0
  .long 0x0, 0x0, 0x0, 0x0, 0x0, 0x0, 0x0, 0x0
  .long 0x0, 0x0, 0x3f800000, 0x0, 0x0, 0x0, 0x0, 0x0
  .long 0x0, 0x0, 0x0, 0x0, 0x0, 0x0, 0x0, 0x0
  .long 0x0, 0x0, 0x0, 0x0, 0x0, 0x0, 0x0, 0x3f80
  .long 0x0, 0x0, 0x0, 0x0, 0x0, 0x0, 0x0, 0x0
  .long 0x0, 0x0, 0x0, 0x0, 0x0, 0x0, 0x0, 0x0
  .long 0x0, 0x0, 0x0, 0x0, 0x0, 0x0, 0x0, 0x0
  .long 0x0, 0x0, 0x0, 0x0, 0x0, 0x0, 0x0, 0x0
  .long 0x0, 0x0, 0x0, 0x0, 0x0, 0x0, 0x0, 0x0
  .long 0x0, 0x0, 0x0, 0x0, 0x0, 0x0, 0x0, 0x0
  .long 0x0, 0x0, 0x0, 0x0, 0x0, 0x0, 0x0, 0x0
  .long 0x0, 0x0, 0x0, 0x0, 0x0, 0x0, 0x0, 0x0
  .long 0x0, 0x0, 0x0, 0x0, 0x0, 0x0, 0x0, 0x0
  .long 0x0, 0x0, 0x0, 0x0, 0x0, 0x0, 0x0, 0x0
  .long 0x0, 0x0, 0x0, 0x0, 0x0, 0x0, 0x0, 0x0
  .long 0x0, 0x0, 0x0, 0x0, 0x0, 0x0, 0x0, 0x0
  .long 0x0, 0x0, 0x0, 0x0, 0x0, 0x0, 0x0, 0x0
  .long 0x0, 0x0, 0x0, 0x0, 0x0, 0x0, 0x0, 0x0
  .long 0x0, 0x0, 0x0, 0x0, 0x0, 0x0, 0x0, 0x0
  .long 0x0, 0x0, 0x0, 0x0, 0x0, 0x0, 0x0, 0x0
  .long 0x0, 0x0, 0x0, 0x0, 0x0, 0x0, 0x0, 0x0
  .long 0x0, 0x0, 0x0, 0x0, 0x0, 0x0, 0x0, 0x0
  .long 0x0, 0x0, 0x0, 0x0, 0x0, 0x0, 0x0, 0x0
  .long 0x10000, 0x20001, 0x30002, 0x40003, 0x50004, 0x60005, 0x70006, 0x80007
  .long 0x90008, 0xa0009, 0xb000a, 0xc000b, 0xd000c, 0xe000d, 0xf000e, 0x10000f
  .long 0x110010, 0x120011, 0x130012, 0x140013, 0x150014, 0x160015, 0x170016, 0x180017
  .long 0x190018, 0x1a0019, 0x1b001a, 0x1c001b, 0x1d001c, 0x1e001d, 0x1f001e, 0x20001f
  .long 0x210020, 0x220021, 0x230022, 0x240023, 0x250024, 0x260025, 0x270026, 0x280027
  .long 0x290028, 0x2a0029, 0x2b002a, 0x2c002b, 0x2d002c, 0x2e002d, 0x2f002e, 0x30002f
  .long 0x310030, 0x320031, 0x330032, 0x340033, 0x350034, 0x360035, 0x370036, 0x380037
  .long 0x390038, 0x3a0039, 0x3b003a, 0x3c003b, 0x3d003c, 0x3e003d, 0x3f003e, 0x40003f
  .long 0x410040, 0x420041, 0x430042, 0x440043, 0x450044, 0x460045, 0x470046, 0x480047
  .long 0x490048, 0x4a0049, 0x4b004a, 0x4c004b, 0x4d004c, 0x4e004d, 0x4f004e, 0x50004f
  .long 0x510050, 0x520051, 0x530052, 0x540053, 0x550054, 0x560055, 0x570056, 0x580057
  .long 0x590058, 0x5a0059, 0x5b005a, 0x5c005b, 0x5d005c, 0x5e005d, 0x5f005e, 0x60005f
  .long 0x610060, 0x620061, 0x630062, 0x640063, 0x650064, 0x660065, 0x670066, 0x680067
  .long 0x690068, 0x6a0069, 0x6b006a, 0x6c006b, 0x6d006c, 0x6e006d, 0x6f006e, 0x70006f
  .long 0x710070, 0x720071, 0x730072, 0x740073, 0x750074, 0x760075, 0x770076, 0x780077
  .long 0x790078, 0x7a0079, 0x7b007a, 0x7c007b, 0x7d007c, 0x7e007d, 0x7f007e, 0x80007f
  .long 0x820080, 0x840082, 0x860084, 0x880086, 0x8a0088, 0x8c008a, 0x8e008c, 0x90008e
  .long 0x920090, 0x940092, 0x960094, 0x980096, 0x9a0098, 0x9c009a, 0x9e009c, 0xa0009e
  .long 0xa200a0, 0xa400a2, 0xa600a4, 0xa800a6, 0xaa00a8, 0xac00aa, 0xae00ac, 0xb000ae
  .long 0xb200b0, 0xb400b2, 0xb600b4, 0xb800b6, 0xba00b8, 0xbc00ba, 0xbe00bc, 0xc000be
  .long 0xc200c0, 0xc400c2, 0xc600c4, 0xc800c6, 0xca00c8, 0xcc00ca, 0xce00cc, 0xd000ce
  .long 0xd200d0, 0xd400d2, 0xd600d4, 0xd800d6, 0xda00d8, 0xdc00da, 0xde00dc, 0xe000de
  .long 0xe200e0, 0xe400e2, 0xe600e4, 0xe800e6, 0xea00e8, 0xec00ea, 0xee00ec, 0xf000ee
  .long 0xf200f0, 0xf400f2, 0xf600f4, 0xf800f6, 0xfa00f8, 0xfc00fa, 0xfe00fc, 0x10000fe
  .long 0x1020100, 0x1040102, 0x1060104, 0x1080106, 0x10a0108, 0x10c010a, 0x10e010c, 0x110010e
  .long 0x1120110, 0x1140112, 0x1160114, 0x1180116, 0x11a0118, 0x11c011a, 0x11e011c, 0x120011e
  .long 0x1220120, 0x1240122, 0x1260124, 0x1280126, 0x12a0128, 0x12c012a, 0x12e012c, 0x130012e
  .long 0x1320130, 0x1340132, 0x1360134, 0x1380136, 0x13a0138, 0x13c013a, 0x13e013c, 0x140013e
  .long 0x1420140, 0x1440142, 0x1460144, 0x1480146, 0x14a0148, 0x14c014a, 0x14e014c, 0x150014e
  .long 0x1520150, 0x1540152, 0x1560154, 0x1580156, 0x15a0158, 0x15c015a, 0x15e015c, 0x160015e
  .long 0x1620160, 0x1640162, 0x1660164, 0x1680166, 0x16a0168, 0x16c016a, 0x16e016c, 0x170016e
  .long 0x1720170, 0x1740172, 0x1760174, 0x1780176, 0x17a0178, 0x17c017a, 0x17e017c, 0x180017e
  .long 0x1820180, 0x1840182, 0x1860184, 0x1880186, 0x18a0188, 0x18c018a, 0x18e018c, 0x190018e
  .long 0x1920190, 0x1940192, 0x1960194, 0x1980196, 0x19a0198, 0x19c019a, 0x19e019c, 0x1a0019e
  .long 0x1a201a0, 0x1a401a2, 0x1a601a4, 0x1a801a6, 0x1aa01a8, 0x1ac01aa, 0x1ae01ac, 0x1b001ae
  .long 0x1b201b0, 0x1b401b2, 0x1b601b4, 0x1b801b6, 0x1ba01b8, 0x1bc01ba, 0x1be01bc, 0x1c001be
  .long 0x1c201c0, 0x1c401c2, 0x1c601c4, 0x1c801c6, 0x1ca01c8, 0x1cc01ca, 0x1ce01cc, 0x1d001ce
  .long 0x1d201d0, 0x1d401d2, 0x1d601d4, 0x1d801d6, 0x1da01d8, 0x1dc01da, 0x1de01dc, 0x1e001de
  .long 0x1e201e0, 0x1e401e2, 0x1e601e4, 0x1e801e6, 0x1ea01e8, 0x1ec01ea, 0x1ee01ec, 0x1f001ee
  .long 0x1f201f0, 0x1f401f2, 0x1f601f4, 0x1f801f6, 0x1fa01f8, 0x1fc01fa, 0x1fe01fc, 0x20001fe
  .long 0x2020200, 0x2040202, 0x2060204, 0x2080206, 0x20a0208, 0x20c020a, 0x20e020c, 0x210020e
  .long 0x2120210, 0x2140212, 0x2160214, 0x2180216, 0x21a0218, 0x21c021a, 0x21e021c, 0x220021e
  .long 0x2220220, 0x2240222, 0x2260224, 0x2280226, 0x22a0228, 0x22c022a, 0x22e022c, 0x230022e
  .long 0x2320230, 0x2340232, 0x2360234, 0x2380236, 0x23a0238, 0x23c023a, 0x23e023c, 0x240023e
  .long 0x2420240, 0x2440242, 0x2460244, 0x2480246, 0x24a0248, 0x24c024a, 0x24e024c, 0x250024e
  .long 0x2520250, 0x2540252, 0x2560254, 0x2580256, 0x25a0258, 0x25c025a, 0x25e025c, 0x260025e
  .long 0x2620260, 0x2640262, 0x2660264, 0x2680266, 0x26a0268, 0x26c026a, 0x26e026c, 0x270026e
  .long 0x2720270, 0x2740272, 0x2760274, 0x2780276, 0x27a0278, 0x27c027a, 0x27e027c, 0x280027e
  .long 0x2820280, 0x2840282, 0x2860284, 0x2880286, 0x28a0288, 0x28c028a, 0x28e028c, 0x290028e
  .long 0x2920290, 0x2940292, 0x2960294, 0x2980296, 0x29a0298, 0x29c029a, 0x29e029c, 0x2a0029e
  .long 0x2a202a0, 0x2a402a2, 0x2a602a4, 0x2a802a6, 0x2aa02a8, 0x2ac02aa, 0x2ae02ac, 0x2b002ae
  .long 0x2b202b0, 0x2b402b2, 0x2b602b4, 0x2b802b6, 0x2ba02b8, 0x2bc02ba, 0x2be02bc, 0x2c002be
  .long 0x2c202c0, 0x2c402c2, 0x2c602c4, 0x2c802c6, 0x2ca02c8, 0x2cc02ca, 0x2ce02cc, 0x2d002ce
  .long 0x2d202d0, 0x2d402d2, 0x2d602d4, 0x2d802d6, 0x2da02d8, 0x2dc02da, 0x2de02dc, 0x2e002de
  .long 0x2e202e0, 0x2e402e2, 0x2e602e4, 0x2e802e6, 0x2ea02e8, 0x2ec02ea, 0x2ee02ec, 0x2f002ee
  .long 0x2f202f0, 0x2f402f2, 0x2f602f4, 0x2f802f6, 0x2fa02f8, 0x2fc02fa, 0x2fe02fc, 0x30002fe
  .long 0x3020300, 0x3040302, 0x3060304, 0x3080306, 0x30a0308, 0x30c030a, 0x30e030c, 0x310030e
  .long 0x3120310, 0x3140312, 0x3160314, 0x3180316, 0x31a0318, 0x31c031a, 0x31e031c, 0x320031e
  .long 0x3220320, 0x3240322, 0x3260324, 0x3280326, 0x32a0328, 0x32c032a, 0x32e032c, 0x330032e
  .long 0x3320330, 0x3340332, 0x3360334, 0x3380336, 0x33a0338, 0x33c033a, 0x33e033c, 0x340033e
  .long 0x3420340, 0x3440342, 0x3460344, 0x3480346, 0x34a0348, 0x34c034a, 0x34e034c, 0x350034e
  .long 0x3520350, 0x3540352, 0x3560354, 0x3580356, 0x35a0358, 0x35c035a, 0x35e035c, 0x360035e
  .long 0x3620360, 0x3640362, 0x3660364, 0x3680366, 0x36a0368, 0x36c036a, 0x36e036c, 0x370036e
  .long 0x3720370, 0x3740372, 0x3760374, 0x3780376, 0x37a0378, 0x37c037a, 0x37e037c, 0x380037e
  .long 0x3820380, 0x3840382, 0x3860384, 0x3880386, 0x38a0388, 0x38c038a, 0x38e038c, 0x390038e
  .long 0x3920390, 0x3940392, 0x3960394, 0x3980396, 0x39a0398, 0x39c039a, 0x39e039c, 0x3a0039e
  .long 0x3a203a0, 0x3a403a2, 0x3a603a4, 0x3a803a6, 0x3aa03a8, 0x3ac03aa, 0x3ae03ac, 0x3b003ae
  .long 0x3b203b0, 0x3b403b2, 0x3b603b4, 0x3b803b6, 0x3ba03b8, 0x3bc03ba, 0x3be03bc, 0x3c003be
  .long 0x3c203c0, 0x3c403c2, 0x3c603c4, 0x3c803c6, 0x3ca03c8, 0x3cc03ca, 0x3ce03cc, 0x3d003ce
  .long 0x3d203d0, 0x3d403d2, 0x3d603d4, 0x3d803d6, 0x3da03d8, 0x3dc03da, 0x3de03dc, 0x3e003de
  .long 0x3e203e0, 0x3e403e2, 0x3e603e4, 0x3e803e6, 0x3ea03e8, 0x3ec03ea, 0x3ee03ec, 0x3f003ee
  .long 0x3f203f0, 0x3f403f2, 0x3f603f4, 0x3f803f6, 0x3fa03f8, 0x3fc03fa, 0x3fe03fc, 0x40003fe
  .long 0x4020400, 0x4040402, 0x4060404, 0x4080406, 0x40a0408, 0x40c040a, 0x40e040c, 0x410040e
  .long 0x4120410, 0x4140412, 0x4160414, 0x4180416, 0x41a0418, 0x41c041a, 0x41e041c, 0x420041e
  .long 0x4220420, 0x4240422, 0x4260424, 0x4280426, 0x42a0428, 0x42c042a, 0x42e042c, 0x430042e
  .long 0x4320430, 0x4340432, 0x4360434, 0x4380436, 0x43a0438, 0x43c043a, 0x43e043c, 0x440043e
  .long 0x4420440, 0x4440442, 0x4460444, 0x4480446, 0x44a0448, 0x44c044a, 0x44e044c, 0x450044e
  .long 0x4520450, 0x4540452, 0x4560454, 0x4580456, 0x45a0458, 0x45c045a, 0x45e045c, 0x460045e
  .long 0x4620460, 0x4640462, 0x4660464, 0x4680466, 0x46a0468, 0x46c046a, 0x46e046c, 0x470046e
  .long 0x4720470, 0x4740472, 0x4760474, 0x4780476, 0x47a0478, 0x47c047a, 0x47e047c, 0x480047e
  .long 0x4820480, 0x4840482, 0x4860484, 0x4880486, 0x48a0488, 0x48c048a, 0x48e048c, 0x490048e
  .long 0x4920490, 0x4940492, 0x4960494, 0x4980496, 0x49a0498, 0x49c049a, 0x49e049c, 0x4a0049e
  .long 0x4a204a0, 0x4a404a2, 0x4a604a4, 0x4a804a6, 0x4aa04a8, 0x4ac04aa, 0x4ae04ac, 0x4b004ae
  .long 0x4b204b0, 0x4b404b2, 0x4b604b4, 0x4b804b6, 0x4ba04b8, 0x4bc04ba, 0x4be04bc, 0x4c004be
  .long 0x4c204c0, 0x4c404c2, 0x4c604c4, 0x4c804c6, 0x4ca04c8, 0x4cc04ca, 0x4ce04cc, 0x4d004ce
  .long 0x4d204d0, 0x4d404d2, 0x4d604d4, 0x4d804d6, 0x4da04d8, 0x4dc04da, 0x4de04dc, 0x4e004de
  .long 0x4e204e0, 0x4e404e2, 0x4e604e4, 0x4e804e6, 0x4ea04e8, 0x4ec04ea, 0x4ee04ec, 0x4f004ee
  .long 0x4f204f0, 0x4f404f2, 0x4f604f4, 0x4f804f6, 0x4fa04f8, 0x4fc04fa, 0x4fe04fc, 0x50004fe
  .long 0x5020500, 0x5040502, 0x5060504, 0x5080506, 0x50a0508, 0x50c050a, 0x50e050c, 0x510050e
  .long 0x5120510, 0x5140512, 0x5160514, 0x5180516, 0x51a0518, 0x51c051a, 0x51e051c, 0x520051e
  .long 0x5220520, 0x5240522, 0x5260524, 0x5280526, 0x52a0528, 0x52c052a, 0x52e052c, 0x530052e
  .long 0x5320530, 0x5340532, 0x5360534, 0x5380536, 0x53a0538, 0x53c053a, 0x53e053c, 0x540053e
  .long 0x5420540, 0x5440542, 0x5460544, 0x5480546, 0x54a0548, 0x54c054a, 0x54e054c, 0x550054e
  .long 0x5520550, 0x5540552, 0x5560554, 0x5580556, 0x55a0558, 0x55c055a, 0x55e055c, 0x560055e
  .long 0x5620560, 0x5640562, 0x5660564, 0x5680566, 0x56a0568, 0x56c056a, 0x56e056c, 0x570056e
  .long 0x5720570, 0x5740572, 0x5760574, 0x5780576, 0x57a0578, 0x57c057a, 0x57e057c, 0x580057e
  .long 0x5820580, 0x5840582, 0x5860584, 0x5880586, 0x58a0588, 0x58c058a, 0x58e058c, 0x590058e
  .long 0x5920590, 0x5940592, 0x5960594, 0x5980596, 0x59a0598, 0x59c059a, 0x59e059c, 0x5a0059e
  .long 0x5a205a0, 0x5a405a2, 0x5a605a4, 0x5a805a6, 0x5aa05a8, 0x5ac05aa, 0x5ae05ac, 0x5b005ae
  .long 0x5b205b0, 0x5b405b2, 0x5b605b4, 0x5b805b6, 0x5ba05b8, 0x5bc05ba, 0x5be05bc, 0x5c005be
  .long 0x5c205c0, 0x5c405c2, 0x5c605c4, 0x5c805c6, 0x5ca05c8, 0x5cc05ca, 0x5ce05cc, 0x5d005ce
  .long 0x5d205d0, 0x5d405d2, 0x5d605d4, 0x5d805d6, 0x5da05d8, 0x5dc05da, 0x5de05dc, 0x5e005de
  .long 0x5e205e0, 0x5e405e2, 0x5e605e4, 0x5e805e6, 0x5ea05e8, 0x5ec05ea, 0x5ee05ec, 0x5f005ee
  .long 0x5f205f0, 0x5f405f2, 0x5f605f4, 0x5f805f6, 0x5fa05f8, 0x5fc05fa, 0x5fe05fc, 0x60005fe
  .long 0x6020600, 0x6040602, 0x6060604, 0x6080606, 0x60a0608, 0x60c060a, 0x60e060c, 0x610060e
  .long 0x6120610, 0x6140612, 0x6160614, 0x6180616, 0x61a0618, 0x61c061a, 0x61e061c, 0x620061e
  .long 0x6220620, 0x6240622, 0x6260624, 0x6280626, 0x62a0628, 0x62c062a, 0x62e062c, 0x630062e
  .long 0x6320630, 0x6340632, 0x6360634, 0x6380636, 0x63a0638, 0x63c063a, 0x63e063c, 0x640063e
  .long 0x6420640, 0x6440642, 0x6460644, 0x6480646, 0x64a0648, 0x64c064a, 0x64e064c, 0x650064e
  .long 0x6520650, 0x6540652, 0x6560654, 0x6580656, 0x65a0658, 0x65c065a, 0x65e065c, 0x660065e
  .long 0x6620660, 0x6640662, 0x6660664, 0x6680666, 0x66a0668, 0x66c066a, 0x66e066c, 0x670066e
  .long 0x6720670, 0x6740672, 0x6760674, 0x6780676, 0x67a0678, 0x67c067a, 0x67e067c, 0x680067e
  .long 0x6820680, 0x6840682, 0x6860684, 0x6880686, 0x68a0688, 0x68c068a, 0x68e068c, 0x690068e
  .long 0x6920690, 0x6940692, 0x6960694, 0x6980696, 0x69a0698, 0x69c069a, 0x69e069c, 0x6a0069e
  .long 0x6a206a0, 0x6a406a2, 0x6a606a4, 0x6a806a6, 0x6aa06a8, 0x6ac06aa, 0x6ae06ac, 0x6b006ae
  .long 0x6b206b0, 0x6b406b2, 0x6b606b4, 0x6b806b6, 0x6ba06b8, 0x6bc06ba, 0x6be06bc, 0x6c006be
  .long 0x6c206c0, 0x6c406c2, 0x6c606c4, 0x6c806c6, 0x6ca06c8, 0x6cc06ca, 0x6ce06cc, 0x6d006ce
  .long 0x6d206d0, 0x6d406d2, 0x6d606d4, 0x6d806d6, 0x6da06d8, 0x6dc06da, 0x6de06dc, 0x6e006de
  .long 0x6e206e0, 0x6e406e2, 0x6e606e4, 0x6e806e6, 0x6ea06e8, 0x6ec06ea, 0x6ee06ec, 0x6f006ee
  .long 0x6f206f0, 0x6f406f2, 0x6f606f4, 0x6f806f6, 0x6fa06f8, 0x6fc06fa, 0x6fe06fc, 0x70006fe
  .long 0x7020700, 0x7040702, 0x7060704, 0x7080706, 0x70a0708, 0x70c070a, 0x70e070c, 0x710070e
  .long 0x7120710, 0x7140712, 0x7160714, 0x7180716, 0x71a0718, 0x71c071a, 0x71e071c, 0x720071e
  .long 0x7220720, 0x7240722, 0x7260724, 0x7280726, 0x72a0728, 0x72c072a, 0x72e072c, 0x730072e
  .long 0x7320730, 0x7340732, 0x7360734, 0x7380736, 0x73a0738, 0x73c073a, 0x73e073c, 0x740073e
  .long 0x7420740, 0x7440742, 0x7460744, 0x7480746, 0x74a0748, 0x74c074a, 0x74e074c, 0x750074e
  .long 0x7520750, 0x7540752, 0x7560754, 0x7580756, 0x75a0758, 0x75c075a, 0x75e075c, 0x760075e
  .long 0x7620760, 0x7640762, 0x7660764, 0x7680766, 0x76a0768, 0x76c076a, 0x76e076c, 0x770076e
  .long 0x7720770, 0x7740772, 0x7760774, 0x7780776, 0x77a0778, 0x77c077a, 0x77e077c, 0x780077e
  .long 0x7820780, 0x7840782, 0x7860784, 0x7880786, 0x78a0788, 0x78c078a, 0x78e078c, 0x790078e
  .long 0x7920790, 0x7940792, 0x7960794, 0x7980796, 0x79a0798, 0x79c079a, 0x79e079c, 0x7a0079e
  .long 0x7a207a0, 0x7a407a2, 0x7a607a4, 0x7a807a6, 0x7aa07a8, 0x7ac07aa, 0x7ae07ac, 0x7b007ae
  .long 0x7b207b0, 0x7b407b2, 0x7b607b4, 0x7b807b6, 0x7ba07b8, 0x7bc07ba, 0x7be07bc, 0x7c007be
  .long 0x7c207c0, 0x7c407c2, 0x7c607c4, 0x7c807c6, 0x7ca07c8, 0x7cc07ca, 0x7ce07cc, 0x7d007ce
  .long 0x7d207d0, 0x7d407d2, 0x7d607d4, 0x7d807d6, 0x7da07d8, 0x7dc07da, 0x7de07dc, 0x7e007de
  .long 0x7e207e0, 0x7e407e2, 0x7e607e4, 0x7e807e6, 0x7ea07e8, 0x7ec07ea, 0x7ee07ec, 0x7f007ee
  .long 0x7f207f0, 0x7f407f2, 0x7f607f4, 0x7f807f6, 0x7fa07f8, 0x7fc07fa, 0x7fe07fc, 0x80007fe
  .long 0x8020800, 0x8040802, 0x8060804, 0x8080806, 0x80a0808, 0x80c080a, 0x80e080c, 0x810080e
  .long 0x8120810, 0x8140812, 0x8160814, 0x8180816, 0x81a0818, 0x81c081a, 0x81e081c, 0x820081e
  .long 0x8220820, 0x8240822, 0x8260824, 0x8280826, 0x82a0828, 0x82c082a, 0x82e082c, 0x830082e
  .long 0x8320830, 0x8340832, 0x8360834, 0x8380836, 0x83a0838, 0x83c083a, 0x83e083c, 0x840083e
  .long 0x8420840, 0x8440842, 0x8460844, 0x8480846, 0x84a0848, 0x84c084a, 0x84e084c, 0x850084e
  .long 0x8520850, 0x8540852, 0x8560854, 0x8580856, 0x85a0858, 0x85c085a, 0x85e085c, 0x860085e
  .long 0x8620860, 0x8640862, 0x8660864, 0x8680866, 0x86a0868, 0x86c086a, 0x86e086c, 0x870086e
  .long 0x8720870, 0x8740872, 0x8760874, 0x8780876, 0x87a0878, 0x87c087a, 0x87e087c, 0x880087e
  .long 0x8820880, 0x8840882, 0x8860884, 0x8880886, 0x88a0888, 0x88c088a, 0x88e088c, 0x890088e
  .long 0x8920890, 0x8940892, 0x8960894, 0x8980896, 0x89a0898, 0x89c089a, 0x89e089c, 0x8a0089e
  .long 0x8a208a0, 0x8a408a2, 0x8a608a4, 0x8a808a6, 0x8aa08a8, 0x8ac08aa, 0x8ae08ac, 0x8b008ae
  .long 0x8b208b0, 0x8b408b2, 0x8b608b4, 0x8b808b6, 0x8ba08b8, 0x8bc08ba, 0x8be08bc, 0x8c008be
  .long 0x8c208c0, 0x8c408c2, 0x8c608c4, 0x8c808c6, 0x8ca08c8, 0x8cc08ca, 0x8ce08cc, 0x8d008ce
  .long 0x8d208d0, 0x8d408d2, 0x8d608d4, 0x8d808d6, 0x8da08d8, 0x8dc08da, 0x8de08dc, 0x8e008de
  .long 0x8e208e0, 0x8e408e2, 0x8e608e4, 0x8e808e6, 0x8ea08e8, 0x8ec08ea, 0x8ee08ec, 0x8f008ee
  .long 0x8f208f0, 0x8f408f2, 0x8f608f4, 0x8f808f6, 0x8fa08f8, 0x8fc08fa, 0x8fe08fc, 0x90008fe
  .long 0x9020900, 0x9040902, 0x9060904, 0x9080906, 0x90a0908, 0x90c090a, 0x90e090c, 0x910090e
  .long 0x9120910, 0x9140912, 0x9160914, 0x9180916, 0x91a0918, 0x91c091a, 0x91e091c, 0x920091e
  .long 0x9220920, 0x9240922, 0x9260924, 0x9280926, 0x92a0928, 0x92c092a, 0x92e092c, 0x930092e
  .long 0x9320930, 0x9340932, 0x9360934, 0x9380936, 0x93a0938, 0x93c093a, 0x93e093c, 0x940093e
  .long 0x9420940, 0x9440942, 0x9460944, 0x9480946, 0x94a0948, 0x94c094a, 0x94e094c, 0x950094e
  .long 0x9520950, 0x9540952, 0x9560954, 0x9580956, 0x95a0958, 0x95c095a, 0x95e095c, 0x960095e
  .long 0x9620960, 0x9640962, 0x9660964, 0x9680966, 0x96a0968, 0x96c096a, 0x96e096c, 0x970096e
  .long 0x9720970, 0x9740972, 0x9760974, 0x9780976, 0x97a0978, 0x97c097a, 0x97e097c, 0x980097e
  .long 0x9820980, 0x9840982, 0x9860984, 0x9880986, 0x98a0988, 0x98c098a, 0x98e098c, 0x990098e
  .long 0x9920990, 0x9940992, 0x9960994, 0x9980996, 0x99a0998, 0x99c099a, 0x99e099c, 0x9a0099e
  .long 0x9a209a0, 0x9a409a2, 0x9a609a4, 0x9a809a6, 0x9aa09a8, 0x9ac09aa, 0x9ae09ac, 0x9b009ae
  .long 0x9b209b0, 0x9b409b2, 0x9b609b4, 0x9b809b6, 0x9ba09b8, 0x9bc09ba, 0x9be09bc, 0x9c009be
  .long 0x9c209c0, 0x9c409c2, 0x9c609c4, 0x9c809c6, 0x9ca09c8, 0x9cc09ca, 0x9ce09cc, 0x9d009ce
  .long 0x9d209d0, 0x9d409d2, 0x9d609d4, 0x9d809d6, 0x9da09d8, 0x9dc09da, 0x9de09dc, 0x9e009de
  .long 0x9e209e0, 0x9e409e2, 0x9e609e4, 0x9e809e6, 0x9ea09e8, 0x9ec09ea, 0x9ee09ec, 0x9f009ee
  .long 0x9f209f0, 0x9f409f2, 0x9f609f4, 0x9f809f6, 0x9fa09f8, 0x9fc09fa, 0x9fe09fc, 0xa0009fe
  .long 0xa020a00, 0xa040a02, 0xa060a04, 0xa080a06, 0xa0a0a08, 0xa0c0a0a, 0xa0e0a0c, 0xa100a0e
  .long 0xa120a10, 0xa140a12, 0xa160a14, 0xa180a16, 0xa1a0a18, 0xa1c0a1a, 0xa1e0a1c, 0xa200a1e
  .long 0xa220a20, 0xa240a22, 0xa260a24, 0xa280a26, 0xa2a0a28, 0xa2c0a2a, 0xa2e0a2c, 0xa300a2e
  .long 0xa320a30, 0xa340a32, 0xa360a34, 0xa380a36, 0xa3a0a38, 0xa3c0a3a, 0xa3e0a3c, 0xa400a3e
  .long 0xa420a40, 0xa440a42, 0xa460a44, 0xa480a46, 0xa4a0a48, 0xa4c0a4a, 0xa4e0a4c, 0xa500a4e
  .long 0xa520a50, 0xa540a52, 0xa560a54, 0xa580a56, 0xa5a0a58, 0xa5c0a5a, 0xa5e0a5c, 0xa600a5e
  .long 0xa620a60, 0xa640a62, 0xa660a64, 0xa680a66, 0xa6a0a68, 0xa6c0a6a, 0xa6e0a6c, 0xa700a6e
  .long 0xa720a70, 0xa740a72, 0xa760a74, 0xa780a76, 0xa7a0a78, 0xa7c0a7a, 0xa7e0a7c, 0xa800a7e
  .long 0xa820a80, 0xa840a82, 0xa860a84, 0xa880a86, 0xa8a0a88, 0xa8c0a8a, 0xa8e0a8c, 0xa900a8e
  .long 0xa920a90, 0xa940a92, 0xa960a94, 0xa980a96, 0xa9a0a98, 0xa9c0a9a, 0xa9e0a9c, 0xaa00a9e
  .long 0xaa20aa0, 0xaa40aa2, 0xaa60aa4, 0xaa80aa6, 0xaaa0aa8, 0xaac0aaa, 0xaae0aac, 0xab00aae
  .long 0xab20ab0, 0xab40ab2, 0xab60ab4, 0xab80ab6, 0xaba0ab8, 0xabc0aba, 0xabe0abc, 0xac00abe
  .long 0xac20ac0, 0xac40ac2, 0xac60ac4, 0xac80ac6, 0xaca0ac8, 0xacc0aca, 0xace0acc, 0xad00ace
  .long 0xad20ad0, 0xad40ad2, 0xad60ad4, 0xad80ad6, 0xada0ad8, 0xadc0ada, 0xade0adc, 0xae00ade
  .long 0xae20ae0, 0xae40ae2, 0xae60ae4, 0xae80ae6, 0xaea0ae8, 0xaec0aea, 0xaee0aec, 0xaf00aee
  .long 0xaf20af0, 0xaf40af2, 0xaf60af4, 0xaf80af6, 0xafa0af8, 0xafc0afa, 0xafe0afc, 0xb000afe
  .long 0xb020b00, 0xb040b02, 0xb060b04, 0xb080b06, 0xb0a0b08, 0xb0c0b0a, 0xb0e0b0c, 0xb100b0e
  .long 0xb120b10, 0xb140b12, 0xb160b14, 0xb180b16, 0xb1a0b18, 0xb1c0b1a, 0xb1e0b1c, 0xb200b1e
  .long 0xb220b20, 0xb240b22, 0xb260b24, 0xb280b26, 0xb2a0b28, 0xb2c0b2a, 0xb2e0b2c, 0xb300b2e
  .long 0xb320b30, 0xb340b32, 0xb360b34, 0xb380b36, 0xb3a0b38, 0xb3c0b3a, 0xb3e0b3c, 0xb400b3e
  .long 0xb420b40, 0xb440b42, 0xb460b44, 0xb480b46, 0xb4a0b48, 0xb4c0b4a, 0xb4e0b4c, 0xb500b4e
  .long 0xb520b50, 0xb540b52, 0xb560b54, 0xb580b56, 0xb5a0b58, 0xb5c0b5a, 0xb5e0b5c, 0xb600b5e
  .long 0xb620b60, 0xb640b62, 0xb660b64, 0xb680b66, 0xb6a0b68, 0xb6c0b6a, 0xb6e0b6c, 0xb700b6e
  .long 0xb720b70, 0xb740b72, 0xb760b74, 0xb780b76, 0xb7a0b78, 0xb7c0b7a, 0xb7e0b7c, 0xb800b7e
  .long 0xb820b80, 0xb840b82, 0xb860b84, 0xb880b86, 0xb8a0b88, 0xb8c0b8a, 0xb8e0b8c, 0xb900b8e
  .long 0xb920b90, 0xb940b92, 0xb960b94, 0xb980b96, 0xb9a0b98, 0xb9c0b9a, 0xb9e0b9c, 0xba00b9e
  .long 0xba20ba0, 0xba40ba2, 0xba60ba4, 0xba80ba6, 0xbaa0ba8, 0xbac0baa, 0xbae0bac, 0xbb00bae
  .long 0xbb20bb0, 0xbb40bb2, 0xbb60bb4, 0xbb80bb6, 0xbba0bb8, 0xbbc0bba, 0xbbe0bbc, 0xbc00bbe
  .long 0xbc20bc0, 0xbc40bc2, 0xbc60bc4, 0xbc80bc6, 0xbca0bc8, 0xbcc0bca, 0xbce0bcc, 0xbd00bce
  .long 0xbd20bd0, 0xbd40bd2, 0xbd60bd4, 0xbd80bd6, 0xbda0bd8, 0xbdc0bda, 0xbde0bdc, 0xbe00bde
  .long 0xbe20be0, 0xbe40be2, 0xbe60be4, 0xbe80be6, 0xbea0be8, 0xbec0bea, 0xbee0bec, 0xbf00bee
  .long 0xbf20bf0, 0xbf40bf2, 0xbf60bf4, 0xbf80bf6, 0xbfa0bf8, 0xbfc0bfa, 0xbfe0bfc, 0xc000bfe
  .long 0xc020c00, 0xc040c02, 0xc060c04, 0xc080c06, 0xc0a0c08, 0xc0c0c0a, 0xc0e0c0c, 0xc100c0e
  .long 0xc120c10, 0xc140c12, 0xc160c14, 0xc180c16, 0xc1a0c18, 0xc1c0c1a, 0xc1e0c1c, 0xc200c1e
  .long 0xc220c20, 0xc240c22, 0xc260c24, 0xc280c26, 0xc2a0c28, 0xc2c0c2a, 0xc2e0c2c, 0xc300c2e
  .long 0xc320c30, 0xc340c32, 0xc360c34, 0xc380c36, 0xc3a0c38, 0xc3c0c3a, 0xc3e0c3c, 0xc400c3e
  .long 0xc420c40, 0xc440c42, 0xc460c44, 0xc480c46, 0xc4a0c48, 0xc4c0c4a, 0xc4e0c4c, 0xc500c4e
  .long 0xc520c50, 0xc540c52, 0xc560c54, 0xc580c56, 0xc5a0c58, 0xc5c0c5a, 0xc5e0c5c, 0xc600c5e
  .long 0xc620c60, 0xc640c62, 0xc660c64, 0xc680c66, 0xc6a0c68, 0xc6c0c6a, 0xc6e0c6c, 0xc700c6e
  .long 0xc720c70, 0xc740c72, 0xc760c74, 0xc780c76, 0xc7a0c78, 0xc7c0c7a, 0xc7e0c7c, 0xc800c7e
  .long 0xc820c80, 0xc840c82, 0xc860c84, 0xc880c86, 0xc8a0c88, 0xc8c0c8a, 0xc8e0c8c, 0xc900c8e
  .long 0xc920c90, 0xc940c92, 0xc960c94, 0xc980c96, 0xc9a0c98, 0xc9c0c9a, 0xc9e0c9c, 0xca00c9e
  .long 0xca20ca0, 0xca40ca2, 0xca60ca4, 0xca80ca6, 0xcaa0ca8, 0xcac0caa, 0xcae0cac, 0xcb00cae
  .long 0xcb20cb0, 0xcb40cb2, 0xcb60cb4, 0xcb80cb6, 0xcba0cb8, 0xcbc0cba, 0xcbe0cbc, 0xcc00cbe
  .long 0xcc20cc0, 0xcc40cc2, 0xcc60cc4, 0xcc80cc6, 0xcca0cc8, 0xccc0cca, 0xcce0ccc, 0xcd00cce
  .long 0xcd20cd0, 0xcd40cd2, 0xcd60cd4, 0xcd80cd6, 0xcda0cd8, 0xcdc0cda, 0xcde0cdc, 0xce00cde
  .long 0xce20ce0, 0xce40ce2, 0xce60ce4, 0xce80ce6, 0xcea0ce8, 0xcec0cea, 0xcee0cec, 0xcf00cee
  .long 0xcf20cf0, 0xcf40cf2, 0xcf60cf4, 0xcf80cf6, 0xcfa0cf8, 0xcfc0cfa, 0xcfe0cfc, 0xd000cfe
  .long 0xd020d00, 0xd040d02, 0xd060d04, 0xd080d06, 0xd0a0d08, 0xd0c0d0a, 0xd0e0d0c, 0xd100d0e
  .long 0xd120d10, 0xd140d12, 0xd160d14, 0xd180d16, 0xd1a0d18, 0xd1c0d1a, 0xd1e0d1c, 0xd200d1e
  .long 0xd220d20, 0xd240d22, 0xd260d24, 0xd280d26, 0xd2a0d28, 0xd2c0d2a, 0xd2e0d2c, 0xd300d2e
  .long 0xd320d30, 0xd340d32, 0xd360d34, 0xd380d36, 0xd3a0d38, 0xd3c0d3a, 0xd3e0d3c, 0xd400d3e
  .long 0xd420d40, 0xd440d42, 0xd460d44, 0xd480d46, 0xd4a0d48, 0xd4c0d4a, 0xd4e0d4c, 0xd500d4e
  .long 0xd520d50, 0xd540d52, 0xd560d54, 0xd580d56, 0xd5a0d58, 0xd5c0d5a, 0xd5e0d5c, 0xd600d5e
  .long 0xd620d60, 0xd640d62, 0xd660d64, 0xd680d66, 0xd6a0d68, 0xd6c0d6a, 0xd6e0d6c, 0xd700d6e
  .long 0xd720d70, 0xd740d72, 0xd760d74, 0xd780d76, 0xd7a0d78, 0xd7c0d7a, 0xd7e0d7c, 0xd800d7e
  .long 0xd820d80, 0xd840d82, 0xd860d84, 0xd880d86, 0xd8a0d88, 0xd8c0d8a, 0xd8e0d8c, 0xd900d8e
  .long 0xd920d90, 0xd940d92, 0xd960d94, 0xd980d96, 0xd9a0d98, 0xd9c0d9a, 0xd9e0d9c, 0xda00d9e
  .long 0xda20da0, 0xda40da2, 0xda60da4, 0xda80da6, 0xdaa0da8, 0xdac0daa, 0xdae0dac, 0xdb00dae
  .long 0xdb20db0, 0xdb40db2, 0xdb60db4, 0xdb80db6, 0xdba0db8, 0xdbc0dba, 0xdbe0dbc, 0xdc00dbe
  .long 0xdc20dc0, 0xdc40dc2, 0xdc60dc4, 0xdc80dc6, 0xdca0dc8, 0xdcc0dca, 0xdce0dcc, 0xdd00dce
  .long 0xdd20dd0, 0xdd40dd2, 0xdd60dd4, 0xdd80dd6, 0xdda0dd8, 0xddc0dda, 0xdde0ddc, 0xde00dde
  .long 0xde20de0, 0xde40de2, 0xde60de4, 0xde80de6, 0xdea0de8, 0xdec0dea, 0xdee0dec, 0xdf00dee
  .long 0xdf20df0, 0xdf40df2, 0xdf60df4, 0xdf80df6, 0xdfa0df8, 0xdfc0dfa, 0xdfe0dfc, 0xe000dfe
  .long 0xe020e00, 0xe040e02, 0xe060e04, 0xe080e06, 0xe0a0e08, 0xe0c0e0a, 0xe0e0e0c, 0xe100e0e
  .long 0xe120e10, 0xe140e12, 0xe160e14, 0xe180e16, 0xe1a0e18, 0xe1c0e1a, 0xe1e0e1c, 0xe200e1e
  .long 0xe220e20, 0xe240e22, 0xe260e24, 0xe280e26, 0xe2a0e28, 0xe2c0e2a, 0xe2e0e2c, 0xe300e2e
  .long 0xe320e30, 0xe340e32, 0xe360e34, 0xe380e36, 0xe3a0e38, 0xe3c0e3a, 0xe3e0e3c, 0xe400e3e
  .long 0xe420e40, 0xe440e42, 0xe460e44, 0xe480e46, 0xe4a0e48, 0xe4c0e4a, 0xe4e0e4c, 0xe500e4e
  .long 0xe520e50, 0xe540e52, 0xe560e54, 0xe580e56, 0xe5a0e58, 0xe5c0e5a, 0xe5e0e5c, 0xe600e5e
  .long 0xe620e60, 0xe640e62, 0xe660e64, 0xe680e66, 0xe6a0e68, 0xe6c0e6a, 0xe6e0e6c, 0xe700e6e
  .long 0xe720e70, 0xe740e72, 0xe760e74, 0xe780e76, 0xe7a0e78, 0xe7c0e7a, 0xe7e0e7c, 0xe800e7e
  .long 0xe820e80, 0xe840e82, 0xe860e84, 0xe880e86, 0xe8a0e88, 0xe8c0e8a, 0xe8e0e8c, 0xe900e8e
  .long 0xe920e90, 0xe940e92, 0xe960e94, 0xe980e96, 0xe9a0e98, 0xe9c0e9a, 0xe9e0e9c, 0xea00e9e
  .long 0xea20ea0, 0xea40ea2, 0xea60ea4, 0xea80ea6, 0xeaa0ea8, 0xeac0eaa, 0xeae0eac, 0xeb00eae
  .long 0xeb20eb0, 0xeb40eb2, 0xeb60eb4, 0xeb80eb6, 0xeba0eb8, 0xebc0eba, 0xebe0ebc, 0xec00ebe
  .long 0xec20ec0, 0xec40ec2, 0xec60ec4, 0xec80ec6, 0xeca0ec8, 0xecc0eca, 0xece0ecc, 0xed00ece
  .long 0xed20ed0, 0xed40ed2, 0xed60ed4, 0xed80ed6, 0xeda0ed8, 0xedc0eda, 0xede0edc, 0xee00ede
  .long 0xee20ee0, 0xee40ee2, 0xee60ee4, 0xee80ee6, 0xeea0ee8, 0xeec0eea, 0xeee0eec, 0xef00eee
  .long 0xef20ef0, 0xef40ef2, 0xef60ef4, 0xef80ef6, 0xefa0ef8, 0xefc0efa, 0xefe0efc, 0xf000efe
  .long 0xf020f00, 0xf040f02, 0xf060f04, 0xf080f06, 0xf0a0f08, 0xf0c0f0a, 0xf0e0f0c, 0xf100f0e
  .long 0xf120f10, 0xf140f12, 0xf160f14, 0xf180f16, 0xf1a0f18, 0xf1c0f1a, 0xf1e0f1c, 0xf200f1e
  .long 0xf220f20, 0xf240f22, 0xf260f24, 0xf280f26, 0xf2a0f28, 0xf2c0f2a, 0xf2e0f2c, 0xf300f2e
  .long 0xf320f30, 0xf340f32, 0xf360f34, 0xf380f36, 0xf3a0f38, 0xf3c0f3a, 0xf3e0f3c, 0xf400f3e
  .long 0xf420f40, 0xf440f42, 0xf460f44, 0xf480f46, 0xf4a0f48, 0xf4c0f4a, 0xf4e0f4c, 0xf500f4e
  .long 0xf520f50, 0xf540f52, 0xf560f54, 0xf580f56, 0xf5a0f58, 0xf5c0f5a, 0xf5e0f5c, 0xf600f5e
  .long 0xf620f60, 0xf640f62, 0xf660f64, 0xf680f66, 0xf6a0f68, 0xf6c0f6a, 0xf6e0f6c, 0xf700f6e
  .long 0xf720f70, 0xf740f72, 0xf760f74, 0xf780f76, 0xf7a0f78, 0xf7c0f7a, 0xf7e0f7c, 0xf800f7e
  .long 0xf820f80, 0xf840f82, 0xf860f84, 0xf880f86, 0xf8a0f88, 0xf8c0f8a, 0xf8e0f8c, 0xf900f8e
  .long 0xf920f90, 0xf940f92, 0xf960f94, 0xf980f96, 0xf9a0f98, 0xf9c0f9a, 0xf9e0f9c, 0xfa00f9e
  .long 0xfa20fa0, 0xfa40fa2, 0xfa60fa4, 0xfa80fa6, 0xfaa0fa8, 0xfac0faa, 0xfae0fac, 0xfb00fae
  .long 0xfb20fb0, 0xfb40fb2, 0xfb60fb4, 0xfb80fb6, 0xfba0fb8, 0xfbc0fba, 0xfbe0fbc, 0xfc00fbe
  .long 0xfc20fc0, 0xfc40fc2, 0xfc60fc4, 0xfc80fc6, 0xfca0fc8, 0xfcc0fca, 0xfce0fcc, 0xfd00fce
  .long 0xfd20fd0, 0xfd40fd2, 0xfd60fd4, 0xfd80fd6, 0xfda0fd8, 0xfdc0fda, 0xfde0fdc, 0xfe00fde
  .long 0xfe20fe0, 0xfe40fe2, 0xfe60fe4, 0xfe80fe6, 0xfea0fe8, 0xfec0fea, 0xfee0fec, 0xff00fee
  .long 0xff20ff0, 0xff40ff2, 0xff60ff4, 0xff80ff6, 0xffa0ff8, 0xffc0ffa, 0xffe0ffc, 0x10000ffe
  .long 0x10021000, 0x10041002, 0x10061004, 0x10081006, 0x100a1008, 0x100c100a, 0x100e100c, 0x1010100e
  .long 0x10121010, 0x10141012, 0x10161014, 0x10181016, 0x101a1018, 0x101c101a, 0x101e101c, 0x1020101e
  .long 0x10221020, 0x10241022, 0x10261024, 0x10281026, 0x102a1028, 0x102c102a, 0x102e102c, 0x1030102e
  .long 0x10321030, 0x10341032, 0x10361034, 0x10381036, 0x103a1038, 0x103c103a, 0x103e103c, 0x1040103e
  .long 0x10421040, 0x10441042, 0x10461044, 0x10481046, 0x104a1048, 0x104c104a, 0x104e104c, 0x1050104e
  .long 0x10521050, 0x10541052, 0x10561054, 0x10581056, 0x105a1058, 0x105c105a, 0x105e105c, 0x1060105e
  .long 0x10621060, 0x10641062, 0x10661064, 0x10681066, 0x106a1068, 0x106c106a, 0x106e106c, 0x1070106e
  .long 0x10721070, 0x10741072, 0x10761074, 0x10781076, 0x107a1078, 0x107c107a, 0x107e107c, 0x1080107e
  .long 0x10821080, 0x10841082, 0x10861084, 0x10881086, 0x108a1088, 0x108c108a, 0x108e108c, 0x1090108e
  .long 0x10921090, 0x10941092, 0x10961094, 0x10981096, 0x109a1098, 0x109c109a, 0x109e109c, 0x10a0109e
  .long 0x10a210a0, 0x10a410a2, 0x10a610a4, 0x10a810a6, 0x10aa10a8, 0x10ac10aa, 0x10ae10ac, 0x10b010ae
  .long 0x10b210b0, 0x10b410b2, 0x10b610b4, 0x10b810b6, 0x10ba10b8, 0x10bc10ba, 0x10be10bc, 0x10c010be
  .long 0x10c210c0, 0x10c410c2, 0x10c610c4, 0x10c810c6, 0x10ca10c8, 0x10cc10ca, 0x10ce10cc, 0x10d010ce
  .long 0x10d210d0, 0x10d410d2, 0x10d610d4, 0x10d810d6, 0x10da10d8, 0x10dc10da, 0x10de10dc, 0x10e010de
  .long 0x10e210e0, 0x10e410e2, 0x10e610e4, 0x10e810e6, 0x10ea10e8, 0x10ec10ea, 0x10ee10ec, 0x10f010ee
  .long 0x10f210f0, 0x10f410f2, 0x10f610f4, 0x10f810f6, 0x10fa10f8, 0x10fc10fa, 0x10fe10fc, 0x110010fe
  .long 0x11021100, 0x11041102, 0x11061104, 0x11081106, 0x110a1108, 0x110c110a, 0x110e110c, 0x1110110e
  .long 0x11121110, 0x11141112, 0x11161114, 0x11181116, 0x111a1118, 0x111c111a, 0x111e111c, 0x1120111e
  .long 0x11221120, 0x11241122, 0x11261124, 0x11281126, 0x112a1128, 0x112c112a, 0x112e112c, 0x1130112e
  .long 0x11321130, 0x11341132, 0x11361134, 0x11381136, 0x113a1138, 0x113c113a, 0x113e113c, 0x1140113e
  .long 0x11421140, 0x11441142, 0x11461144, 0x11481146, 0x114a1148, 0x114c114a, 0x114e114c, 0x1150114e
  .long 0x11521150, 0x11541152, 0x11561154, 0x11581156, 0x115a1158, 0x115c115a, 0x115e115c, 0x1160115e
  .long 0x11621160, 0x11641162, 0x11661164, 0x11681166, 0x116a1168, 0x116c116a, 0x116e116c, 0x1170116e
  .long 0x11721170, 0x11741172, 0x11761174, 0x11781176, 0x117a1178, 0x117c117a, 0x117e117c, 0x1180117e
  .long 0x11821180, 0x11841182, 0x11861184, 0x11881186, 0x118a1188, 0x118c118a, 0x118e118c, 0x1190118e
  .long 0x11921190, 0x11941192, 0x11961194, 0x11981196, 0x119a1198, 0x119c119a, 0x119e119c, 0x11a0119e
  .long 0x11a211a0, 0x11a411a2, 0x11a611a4, 0x11a811a6, 0x11aa11a8, 0x11ac11aa, 0x11ae11ac, 0x11b011ae
  .long 0x11b211b0, 0x11b411b2, 0x11b611b4, 0x11b811b6, 0x11ba11b8, 0x11bc11ba, 0x11be11bc, 0x11c011be
  .long 0x11c211c0, 0x11c411c2, 0x11c611c4, 0x11c811c6, 0x11ca11c8, 0x11cc11ca, 0x11ce11cc, 0x11d011ce
  .long 0x11d211d0, 0x11d411d2, 0x11d611d4, 0x11d811d6, 0x11da11d8, 0x11dc11da, 0x11de11dc, 0x11e011de
  .long 0x11e211e0, 0x11e411e2, 0x11e611e4, 0x11e811e6, 0x11ea11e8, 0x11ec11ea, 0x11ee11ec, 0x11f011ee
  .long 0x11f211f0, 0x11f411f2, 0x11f611f4, 0x11f811f6, 0x11fa11f8, 0x11fc11fa, 0x11fe11fc, 0x120011fe
  .long 0x12021200, 0x12041202, 0x12061204, 0x12081206, 0x120a1208, 0x120c120a, 0x120e120c, 0x1210120e
  .long 0x12121210, 0x12141212, 0x12161214, 0x12181216, 0x121a1218, 0x121c121a, 0x121e121c, 0x1220121e
  .long 0x12221220, 0x12241222, 0x12261224, 0x12281226, 0x122a1228, 0x122c122a, 0x122e122c, 0x1230122e
  .long 0x12321230, 0x12341232, 0x12361234, 0x12381236, 0x123a1238, 0x123c123a, 0x123e123c, 0x1240123e
  .long 0x12421240, 0x12441242, 0x12461244, 0x12481246, 0x124a1248, 0x124c124a, 0x124e124c, 0x1250124e
  .long 0x12521250, 0x12541252, 0x12561254, 0x12581256, 0x125a1258, 0x125c125a, 0x125e125c, 0x1260125e
  .long 0x12621260, 0x12641262, 0x12661264, 0x12681266, 0x126a1268, 0x126c126a, 0x126e126c, 0x1270126e
  .long 0x12721270, 0x12741272, 0x12761274, 0x12781276, 0x127a1278, 0x127c127a, 0x127e127c, 0x1280127e
  .long 0x12821280, 0x12841282, 0x12861284, 0x12881286, 0x128a1288, 0x128c128a, 0x128e128c, 0x1290128e
  .long 0x12921290, 0x12941292, 0x12961294, 0x12981296, 0x129a1298, 0x129c129a, 0x129e129c, 0x12a0129e
  .long 0x12a212a0, 0x12a412a2, 0x12a612a4, 0x12a812a6, 0x12aa12a8, 0x12ac12aa, 0x12ae12ac, 0x12b012ae
  .long 0x12b212b0, 0x12b412b2, 0x12b612b4, 0x12b812b6, 0x12ba12b8, 0x12bc12ba, 0x12be12bc, 0x12c012be
  .long 0x12c212c0, 0x12c412c2, 0x12c612c4, 0x12c812c6, 0x12ca12c8, 0x12cc12ca, 0x12ce12cc, 0x12d012ce
  .long 0x12d212d0, 0x12d412d2, 0x12d612d4, 0x12d812d6, 0x12da12d8, 0x12dc12da, 0x12de12dc, 0x12e012de
  .long 0x12e212e0, 0x12e412e2, 0x12e612e4, 0x12e812e6, 0x12ea12e8, 0x12ec12ea, 0x12ee12ec, 0x12f012ee
  .long 0x12f212f0, 0x12f412f2, 0x12f612f4, 0x12f812f6, 0x12fa12f8, 0x12fc12fa, 0x12fe12fc, 0x130012fe
  .long 0x13021300, 0x13041302, 0x13061304, 0x13081306, 0x130a1308, 0x130c130a, 0x130e130c, 0x1310130e
  .long 0x13121310, 0x13141312, 0x13161314, 0x13181316, 0x131a1318, 0x131c131a, 0x131e131c, 0x1320131e
  .long 0x13221320, 0x13241322, 0x13261324, 0x13281326, 0x132a1328, 0x132c132a, 0x132e132c, 0x1330132e
  .long 0x13321330, 0x13341332, 0x13361334, 0x13381336, 0x133a1338, 0x133c133a, 0x133e133c, 0x1340133e
  .long 0x13421340, 0x13441342, 0x13461344, 0x13481346, 0x134a1348, 0x134c134a, 0x134e134c, 0x1350134e
  .long 0x13521350, 0x13541352, 0x13561354, 0x13581356, 0x135a1358, 0x135c135a, 0x135e135c, 0x1360135e
  .long 0x13621360, 0x13641362, 0x13661364, 0x13681366, 0x136a1368, 0x136c136a, 0x136e136c, 0x1370136e
  .long 0x13721370, 0x13741372, 0x13761374, 0x13781376, 0x137a1378, 0x137c137a, 0x137e137c, 0x1380137e
  .long 0x13821380, 0x13841382, 0x13861384, 0x13881386, 0x138a1388, 0x138c138a, 0x138e138c, 0x1390138e
  .long 0x13921390, 0x13941392, 0x13961394, 0x13981396, 0x139a1398, 0x139c139a, 0x139e139c, 0x13a0139e
  .long 0x13a213a0, 0x13a413a2, 0x13a613a4, 0x13a813a6, 0x13aa13a8, 0x13ac13aa, 0x13ae13ac, 0x13b013ae
  .long 0x13b213b0, 0x13b413b2, 0x13b613b4, 0x13b813b6, 0x13ba13b8, 0x13bc13ba, 0x13be13bc, 0x13c013be
  .long 0x13c213c0, 0x13c413c2, 0x13c613c4, 0x13c813c6, 0x13ca13c8, 0x13cc13ca, 0x13ce13cc, 0x13d013ce
  .long 0x13d213d0, 0x13d413d2, 0x13d613d4, 0x13d813d6, 0x13da13d8, 0x13dc13da, 0x13de13dc, 0x13e013de
  .long 0x13e213e0, 0x13e413e2, 0x13e613e4, 0x13e813e6, 0x13ea13e8, 0x13ec13ea, 0x13ee13ec, 0x13f013ee
  .long 0x13f213f0, 0x13f413f2, 0x13f613f4, 0x13f813f6, 0x13fa13f8, 0x13fc13fa, 0x13fe13fc, 0x140013fe
  .long 0x14021400, 0x14041402, 0x14061404, 0x14081406, 0x140a1408, 0x140c140a, 0x140e140c, 0x1410140e
  .long 0x14121410, 0x14141412, 0x14161414, 0x14181416, 0x141a1418, 0x141c141a, 0x141e141c, 0x1420141e
  .long 0x14221420, 0x14241422, 0x14261424, 0x14281426, 0x142a1428, 0x142c142a, 0x142e142c, 0x1430142e
  .long 0x14321430, 0x14341432, 0x14361434, 0x14381436, 0x143a1438, 0x143c143a, 0x143e143c, 0x1440143e
  .long 0x14421440, 0x14441442, 0x14461444, 0x14481446, 0x144a1448, 0x144c144a, 0x144e144c, 0x1450144e
  .long 0x14521450, 0x14541452, 0x14561454, 0x14581456, 0x145a1458, 0x145c145a, 0x145e145c, 0x1460145e
  .long 0x14621460, 0x14641462, 0x14661464, 0x14681466, 0x146a1468, 0x146c146a, 0x146e146c, 0x1470146e
  .long 0x14721470, 0x14741472, 0x14761474, 0x14781476, 0x147a1478, 0x147c147a, 0x147e147c, 0x1480147e
  .long 0x14821480, 0x14841482, 0x14861484, 0x14881486, 0x148a1488, 0x148c148a, 0x148e148c, 0x1490148e
  .long 0x14921490, 0x14941492, 0x14961494, 0x14981496, 0x149a1498, 0x149c149a, 0x149e149c, 0x14a0149e
  .long 0x14a214a0, 0x14a414a2, 0x14a614a4, 0x14a814a6, 0x14aa14a8, 0x14ac14aa, 0x14ae14ac, 0x14b014ae
  .long 0x14b214b0, 0x14b414b2, 0x14b614b4, 0x14b814b6, 0x14ba14b8, 0x14bc14ba, 0x14be14bc, 0x14c014be
  .long 0x14c214c0, 0x14c414c2, 0x14c614c4, 0x14c814c6, 0x14ca14c8, 0x14cc14ca, 0x14ce14cc, 0x14d014ce
  .long 0x14d214d0, 0x14d414d2, 0x14d614d4, 0x14d814d6, 0x14da14d8, 0x14dc14da, 0x14de14dc, 0x14e014de
  .long 0x14e214e0, 0x14e414e2, 0x14e614e4, 0x14e814e6, 0x14ea14e8, 0x14ec14ea, 0x14ee14ec, 0x14f014ee
  .long 0x14f214f0, 0x14f414f2, 0x14f614f4, 0x14f814f6, 0x14fa14f8, 0x14fc14fa, 0x14fe14fc, 0x150014fe
  .long 0x15021500, 0x15041502, 0x15061504, 0x15081506, 0x150a1508, 0x150c150a, 0x150e150c, 0x1510150e
  .long 0x15121510, 0x15141512, 0x15161514, 0x15181516, 0x151a1518, 0x151c151a, 0x151e151c, 0x1520151e
  .long 0x15221520, 0x15241522, 0x15261524, 0x15281526, 0x152a1528, 0x152c152a, 0x152e152c, 0x1530152e
  .long 0x15321530, 0x15341532, 0x15361534, 0x15381536, 0x153a1538, 0x153c153a, 0x153e153c, 0x1540153e
  .long 0x15421540, 0x15441542, 0x15461544, 0x15481546, 0x154a1548, 0x154c154a, 0x154e154c, 0x1550154e
  .long 0x15521550, 0x15541552, 0x15561554, 0x15581556, 0x155a1558, 0x155c155a, 0x155e155c, 0x1560155e
  .long 0x15621560, 0x15641562, 0x15661564, 0x15681566, 0x156a1568, 0x156c156a, 0x156e156c, 0x1570156e
  .long 0x15721570, 0x15741572, 0x15761574, 0x15781576, 0x157a1578, 0x157c157a, 0x157e157c, 0x1580157e
  .long 0x15821580, 0x15841582, 0x15861584, 0x15881586, 0x158a1588, 0x158c158a, 0x158e158c, 0x1590158e
  .long 0x15921590, 0x15941592, 0x15961594, 0x15981596, 0x159a1598, 0x159c159a, 0x159e159c, 0x15a0159e
  .long 0x15a215a0, 0x15a415a2, 0x15a615a4, 0x15a815a6, 0x15aa15a8, 0x15ac15aa, 0x15ae15ac, 0x15b015ae
  .long 0x15b215b0, 0x15b415b2, 0x15b615b4, 0x15b815b6, 0x15ba15b8, 0x15bc15ba, 0x15be15bc, 0x15c015be
  .long 0x15c215c0, 0x15c415c2, 0x15c615c4, 0x15c815c6, 0x15ca15c8, 0x15cc15ca, 0x15ce15cc, 0x15d015ce
  .long 0x15d215d0, 0x15d415d2, 0x15d615d4, 0x15d815d6, 0x15da15d8, 0x15dc15da, 0x15de15dc, 0x15e015de
  .long 0x15e215e0, 0x15e415e2, 0x15e615e4, 0x15e815e6, 0x15ea15e8, 0x15ec15ea, 0x15ee15ec, 0x15f015ee
  .long 0x15f215f0, 0x15f415f2, 0x15f615f4, 0x15f815f6, 0x15fa15f8, 0x15fc15fa, 0x15fe15fc, 0x160015fe
  .long 0x16021600, 0x16041602, 0x16061604, 0x16081606, 0x160a1608, 0x160c160a, 0x160e160c, 0x1610160e
  .long 0x16121610, 0x16141612, 0x16161614, 0x16181616, 0x161a1618, 0x161c161a, 0x161e161c, 0x1620161e
  .long 0x16221620, 0x16241622, 0x16261624, 0x16281626, 0x162a1628, 0x162c162a, 0x162e162c, 0x1630162e
  .long 0x16321630, 0x16341632, 0x16361634, 0x16381636, 0x163a1638, 0x163c163a, 0x163e163c, 0x1640163e
  .long 0x16421640, 0x16441642, 0x16461644, 0x16481646, 0x164a1648, 0x164c164a, 0x164e164c, 0x1650164e
  .long 0x16521650, 0x16541652, 0x16561654, 0x16581656, 0x165a1658, 0x165c165a, 0x165e165c, 0x1660165e
  .long 0x16621660, 0x16641662, 0x16661664, 0x16681666, 0x166a1668, 0x166c166a, 0x166e166c, 0x1670166e
  .long 0x16721670, 0x16741672, 0x16761674, 0x16781676, 0x167a1678, 0x167c167a, 0x167e167c, 0x1680167e
  .long 0x16821680, 0x16841682, 0x16861684, 0x16881686, 0x168a1688, 0x168c168a, 0x168e168c, 0x1690168e
  .long 0x16921690, 0x16941692, 0x16961694, 0x16981696, 0x169a1698, 0x169c169a, 0x169e169c, 0x16a0169e
  .long 0x16a216a0, 0x16a416a2, 0x16a616a4, 0x16a816a6, 0x16aa16a8, 0x16ac16aa, 0x16ae16ac, 0x16b016ae
  .long 0x16b216b0, 0x16b416b2, 0x16b616b4, 0x16b816b6, 0x16ba16b8, 0x16bc16ba, 0x16be16bc, 0x16c016be
  .long 0x16c216c0, 0x16c416c2, 0x16c616c4, 0x16c816c6, 0x16ca16c8, 0x16cc16ca, 0x16ce16cc, 0x16d016ce
  .long 0x16d216d0, 0x16d416d2, 0x16d616d4, 0x16d816d6, 0x16da16d8, 0x16dc16da, 0x16de16dc, 0x16e016de
  .long 0x16e216e0, 0x16e416e2, 0x16e616e4, 0x16e816e6, 0x16ea16e8, 0x16ec16ea, 0x16ee16ec, 0x16f016ee
  .long 0x16f216f0, 0x16f416f2, 0x16f616f4, 0x16f816f6, 0x16fa16f8, 0x16fc16fa, 0x16fe16fc, 0x170016fe
  .long 0x17021700, 0x17041702, 0x17061704, 0x17081706, 0x170a1708, 0x170c170a, 0x170e170c, 0x1710170e
  .long 0x17121710, 0x17141712, 0x17161714, 0x17181716, 0x171a1718, 0x171c171a, 0x171e171c, 0x1720171e
  .long 0x17221720, 0x17241722, 0x17261724, 0x17281726, 0x172a1728, 0x172c172a, 0x172e172c, 0x1730172e
  .long 0x17321730, 0x17341732, 0x17361734, 0x17381736, 0x173a1738, 0x173c173a, 0x173e173c, 0x1740173e
  .long 0x17421740, 0x17441742, 0x17461744, 0x17481746, 0x174a1748, 0x174c174a, 0x174e174c, 0x1750174e
  .long 0x17521750, 0x17541752, 0x17561754, 0x17581756, 0x175a1758, 0x175c175a, 0x175e175c, 0x1760175e
  .long 0x17621760, 0x17641762, 0x17661764, 0x17681766, 0x176a1768, 0x176c176a, 0x176e176c, 0x1770176e
  .long 0x17721770, 0x17741772, 0x17761774, 0x17781776, 0x177a1778, 0x177c177a, 0x177e177c, 0x1780177e
  .long 0x17821780, 0x17841782, 0x17861784, 0x17881786, 0x178a1788, 0x178c178a, 0x178e178c, 0x1790178e
  .long 0x17921790, 0x17941792, 0x17961794, 0x17981796, 0x179a1798, 0x179c179a, 0x179e179c, 0x17a0179e
  .long 0x17a217a0, 0x17a417a2, 0x17a617a4, 0x17a817a6, 0x17aa17a8, 0x17ac17aa, 0x17ae17ac, 0x17b017ae
  .long 0x17b217b0, 0x17b417b2, 0x17b617b4, 0x17b817b6, 0x17ba17b8, 0x17bc17ba, 0x17be17bc, 0x17c017be
  .long 0x17c217c0, 0x17c417c2, 0x17c617c4, 0x17c817c6, 0x17ca17c8, 0x17cc17ca, 0x17ce17cc, 0x17d017ce
  .long 0x17d217d0, 0x17d417d2, 0x17d617d4, 0x17d817d6, 0x17da17d8, 0x17dc17da, 0x17de17dc, 0x17e017de
  .long 0x17e217e0, 0x17e417e2, 0x17e617e4, 0x17e817e6, 0x17ea17e8, 0x17ec17ea, 0x17ee17ec, 0x17f017ee
  .long 0x17f217f0, 0x17f417f2, 0x17f617f4, 0x17f817f6, 0x17fa17f8, 0x17fc17fa, 0x17fe17fc, 0x180017fe
  .long 0x18021800, 0x18041802, 0x18061804, 0x18081806, 0x180a1808, 0x180c180a, 0x180e180c, 0x1810180e
  .long 0x18121810, 0x18141812, 0x18161814, 0x18181816, 0x181a1818, 0x181c181a, 0x181e181c, 0x1820181e
  .long 0x18221820, 0x18241822, 0x18261824, 0x18281826, 0x182a1828, 0x182c182a, 0x182e182c, 0x1830182e
  .long 0x18321830, 0x18341832, 0x18361834, 0x18381836, 0x183a1838, 0x183c183a, 0x183e183c, 0x1840183e
  .long 0x18421840, 0x18441842, 0x18461844, 0x18481846, 0x184a1848, 0x184c184a, 0x184e184c, 0x1850184e
  .long 0x18521850, 0x18541852, 0x18561854, 0x18581856, 0x185a1858, 0x185c185a, 0x185e185c, 0x1860185e
  .long 0x18621860, 0x18641862, 0x18661864, 0x18681866, 0x186a1868, 0x186c186a, 0x186e186c, 0x1870186e
  .long 0x18721870, 0x18741872, 0x18761874, 0x18781876, 0x187a1878, 0x187c187a, 0x187e187c, 0x1880187e
  .long 0x18821880, 0x18841882, 0x18861884, 0x18881886, 0x188a1888, 0x188c188a, 0x188e188c, 0x1890188e
  .long 0x18921890, 0x18941892, 0x18961894, 0x18981896, 0x189a1898, 0x189c189a, 0x189e189c, 0x18a0189e
  .long 0x18a218a0, 0x18a418a2, 0x18a618a4, 0x18a818a6, 0x18aa18a8, 0x18ac18aa, 0x18ae18ac, 0x18b018ae
  .long 0x18b218b0, 0x18b418b2, 0x18b618b4, 0x18b818b6, 0x18ba18b8, 0x18bc18ba, 0x18be18bc, 0x18c018be
  .long 0x18c218c0, 0x18c418c2, 0x18c618c4, 0x18c818c6, 0x18ca18c8, 0x18cc18ca, 0x18ce18cc, 0x18d018ce
  .long 0x18d218d0, 0x18d418d2, 0x18d618d4, 0x18d818d6, 0x18da18d8, 0x18dc18da, 0x18de18dc, 0x18e018de
  .long 0x18e218e0, 0x18e418e2, 0x18e618e4, 0x18e818e6, 0x18ea18e8, 0x18ec18ea, 0x18ee18ec, 0x18f018ee
  .long 0x18f218f0, 0x18f418f2, 0x18f618f4, 0x18f818f6, 0x18fa18f8, 0x18fc18fa, 0x18fe18fc, 0x190018fe
  .long 0x19021900, 0x19041902, 0x19061904, 0x19081906, 0x190a1908, 0x190c190a, 0x190e190c, 0x1910190e
  .long 0x19121910, 0x19141912, 0x19161914, 0x19181916, 0x191a1918, 0x191c191a, 0x191e191c, 0x1920191e
  .long 0x19221920, 0x19241922, 0x19261924, 0x19281926, 0x192a1928, 0x192c192a, 0x192e192c, 0x1930192e
  .long 0x19321930, 0x19341932, 0x19361934, 0x19381936, 0x193a1938, 0x193c193a, 0x193e193c, 0x1940193e
  .long 0x19421940, 0x19441942, 0x19461944, 0x19481946, 0x194a1948, 0x194c194a, 0x194e194c, 0x1950194e
  .long 0x19521950, 0x19541952, 0x19561954, 0x19581956, 0x195a1958, 0x195c195a, 0x195e195c, 0x1960195e
  .long 0x19621960, 0x19641962, 0x19661964, 0x19681966, 0x196a1968, 0x196c196a, 0x196e196c, 0x1970196e
  .long 0x19721970, 0x19741972, 0x19761974, 0x19781976, 0x197a1978, 0x197c197a, 0x197e197c, 0x1980197e
  .long 0x19821980, 0x19841982, 0x19861984, 0x19881986, 0x198a1988, 0x198c198a, 0x198e198c, 0x1990198e
  .long 0x19921990, 0x19941992, 0x19961994, 0x19981996, 0x199a1998, 0x199c199a, 0x199e199c, 0x19a0199e
  .long 0x19a219a0, 0x19a419a2, 0x19a619a4, 0x19a819a6, 0x19aa19a8, 0x19ac19aa, 0x19ae19ac, 0x19b019ae
  .long 0x19b219b0, 0x19b419b2, 0x19b619b4, 0x19b819b6, 0x19ba19b8, 0x19bc19ba, 0x19be19bc, 0x19c019be
  .long 0x19c219c0, 0x19c419c2, 0x19c619c4, 0x19c819c6, 0x19ca19c8, 0x19cc19ca, 0x19ce19cc, 0x19d019ce
  .long 0x19d219d0, 0x19d419d2, 0x19d619d4, 0x19d819d6, 0x19da19d8, 0x19dc19da, 0x19de19dc, 0x19e019de
  .long 0x19e219e0, 0x19e419e2, 0x19e619e4, 0x19e819e6, 0x19ea19e8, 0x19ec19ea, 0x19ee19ec, 0x19f019ee
  .long 0x19f219f0, 0x19f419f2, 0x19f619f4, 0x19f819f6, 0x19fa19f8, 0x19fc19fa, 0x19fe19fc, 0x1a0019fe
  .long 0x1a021a00, 0x1a041a02, 0x1a061a04, 0x1a081a06, 0x1a0a1a08, 0x1a0c1a0a, 0x1a0e1a0c, 0x1a101a0e
  .long 0x1a121a10, 0x1a141a12, 0x1a161a14, 0x1a181a16, 0x1a1a1a18, 0x1a1c1a1a, 0x1a1e1a1c, 0x1a201a1e
  .long 0x1a221a20, 0x1a241a22, 0x1a261a24, 0x1a281a26, 0x1a2a1a28, 0x1a2c1a2a, 0x1a2e1a2c, 0x1a301a2e
  .long 0x1a321a30, 0x1a341a32, 0x1a361a34, 0x1a381a36, 0x1a3a1a38, 0x1a3c1a3a, 0x1a3e1a3c, 0x1a401a3e
  .long 0x1a421a40, 0x1a441a42, 0x1a461a44, 0x1a481a46, 0x1a4a1a48, 0x1a4c1a4a, 0x1a4e1a4c, 0x1a501a4e
  .long 0x1a521a50, 0x1a541a52, 0x1a561a54, 0x1a581a56, 0x1a5a1a58, 0x1a5c1a5a, 0x1a5e1a5c, 0x1a601a5e
  .long 0x1a621a60, 0x1a641a62, 0x1a661a64, 0x1a681a66, 0x1a6a1a68, 0x1a6c1a6a, 0x1a6e1a6c, 0x1a701a6e
  .long 0x1a721a70, 0x1a741a72, 0x1a761a74, 0x1a781a76, 0x1a7a1a78, 0x1a7c1a7a, 0x1a7e1a7c, 0x1a801a7e
  .long 0x1a821a80, 0x1a841a82, 0x1a861a84, 0x1a881a86, 0x1a8a1a88, 0x1a8c1a8a, 0x1a8e1a8c, 0x1a901a8e
  .long 0x1a921a90, 0x1a941a92, 0x1a961a94, 0x1a981a96, 0x1a9a1a98, 0x1a9c1a9a, 0x1a9e1a9c, 0x1aa01a9e
  .long 0x1aa21aa0, 0x1aa41aa2, 0x1aa61aa4, 0x1aa81aa6, 0x1aaa1aa8, 0x1aac1aaa, 0x1aae1aac, 0x1ab01aae
  .long 0x1ab21ab0, 0x1ab41ab2, 0x1ab61ab4, 0x1ab81ab6, 0x1aba1ab8, 0x1abc1aba, 0x1abe1abc, 0x1ac01abe
  .long 0x1ac21ac0, 0x1ac41ac2, 0x1ac61ac4, 0x1ac81ac6, 0x1aca1ac8, 0x1acc1aca, 0x1ace1acc, 0x1ad01ace
  .long 0x1ad21ad0, 0x1ad41ad2, 0x1ad61ad4, 0x1ad81ad6, 0x1ada1ad8, 0x1adc1ada, 0x1ade1adc, 0x1ae01ade
  .long 0x1ae21ae0, 0x1ae41ae2, 0x1ae61ae4, 0x1ae81ae6, 0x1aea1ae8, 0x1aec1aea, 0x1aee1aec, 0x1af01aee
  .long 0x1af21af0, 0x1af41af2, 0x1af61af4, 0x1af81af6, 0x1afa1af8, 0x1afc1afa, 0x1afe1afc, 0x1b001afe
  .long 0x1b021b00, 0x1b041b02, 0x1b061b04, 0x1b081b06, 0x1b0a1b08, 0x1b0c1b0a, 0x1b0e1b0c, 0x1b101b0e
  .long 0x1b121b10, 0x1b141b12, 0x1b161b14, 0x1b181b16, 0x1b1a1b18, 0x1b1c1b1a, 0x1b1e1b1c, 0x1b201b1e
  .long 0x1b221b20, 0x1b241b22, 0x1b261b24, 0x1b281b26, 0x1b2a1b28, 0x1b2c1b2a, 0x1b2e1b2c, 0x1b301b2e
  .long 0x1b321b30, 0x1b341b32, 0x1b361b34, 0x1b381b36, 0x1b3a1b38, 0x1b3c1b3a, 0x1b3e1b3c, 0x1b401b3e
  .long 0x1b421b40, 0x1b441b42, 0x1b461b44, 0x1b481b46, 0x1b4a1b48, 0x1b4c1b4a, 0x1b4e1b4c, 0x1b501b4e
  .long 0x1b521b50, 0x1b541b52, 0x1b561b54, 0x1b581b56, 0x1b5a1b58, 0x1b5c1b5a, 0x1b5e1b5c, 0x1b601b5e
  .long 0x1b621b60, 0x1b641b62, 0x1b661b64, 0x1b681b66, 0x1b6a1b68, 0x1b6c1b6a, 0x1b6e1b6c, 0x1b701b6e
  .long 0x1b721b70, 0x1b741b72, 0x1b761b74, 0x1b781b76, 0x1b7a1b78, 0x1b7c1b7a, 0x1b7e1b7c, 0x1b801b7e
  .long 0x1b821b80, 0x1b841b82, 0x1b861b84, 0x1b881b86, 0x1b8a1b88, 0x1b8c1b8a, 0x1b8e1b8c, 0x1b901b8e
  .long 0x1b921b90, 0x1b941b92, 0x1b961b94, 0x1b981b96, 0x1b9a1b98, 0x1b9c1b9a, 0x1b9e1b9c, 0x1ba01b9e
  .long 0x1ba21ba0, 0x1ba41ba2, 0x1ba61ba4, 0x1ba81ba6, 0x1baa1ba8, 0x1bac1baa, 0x1bae1bac, 0x1bb01bae
  .long 0x1bb21bb0, 0x1bb41bb2, 0x1bb61bb4, 0x1bb81bb6, 0x1bba1bb8, 0x1bbc1bba, 0x1bbe1bbc, 0x1bc01bbe
  .long 0x1bc21bc0, 0x1bc41bc2, 0x1bc61bc4, 0x1bc81bc6, 0x1bca1bc8, 0x1bcc1bca, 0x1bce1bcc, 0x1bd01bce
  .long 0x1bd21bd0, 0x1bd41bd2, 0x1bd61bd4, 0x1bd81bd6, 0x1bda1bd8, 0x1bdc1bda, 0x1bde1bdc, 0x1be01bde
  .long 0x1be21be0, 0x1be41be2, 0x1be61be4, 0x1be81be6, 0x1bea1be8, 0x1bec1bea, 0x1bee1bec, 0x1bf01bee
  .long 0x1bf21bf0, 0x1bf41bf2, 0x1bf61bf4, 0x1bf81bf6, 0x1bfa1bf8, 0x1bfc1bfa, 0x1bfe1bfc, 0x1c001bfe
  .long 0x1c021c00, 0x1c041c02, 0x1c061c04, 0x1c081c06, 0x1c0a1c08, 0x1c0c1c0a, 0x1c0e1c0c, 0x1c101c0e
  .long 0x1c121c10, 0x1c141c12, 0x1c161c14, 0x1c181c16, 0x1c1a1c18, 0x1c1c1c1a, 0x1c1e1c1c, 0x1c201c1e
  .long 0x1c221c20, 0x1c241c22, 0x1c261c24, 0x1c281c26, 0x1c2a1c28, 0x1c2c1c2a, 0x1c2e1c2c, 0x1c301c2e
  .long 0x1c321c30, 0x1c341c32, 0x1c361c34, 0x1c381c36, 0x1c3a1c38, 0x1c3c1c3a, 0x1c3e1c3c, 0x1c401c3e
  .long 0x1c421c40, 0x1c441c42, 0x1c461c44, 0x1c481c46, 0x1c4a1c48, 0x1c4c1c4a, 0x1c4e1c4c, 0x1c501c4e
  .long 0x1c521c50, 0x1c541c52, 0x1c561c54, 0x1c581c56, 0x1c5a1c58, 0x1c5c1c5a, 0x1c5e1c5c, 0x1c601c5e
  .long 0x1c621c60, 0x1c641c62, 0x1c661c64, 0x1c681c66, 0x1c6a1c68, 0x1c6c1c6a, 0x1c6e1c6c, 0x1c701c6e
  .long 0x1c721c70, 0x1c741c72, 0x1c761c74, 0x1c781c76, 0x1c7a1c78, 0x1c7c1c7a, 0x1c7e1c7c, 0x1c801c7e
  .long 0x1c821c80, 0x1c841c82, 0x1c861c84, 0x1c881c86, 0x1c8a1c88, 0x1c8c1c8a, 0x1c8e1c8c, 0x1c901c8e
  .long 0x1c921c90, 0x1c941c92, 0x1c961c94, 0x1c981c96, 0x1c9a1c98, 0x1c9c1c9a, 0x1c9e1c9c, 0x1ca01c9e
  .long 0x1ca21ca0, 0x1ca41ca2, 0x1ca61ca4, 0x1ca81ca6, 0x1caa1ca8, 0x1cac1caa, 0x1cae1cac, 0x1cb01cae
  .long 0x1cb21cb0, 0x1cb41cb2, 0x1cb61cb4, 0x1cb81cb6, 0x1cba1cb8, 0x1cbc1cba, 0x1cbe1cbc, 0x1cc01cbe
  .long 0x1cc21cc0, 0x1cc41cc2, 0x1cc61cc4, 0x1cc81cc6, 0x1cca1cc8, 0x1ccc1cca, 0x1cce1ccc, 0x1cd01cce
  .long 0x1cd21cd0, 0x1cd41cd2, 0x1cd61cd4, 0x1cd81cd6, 0x1cda1cd8, 0x1cdc1cda, 0x1cde1cdc, 0x1ce01cde
  .long 0x1ce21ce0, 0x1ce41ce2, 0x1ce61ce4, 0x1ce81ce6, 0x1cea1ce8, 0x1cec1cea, 0x1cee1cec, 0x1cf01cee
  .long 0x1cf21cf0, 0x1cf41cf2, 0x1cf61cf4, 0x1cf81cf6, 0x1cfa1cf8, 0x1cfc1cfa, 0x1cfe1cfc, 0x1d001cfe
  .long 0x1d021d00, 0x1d041d02, 0x1d061d04, 0x1d081d06, 0x1d0a1d08, 0x1d0c1d0a, 0x1d0e1d0c, 0x1d101d0e
  .long 0x1d121d10, 0x1d141d12, 0x1d161d14, 0x1d181d16, 0x1d1a1d18, 0x1d1c1d1a, 0x1d1e1d1c, 0x1d201d1e
  .long 0x1d221d20, 0x1d241d22, 0x1d261d24, 0x1d281d26, 0x1d2a1d28, 0x1d2c1d2a, 0x1d2e1d2c, 0x1d301d2e
  .long 0x1d321d30, 0x1d341d32, 0x1d361d34, 0x1d381d36, 0x1d3a1d38, 0x1d3c1d3a, 0x1d3e1d3c, 0x1d401d3e
  .long 0x1d421d40, 0x1d441d42, 0x1d461d44, 0x1d481d46, 0x1d4a1d48, 0x1d4c1d4a, 0x1d4e1d4c, 0x1d501d4e
  .long 0x1d521d50, 0x1d541d52, 0x1d561d54, 0x1d581d56, 0x1d5a1d58, 0x1d5c1d5a, 0x1d5e1d5c, 0x1d601d5e
  .long 0x1d621d60, 0x1d641d62, 0x1d661d64, 0x1d681d66, 0x1d6a1d68, 0x1d6c1d6a, 0x1d6e1d6c, 0x1d701d6e
  .long 0x1d721d70, 0x1d741d72, 0x1d761d74, 0x1d781d76, 0x1d7a1d78, 0x1d7c1d7a, 0x1d7e1d7c, 0x1d801d7e
  .long 0x1d821d80, 0x1d841d82, 0x1d861d84, 0x1d881d86, 0x1d8a1d88, 0x1d8c1d8a, 0x1d8e1d8c, 0x1d901d8e
  .long 0x1d921d90, 0x1d941d92, 0x1d961d94, 0x1d981d96, 0x1d9a1d98, 0x1d9c1d9a, 0x1d9e1d9c, 0x1da01d9e
  .long 0x1da21da0, 0x1da41da2, 0x1da61da4, 0x1da81da6, 0x1daa1da8, 0x1dac1daa, 0x1dae1dac, 0x1db01dae
  .long 0x1db21db0, 0x1db41db2, 0x1db61db4, 0x1db81db6, 0x1dba1db8, 0x1dbc1dba, 0x1dbe1dbc, 0x1dc01dbe
  .long 0x1dc21dc0, 0x1dc41dc2, 0x1dc61dc4, 0x1dc81dc6, 0x1dca1dc8, 0x1dcc1dca, 0x1dce1dcc, 0x1dd01dce
  .long 0x1dd21dd0, 0x1dd41dd2, 0x1dd61dd4, 0x1dd81dd6, 0x1dda1dd8, 0x1ddc1dda, 0x1dde1ddc, 0x1de01dde
  .long 0x1de21de0, 0x1de41de2, 0x1de61de4, 0x1de81de6, 0x1dea1de8, 0x1dec1dea, 0x1dee1dec, 0x1df01dee
  .long 0x1df21df0, 0x1df41df2, 0x1df61df4, 0x1df81df6, 0x1dfa1df8, 0x1dfc1dfa, 0x1dfe1dfc, 0x1e001dfe
  .long 0x1e021e00, 0x1e041e02, 0x1e061e04, 0x1e081e06, 0x1e0a1e08, 0x1e0c1e0a, 0x1e0e1e0c, 0x1e101e0e
  .long 0x1e121e10, 0x1e141e12, 0x1e161e14, 0x1e181e16, 0x1e1a1e18, 0x1e1c1e1a, 0x1e1e1e1c, 0x1e201e1e
  .long 0x1e221e20, 0x1e241e22, 0x1e261e24, 0x1e281e26, 0x1e2a1e28, 0x1e2c1e2a, 0x1e2e1e2c, 0x1e301e2e
  .long 0x1e321e30, 0x1e341e32, 0x1e361e34, 0x1e381e36, 0x1e3a1e38, 0x1e3c1e3a, 0x1e3e1e3c, 0x1e401e3e
  .long 0x1e421e40, 0x1e441e42, 0x1e461e44, 0x1e481e46, 0x1e4a1e48, 0x1e4c1e4a, 0x1e4e1e4c, 0x1e501e4e
  .long 0x1e521e50, 0x1e541e52, 0x1e561e54, 0x1e581e56, 0x1e5a1e58, 0x1e5c1e5a, 0x1e5e1e5c, 0x1e601e5e
  .long 0x1e621e60, 0x1e641e62, 0x1e661e64, 0x1e681e66, 0x1e6a1e68, 0x1e6c1e6a, 0x1e6e1e6c, 0x1e701e6e
  .long 0x1e721e70, 0x1e741e72, 0x1e761e74, 0x1e781e76, 0x1e7a1e78, 0x1e7c1e7a, 0x1e7e1e7c, 0x1e801e7e
  .long 0x1e821e80, 0x1e841e82, 0x1e861e84, 0x1e881e86, 0x1e8a1e88, 0x1e8c1e8a, 0x1e8e1e8c, 0x1e901e8e
  .long 0x1e921e90, 0x1e941e92, 0x1e961e94, 0x1e981e96, 0x1e9a1e98, 0x1e9c1e9a, 0x1e9e1e9c, 0x1ea01e9e
  .long 0x1ea21ea0, 0x1ea41ea2, 0x1ea61ea4, 0x1ea81ea6, 0x1eaa1ea8, 0x1eac1eaa, 0x1eae1eac, 0x1eb01eae
  .long 0x1eb21eb0, 0x1eb41eb2, 0x1eb61eb4, 0x1eb81eb6, 0x1eba1eb8, 0x1ebc1eba, 0x1ebe1ebc, 0x1ec01ebe
  .long 0x1ec21ec0, 0x1ec41ec2, 0x1ec61ec4, 0x1ec81ec6, 0x1eca1ec8, 0x1ecc1eca, 0x1ece1ecc, 0x1ed01ece
  .long 0x1ed21ed0, 0x1ed41ed2, 0x1ed61ed4, 0x1ed81ed6, 0x1eda1ed8, 0x1edc1eda, 0x1ede1edc, 0x1ee01ede
  .long 0x1ee21ee0, 0x1ee41ee2, 0x1ee61ee4, 0x1ee81ee6, 0x1eea1ee8, 0x1eec1eea, 0x1eee1eec, 0x1ef01eee
  .long 0x1ef21ef0, 0x1ef41ef2, 0x1ef61ef4, 0x1ef81ef6, 0x1efa1ef8, 0x1efc1efa, 0x1efe1efc, 0x1f001efe
  .long 0x1f021f00, 0x1f041f02, 0x1f061f04, 0x1f081f06, 0x1f0a1f08, 0x1f0c1f0a, 0x1f0e1f0c, 0x1f101f0e
  .long 0x1f121f10, 0x1f141f12, 0x1f161f14, 0x1f181f16, 0x1f1a1f18, 0x1f1c1f1a, 0x1f1e1f1c, 0x1f201f1e
  .long 0x1f221f20, 0x1f241f22, 0x1f261f24, 0x1f281f26, 0x1f2a1f28, 0x1f2c1f2a, 0x1f2e1f2c, 0x1f301f2e
  .long 0x1f321f30, 0x1f341f32, 0x1f361f34, 0x1f381f36, 0x1f3a1f38, 0x1f3c1f3a, 0x1f3e1f3c, 0x1f401f3e
  .long 0x1f421f40, 0x1f441f42, 0x1f461f44, 0x1f481f46, 0x1f4a1f48, 0x1f4c1f4a, 0x1f4e1f4c, 0x1f501f4e
  .long 0x1f521f50, 0x1f541f52, 0x1f561f54, 0x1f581f56, 0x1f5a1f58, 0x1f5c1f5a, 0x1f5e1f5c, 0x1f601f5e
  .long 0x1f621f60, 0x1f641f62, 0x1f661f64, 0x1f681f66, 0x1f6a1f68, 0x1f6c1f6a, 0x1f6e1f6c, 0x1f701f6e
  .long 0x1f721f70, 0x1f741f72, 0x1f761f74, 0x1f781f76, 0x1f7a1f78, 0x1f7c1f7a, 0x1f7e1f7c, 0x1f801f7e
  .long 0x1f821f80, 0x1f841f82, 0x1f861f84, 0x1f881f86, 0x1f8a1f88, 0x1f8c1f8a, 0x1f8e1f8c, 0x1f901f8e
  .long 0x1f921f90, 0x1f941f92, 0x1f961f94, 0x1f981f96, 0x1f9a1f98, 0x1f9c1f9a, 0x1f9e1f9c, 0x1fa01f9e
  .long 0x1fa21fa0, 0x1fa41fa2, 0x1fa61fa4, 0x1fa81fa6, 0x1faa1fa8, 0x1fac1faa, 0x1fae1fac, 0x1fb01fae
  .long 0x1fb21fb0, 0x1fb41fb2, 0x1fb61fb4, 0x1fb81fb6, 0x1fba1fb8, 0x1fbc1fba, 0x1fbe1fbc, 0x1fc01fbe
  .long 0x1fc21fc0, 0x1fc41fc2, 0x1fc61fc4, 0x1fc81fc6, 0x1fca1fc8, 0x1fcc1fca, 0x1fce1fcc, 0x1fd01fce
  .long 0x1fd21fd0, 0x1fd41fd2, 0x1fd61fd4, 0x1fd81fd6, 0x1fda1fd8, 0x1fdc1fda, 0x1fde1fdc, 0x1fe01fde
  .long 0x1fe21fe0, 0x1fe41fe2, 0x1fe61fe4, 0x1fe81fe6, 0x1fea1fe8, 0x1fec1fea, 0x1fee1fec, 0x1ff01fee
  .long 0x1ff21ff0, 0x1ff41ff2, 0x1ff61ff4, 0x1ff81ff6, 0x1ffa1ff8, 0x1ffc1ffa, 0x1ffe1ffc, 0x20001ffe
  .long 0x20022000, 0x20042002, 0x20062004, 0x20082006, 0x200a2008, 0x200c200a, 0x200e200c, 0x2010200e
  .long 0x20122010, 0x20142012, 0x20162014, 0x20182016, 0x201a2018, 0x201c201a, 0x201e201c, 0x2020201e
  .long 0x20222020, 0x20242022, 0x20262024, 0x20282026, 0x202a2028, 0x202c202a, 0x202e202c, 0x2030202e
  .long 0x20322030, 0x20342032, 0x20362034, 0x20382036, 0x203a2038, 0x203c203a, 0x203e203c, 0x2040203e
  .long 0x20422040, 0x20442042, 0x20462044, 0x20482046, 0x204a2048, 0x204c204a, 0x204e204c, 0x2050204e
  .long 0x20522050, 0x20542052, 0x20562054, 0x20582056, 0x205a2058, 0x205c205a, 0x205e205c, 0x2060205e
  .long 0x20622060, 0x20642062, 0x20662064, 0x20682066, 0x206a2068, 0x206c206a, 0x206e206c, 0x2070206e
  .long 0x20722070, 0x20742072, 0x20762074, 0x20782076, 0x207a2078, 0x207c207a, 0x207e207c, 0x2080207e
  .long 0x20822080, 0x20842082, 0x20862084, 0x20882086, 0x208a2088, 0x208c208a, 0x208e208c, 0x2090208e
  .long 0x20922090, 0x20942092, 0x20962094, 0x20982096, 0x209a2098, 0x209c209a, 0x209e209c, 0x20a0209e
  .long 0x20a220a0, 0x20a420a2, 0x20a620a4, 0x20a820a6, 0x20aa20a8, 0x20ac20aa, 0x20ae20ac, 0x20b020ae
  .long 0x20b220b0, 0x20b420b2, 0x20b620b4, 0x20b820b6, 0x20ba20b8, 0x20bc20ba, 0x20be20bc, 0x20c020be
  .long 0x20c220c0, 0x20c420c2, 0x20c620c4, 0x20c820c6, 0x20ca20c8, 0x20cc20ca, 0x20ce20cc, 0x20d020ce
  .long 0x20d220d0, 0x20d420d2, 0x20d620d4, 0x20d820d6, 0x20da20d8, 0x20dc20da, 0x20de20dc, 0x20e020de
  .long 0x20e220e0, 0x20e420e2, 0x20e620e4, 0x20e820e6, 0x20ea20e8, 0x20ec20ea, 0x20ee20ec, 0x20f020ee
  .long 0x20f220f0, 0x20f420f2, 0x20f620f4, 0x20f820f6, 0x20fa20f8, 0x20fc20fa, 0x20fe20fc, 0x210020fe
  .long 0x21022100, 0x21042102, 0x21062104, 0x21082106, 0x210a2108, 0x210c210a, 0x210e210c, 0x2110210e
  .long 0x21122110, 0x21142112, 0x21162114, 0x21182116, 0x211a2118, 0x211c211a, 0x211e211c, 0x2120211e
  .long 0x21222120, 0x21242122, 0x21262124, 0x21282126, 0x212a2128, 0x212c212a, 0x212e212c, 0x2130212e
  .long 0x21322130, 0x21342132, 0x21362134, 0x21382136, 0x213a2138, 0x213c213a, 0x213e213c, 0x2140213e
  .long 0x21422140, 0x21442142, 0x21462144, 0x21482146, 0x214a2148, 0x214c214a, 0x214e214c, 0x2150214e
  .long 0x21522150, 0x21542152, 0x21562154, 0x21582156, 0x215a2158, 0x215c215a, 0x215e215c, 0x2160215e
  .long 0x21622160, 0x21642162, 0x21662164, 0x21682166, 0x216a2168, 0x216c216a, 0x216e216c, 0x2170216e
  .long 0x21722170, 0x21742172, 0x21762174, 0x21782176, 0x217a2178, 0x217c217a, 0x217e217c, 0x2180217e
  .long 0x21822180, 0x21842182, 0x21862184, 0x21882186, 0x218a2188, 0x218c218a, 0x218e218c, 0x2190218e
  .long 0x21922190, 0x21942192, 0x21962194, 0x21982196, 0x219a2198, 0x219c219a, 0x219e219c, 0x21a0219e
  .long 0x21a221a0, 0x21a421a2, 0x21a621a4, 0x21a821a6, 0x21aa21a8, 0x21ac21aa, 0x21ae21ac, 0x21b021ae
  .long 0x21b221b0, 0x21b421b2, 0x21b621b4, 0x21b821b6, 0x21ba21b8, 0x21bc21ba, 0x21be21bc, 0x21c021be
  .long 0x21c221c0, 0x21c421c2, 0x21c621c4, 0x21c821c6, 0x21ca21c8, 0x21cc21ca, 0x21ce21cc, 0x21d021ce
  .long 0x21d221d0, 0x21d421d2, 0x21d621d4, 0x21d821d6, 0x21da21d8, 0x21dc21da, 0x21de21dc, 0x21e021de
  .long 0x21e221e0, 0x21e421e2, 0x21e621e4, 0x21e821e6, 0x21ea21e8, 0x21ec21ea, 0x21ee21ec, 0x21f021ee
  .long 0x21f221f0, 0x21f421f2, 0x21f621f4, 0x21f821f6, 0x21fa21f8, 0x21fc21fa, 0x21fe21fc, 0x220021fe
  .long 0x22022200, 0x22042202, 0x22062204, 0x22082206, 0x220a2208, 0x220c220a, 0x220e220c, 0x2210220e
  .long 0x22122210, 0x22142212, 0x22162214, 0x22182216, 0x221a2218, 0x221c221a, 0x221e221c, 0x2220221e
  .long 0x22222220, 0x22242222, 0x22262224, 0x22282226, 0x222a2228, 0x222c222a, 0x222e222c, 0x2230222e
  .long 0x22322230, 0x22342232, 0x22362234, 0x22382236, 0x223a2238, 0x223c223a, 0x223e223c, 0x2240223e
  .long 0x22422240, 0x22442242, 0x22462244, 0x22482246, 0x224a2248, 0x224c224a, 0x224e224c, 0x2250224e
  .long 0x22522250, 0x22542252, 0x22562254, 0x22582256, 0x225a2258, 0x225c225a, 0x225e225c, 0x2260225e
  .long 0x22622260, 0x22642262, 0x22662264, 0x22682266, 0x226a2268, 0x226c226a, 0x226e226c, 0x2270226e
  .long 0x22722270, 0x22742272, 0x22762274, 0x22782276, 0x227a2278, 0x227c227a, 0x227e227c, 0x2280227e
  .long 0x22822280, 0x22842282, 0x22862284, 0x22882286, 0x228a2288, 0x228c228a, 0x228e228c, 0x2290228e
  .long 0x22922290, 0x22942292, 0x22962294, 0x22982296, 0x229a2298, 0x229c229a, 0x229e229c, 0x22a0229e
  .long 0x22a222a0, 0x22a422a2, 0x22a622a4, 0x22a822a6, 0x22aa22a8, 0x22ac22aa, 0x22ae22ac, 0x22b022ae
  .long 0x22b222b0, 0x22b422b2, 0x22b622b4, 0x22b822b6, 0x22ba22b8, 0x22bc22ba, 0x22be22bc, 0x22c022be
  .long 0x22c222c0, 0x22c422c2, 0x22c622c4, 0x22c822c6, 0x22ca22c8, 0x22cc22ca, 0x22ce22cc, 0x22d022ce
  .long 0x22d222d0, 0x22d422d2, 0x22d622d4, 0x22d822d6, 0x22da22d8, 0x22dc22da, 0x22de22dc, 0x22e022de
  .long 0x22e222e0, 0x22e422e2, 0x22e622e4, 0x22e822e6, 0x22ea22e8, 0x22ec22ea, 0x22ee22ec, 0x22f022ee
  .long 0x22f222f0, 0x22f422f2, 0x22f622f4, 0x22f822f6, 0x22fa22f8, 0x22fc22fa, 0x22fe22fc, 0x230022fe
  .long 0x23022300, 0x23042302, 0x23062304, 0x23082306, 0x230a2308, 0x230c230a, 0x230e230c, 0x2310230e
  .long 0x23122310, 0x23142312, 0x23162314, 0x23182316, 0x231a2318, 0x231c231a, 0x231e231c, 0x2320231e
  .long 0x23222320, 0x23242322, 0x23262324, 0x23282326, 0x232a2328, 0x232c232a, 0x232e232c, 0x2330232e
  .long 0x23322330, 0x23342332, 0x23362334, 0x23382336, 0x233a2338, 0x233c233a, 0x233e233c, 0x2340233e
  .long 0x23422340, 0x23442342, 0x23462344, 0x23482346, 0x234a2348, 0x234c234a, 0x234e234c, 0x2350234e
  .long 0x23522350, 0x23542352, 0x23562354, 0x23582356, 0x235a2358, 0x235c235a, 0x235e235c, 0x2360235e
  .long 0x23622360, 0x23642362, 0x23662364, 0x23682366, 0x236a2368, 0x236c236a, 0x236e236c, 0x2370236e
  .long 0x23722370, 0x23742372, 0x23762374, 0x23782376, 0x237a2378, 0x237c237a, 0x237e237c, 0x2380237e
  .long 0x23822380, 0x23842382, 0x23862384, 0x23882386, 0x238a2388, 0x238c238a, 0x238e238c, 0x2390238e
  .long 0x23922390, 0x23942392, 0x23962394, 0x23982396, 0x239a2398, 0x239c239a, 0x239e239c, 0x23a0239e
  .long 0x23a223a0, 0x23a423a2, 0x23a623a4, 0x23a823a6, 0x23aa23a8, 0x23ac23aa, 0x23ae23ac, 0x23b023ae
  .long 0x23b223b0, 0x23b423b2, 0x23b623b4, 0x23b823b6, 0x23ba23b8, 0x23bc23ba, 0x23be23bc, 0x23c023be
  .long 0x23c223c0, 0x23c423c2, 0x23c623c4, 0x23c823c6, 0x23ca23c8, 0x23cc23ca, 0x23ce23cc, 0x23d023ce
  .long 0x23d223d0, 0x23d423d2, 0x23d623d4, 0x23d823d6, 0x23da23d8, 0x23dc23da, 0x23de23dc, 0x23e023de
  .long 0x23e223e0, 0x23e423e2, 0x23e623e4, 0x23e823e6, 0x23ea23e8, 0x23ec23ea, 0x23ee23ec, 0x23f023ee
  .long 0x23f223f0, 0x23f423f2, 0x23f623f4, 0x23f823f6, 0x23fa23f8, 0x23fc23fa, 0x23fe23fc, 0x240023fe
  .long 0x24022400, 0x24042402, 0x24062404, 0x24082406, 0x240a2408, 0x240c240a, 0x240e240c, 0x2410240e
  .long 0x24122410, 0x24142412, 0x24162414, 0x24182416, 0x241a2418, 0x241c241a, 0x241e241c, 0x2420241e
  .long 0x24222420, 0x24242422, 0x24262424, 0x24282426, 0x242a2428, 0x242c242a, 0x242e242c, 0x2430242e
  .long 0x24322430, 0x24342432, 0x24362434, 0x24382436, 0x243a2438, 0x243c243a, 0x243e243c, 0x2440243e
  .long 0x24422440, 0x24442442, 0x24462444, 0x24482446, 0x244a2448, 0x244c244a, 0x244e244c, 0x2450244e
  .long 0x24522450, 0x24542452, 0x24562454, 0x24582456, 0x245a2458, 0x245c245a, 0x245e245c, 0x2460245e
  .long 0x24622460, 0x24642462, 0x24662464, 0x24682466, 0x246a2468, 0x246c246a, 0x246e246c, 0x2470246e
  .long 0x24722470, 0x24742472, 0x24762474, 0x24782476, 0x247a2478, 0x247c247a, 0x247e247c, 0x2480247e
  .long 0x24822480, 0x24842482, 0x24862484, 0x24882486, 0x248a2488, 0x248c248a, 0x248e248c, 0x2490248e
  .long 0x24922490, 0x24942492, 0x24962494, 0x24982496, 0x249a2498, 0x249c249a, 0x249e249c, 0x24a0249e
  .long 0x24a224a0, 0x24a424a2, 0x24a624a4, 0x24a824a6, 0x24aa24a8, 0x24ac24aa, 0x24ae24ac, 0x24b024ae
  .long 0x24b224b0, 0x24b424b2, 0x24b624b4, 0x24b824b6, 0x24ba24b8, 0x24bc24ba, 0x24be24bc, 0x24c024be
  .long 0x24c224c0, 0x24c424c2, 0x24c624c4, 0x24c824c6, 0x24ca24c8, 0x24cc24ca, 0x24ce24cc, 0x24d024ce
  .long 0x24d224d0, 0x24d424d2, 0x24d624d4, 0x24d824d6, 0x24da24d8, 0x24dc24da, 0x24de24dc, 0x24e024de
  .long 0x24e224e0, 0x24e424e2, 0x24e624e4, 0x24e824e6, 0x24ea24e8, 0x24ec24ea, 0x24ee24ec, 0x24f024ee
  .long 0x24f224f0, 0x24f424f2, 0x24f624f4, 0x24f824f6, 0x24fa24f8, 0x24fc24fa, 0x24fe24fc, 0x250024fe
  .long 0x25022500, 0x25042502, 0x25062504, 0x25082506, 0x250a2508, 0x250c250a, 0x250e250c, 0x2510250e
  .long 0x25122510, 0x25142512, 0x25162514, 0x25182516, 0x251a2518, 0x251c251a, 0x251e251c, 0x2520251e
  .long 0x25222520, 0x25242522, 0x25262524, 0x25282526, 0x252a2528, 0x252c252a, 0x252e252c, 0x2530252e
  .long 0x25322530, 0x25342532, 0x25362534, 0x25382536, 0x253a2538, 0x253c253a, 0x253e253c, 0x2540253e
  .long 0x25422540, 0x25442542, 0x25462544, 0x25482546, 0x254a2548, 0x254c254a, 0x254e254c, 0x2550254e
  .long 0x25522550, 0x25542552, 0x25562554, 0x25582556, 0x255a2558, 0x255c255a, 0x255e255c, 0x2560255e
  .long 0x25622560, 0x25642562, 0x25662564, 0x25682566, 0x256a2568, 0x256c256a, 0x256e256c, 0x2570256e
  .long 0x25722570, 0x25742572, 0x25762574, 0x25782576, 0x257a2578, 0x257c257a, 0x257e257c, 0x2580257e
  .long 0x25822580, 0x25842582, 0x25862584, 0x25882586, 0x258a2588, 0x258c258a, 0x258e258c, 0x2590258e
  .long 0x25922590, 0x25942592, 0x25962594, 0x25982596, 0x259a2598, 0x259c259a, 0x259e259c, 0x25a0259e
  .long 0x25a225a0, 0x25a425a2, 0x25a625a4, 0x25a825a6, 0x25aa25a8, 0x25ac25aa, 0x25ae25ac, 0x25b025ae
  .long 0x25b225b0, 0x25b425b2, 0x25b625b4, 0x25b825b6, 0x25ba25b8, 0x25bc25ba, 0x25be25bc, 0x25c025be
  .long 0x25c225c0, 0x25c425c2, 0x25c625c4, 0x25c825c6, 0x25ca25c8, 0x25cc25ca, 0x25ce25cc, 0x25d025ce
  .long 0x25d225d0, 0x25d425d2, 0x25d625d4, 0x25d825d6, 0x25da25d8, 0x25dc25da, 0x25de25dc, 0x25e025de
  .long 0x25e225e0, 0x25e425e2, 0x25e625e4, 0x25e825e6, 0x25ea25e8, 0x25ec25ea, 0x25ee25ec, 0x25f025ee
  .long 0x25f225f0, 0x25f425f2, 0x25f625f4, 0x25f825f6, 0x25fa25f8, 0x25fc25fa, 0x25fe25fc, 0x260025fe
  .long 0x26022600, 0x26042602, 0x26062604, 0x26082606, 0x260a2608, 0x260c260a, 0x260e260c, 0x2610260e
  .long 0x26122610, 0x26142612, 0x26162614, 0x26182616, 0x261a2618, 0x261c261a, 0x261e261c, 0x2620261e
  .long 0x26222620, 0x26242622, 0x26262624, 0x26282626, 0x262a2628, 0x262c262a, 0x262e262c, 0x2630262e
  .long 0x26322630, 0x26342632, 0x26362634, 0x26382636, 0x263a2638, 0x263c263a, 0x263e263c, 0x2640263e
  .long 0x26422640, 0x26442642, 0x26462644, 0x26482646, 0x264a2648, 0x264c264a, 0x264e264c, 0x2650264e
  .long 0x26522650, 0x26542652, 0x26562654, 0x26582656, 0x265a2658, 0x265c265a, 0x265e265c, 0x2660265e
  .long 0x26622660, 0x26642662, 0x26662664, 0x26682666, 0x266a2668, 0x266c266a, 0x266e266c, 0x2670266e
  .long 0x26722670, 0x26742672, 0x26762674, 0x26782676, 0x267a2678, 0x267c267a, 0x267e267c, 0x2680267e
  .long 0x26822680, 0x26842682, 0x26862684, 0x26882686, 0x268a2688, 0x268c268a, 0x268e268c, 0x2690268e
  .long 0x26922690, 0x26942692, 0x26962694, 0x26982696, 0x269a2698, 0x269c269a, 0x269e269c, 0x26a0269e
  .long 0x26a226a0, 0x26a426a2, 0x26a626a4, 0x26a826a6, 0x26aa26a8, 0x26ac26aa, 0x26ae26ac, 0x26b026ae
  .long 0x26b226b0, 0x26b426b2, 0x26b626b4, 0x26b826b6, 0x26ba26b8, 0x26bc26ba, 0x26be26bc, 0x26c026be
  .long 0x26c226c0, 0x26c426c2, 0x26c626c4, 0x26c826c6, 0x26ca26c8, 0x26cc26ca, 0x26ce26cc, 0x26d026ce
  .long 0x26d226d0, 0x26d426d2, 0x26d626d4, 0x26d826d6, 0x26da26d8, 0x26dc26da, 0x26de26dc, 0x26e026de
  .long 0x26e226e0, 0x26e426e2, 0x26e626e4, 0x26e826e6, 0x26ea26e8, 0x26ec26ea, 0x26ee26ec, 0x26f026ee
  .long 0x26f226f0, 0x26f426f2, 0x26f626f4, 0x26f826f6, 0x26fa26f8, 0x26fc26fa, 0x26fe26fc, 0x270026fe
  .long 0x27022700, 0x27042702, 0x27062704, 0x27082706, 0x270a2708, 0x270c270a, 0x270e270c, 0x2710270e
  .long 0x27122710, 0x27142712, 0x27162714, 0x27182716, 0x271a2718, 0x271c271a, 0x271e271c, 0x2720271e
  .long 0x27222720, 0x27242722, 0x27262724, 0x27282726, 0x272a2728, 0x272c272a, 0x272e272c, 0x2730272e
  .long 0x27322730, 0x27342732, 0x27362734, 0x27382736, 0x273a2738, 0x273c273a, 0x273e273c, 0x2740273e
  .long 0x27422740, 0x27442742, 0x27462744, 0x27482746, 0x274a2748, 0x274c274a, 0x274e274c, 0x2750274e
  .long 0x27522750, 0x27542752, 0x27562754, 0x27582756, 0x275a2758, 0x275c275a, 0x275e275c, 0x2760275e
  .long 0x27622760, 0x27642762, 0x27662764, 0x27682766, 0x276a2768, 0x276c276a, 0x276e276c, 0x2770276e
  .long 0x27722770, 0x27742772, 0x27762774, 0x27782776, 0x277a2778, 0x277c277a, 0x277e277c, 0x2780277e
  .long 0x27822780, 0x27842782, 0x27862784, 0x27882786, 0x278a2788, 0x278c278a, 0x278e278c, 0x2790278e
  .long 0x27922790, 0x27942792, 0x27962794, 0x27982796, 0x279a2798, 0x279c279a, 0x279e279c, 0x27a0279e
  .long 0x27a227a0, 0x27a427a2, 0x27a627a4, 0x27a827a6, 0x27aa27a8, 0x27ac27aa, 0x27ae27ac, 0x27b027ae
  .long 0x27b227b0, 0x27b427b2, 0x27b627b4, 0x27b827b6, 0x27ba27b8, 0x27bc27ba, 0x27be27bc, 0x27c027be
  .long 0x27c227c0, 0x27c427c2, 0x27c627c4, 0x27c827c6, 0x27ca27c8, 0x27cc27ca, 0x27ce27cc, 0x27d027ce
  .long 0x27d227d0, 0x27d427d2, 0x27d627d4, 0x27d827d6, 0x27da27d8, 0x27dc27da, 0x27de27dc, 0x27e027de
  .long 0x27e227e0, 0x27e427e2, 0x27e627e4, 0x27e827e6, 0x27ea27e8, 0x27ec27ea, 0x27ee27ec, 0x27f027ee
  .long 0x27f227f0, 0x27f427f2, 0x27f627f4, 0x27f827f6, 0x27fa27f8, 0x27fc27fa, 0x27fe27fc, 0x280027fe
  .long 0x28022800, 0x28042802, 0x28062804, 0x28082806, 0x280a2808, 0x280c280a, 0x280e280c, 0x2810280e
  .long 0x28122810, 0x28142812, 0x28162814, 0x28182816, 0x281a2818, 0x281c281a, 0x281e281c, 0x2820281e
  .long 0x28222820, 0x28242822, 0x28262824, 0x28282826, 0x282a2828, 0x282c282a, 0x282e282c, 0x2830282e
  .long 0x28322830, 0x28342832, 0x28362834, 0x28382836, 0x283a2838, 0x283c283a, 0x283e283c, 0x2840283e
  .long 0x28422840, 0x28442842, 0x28462844, 0x28482846, 0x284a2848, 0x284c284a, 0x284e284c, 0x2850284e
  .long 0x28522850, 0x28542852, 0x28562854, 0x28582856, 0x285a2858, 0x285c285a, 0x285e285c, 0x2860285e
  .long 0x28622860, 0x28642862, 0x28662864, 0x28682866, 0x286a2868, 0x286c286a, 0x286e286c, 0x2870286e
  .long 0x28722870, 0x28742872, 0x28762874, 0x28782876, 0x287a2878, 0x287c287a, 0x287e287c, 0x2880287e
  .long 0x28822880, 0x28842882, 0x28862884, 0x28882886, 0x288a2888, 0x288c288a, 0x288e288c, 0x2890288e
  .long 0x28922890, 0x28942892, 0x28962894, 0x28982896, 0x289a2898, 0x289c289a, 0x289e289c, 0x28a0289e
  .long 0x28a228a0, 0x28a428a2, 0x28a628a4, 0x28a828a6, 0x28aa28a8, 0x28ac28aa, 0x28ae28ac, 0x28b028ae
  .long 0x28b228b0, 0x28b428b2, 0x28b628b4, 0x28b828b6, 0x28ba28b8, 0x28bc28ba, 0x28be28bc, 0x28c028be
  .long 0x28c228c0, 0x28c428c2, 0x28c628c4, 0x28c828c6, 0x28ca28c8, 0x28cc28ca, 0x28ce28cc, 0x28d028ce
  .long 0x28d228d0, 0x28d428d2, 0x28d628d4, 0x28d828d6, 0x28da28d8, 0x28dc28da, 0x28de28dc, 0x28e028de
  .long 0x28e228e0, 0x28e428e2, 0x28e628e4, 0x28e828e6, 0x28ea28e8, 0x28ec28ea, 0x28ee28ec, 0x28f028ee
  .long 0x28f228f0, 0x28f428f2, 0x28f628f4, 0x28f828f6, 0x28fa28f8, 0x28fc28fa, 0x28fe28fc, 0x290028fe
  .long 0x29022900, 0x29042902, 0x29062904, 0x29082906, 0x290a2908, 0x290c290a, 0x290e290c, 0x2910290e
  .long 0x29122910, 0x29142912, 0x29162914, 0x29182916, 0x291a2918, 0x291c291a, 0x291e291c, 0x2920291e
  .long 0x29222920, 0x29242922, 0x29262924, 0x29282926, 0x292a2928, 0x292c292a, 0x292e292c, 0x2930292e
  .long 0x29322930, 0x29342932, 0x29362934, 0x29382936, 0x293a2938, 0x293c293a, 0x293e293c, 0x2940293e
  .long 0x29422940, 0x29442942, 0x29462944, 0x29482946, 0x294a2948, 0x294c294a, 0x294e294c, 0x2950294e
  .long 0x29522950, 0x29542952, 0x29562954, 0x29582956, 0x295a2958, 0x295c295a, 0x295e295c, 0x2960295e
  .long 0x29622960, 0x29642962, 0x29662964, 0x29682966, 0x296a2968, 0x296c296a, 0x296e296c, 0x2970296e
  .long 0x29722970, 0x29742972, 0x29762974, 0x29782976, 0x297a2978, 0x297c297a, 0x297e297c, 0x2980297e
  .long 0x29822980, 0x29842982, 0x29862984, 0x29882986, 0x298a2988, 0x298c298a, 0x298e298c, 0x2990298e
  .long 0x29922990, 0x29942992, 0x29962994, 0x29982996, 0x299a2998, 0x299c299a, 0x299e299c, 0x29a0299e
  .long 0x29a229a0, 0x29a429a2, 0x29a629a4, 0x29a829a6, 0x29aa29a8, 0x29ac29aa, 0x29ae29ac, 0x29b029ae
  .long 0x29b229b0, 0x29b429b2, 0x29b629b4, 0x29b829b6, 0x29ba29b8, 0x29bc29ba, 0x29be29bc, 0x29c029be
  .long 0x29c229c0, 0x29c429c2, 0x29c629c4, 0x29c829c6, 0x29ca29c8, 0x29cc29ca, 0x29ce29cc, 0x29d029ce
  .long 0x29d229d0, 0x29d429d2, 0x29d629d4, 0x29d829d6, 0x29da29d8, 0x29dc29da, 0x29de29dc, 0x29e029de
  .long 0x29e229e0, 0x29e429e2, 0x29e629e4, 0x29e829e6, 0x29ea29e8, 0x29ec29ea, 0x29ee29ec, 0x29f029ee
  .long 0x29f229f0, 0x29f429f2, 0x29f629f4, 0x29f829f6, 0x29fa29f8, 0x29fc29fa, 0x29fe29fc, 0x2a0029fe
  .long 0x2a022a00, 0x2a042a02, 0x2a062a04, 0x2a082a06, 0x2a0a2a08, 0x2a0c2a0a, 0x2a0e2a0c, 0x2a102a0e
  .long 0x2a122a10, 0x2a142a12, 0x2a162a14, 0x2a182a16, 0x2a1a2a18, 0x2a1c2a1a, 0x2a1e2a1c, 0x2a202a1e
  .long 0x2a222a20, 0x2a242a22, 0x2a262a24, 0x2a282a26, 0x2a2a2a28, 0x2a2c2a2a, 0x2a2e2a2c, 0x2a302a2e
  .long 0x2a322a30, 0x2a342a32, 0x2a362a34, 0x2a382a36, 0x2a3a2a38, 0x2a3c2a3a, 0x2a3e2a3c, 0x2a402a3e
  .long 0x2a422a40, 0x2a442a42, 0x2a462a44, 0x2a482a46, 0x2a4a2a48, 0x2a4c2a4a, 0x2a4e2a4c, 0x2a502a4e
  .long 0x2a522a50, 0x2a542a52, 0x2a562a54, 0x2a582a56, 0x2a5a2a58, 0x2a5c2a5a, 0x2a5e2a5c, 0x2a602a5e
  .long 0x2a622a60, 0x2a642a62, 0x2a662a64, 0x2a682a66, 0x2a6a2a68, 0x2a6c2a6a, 0x2a6e2a6c, 0x2a702a6e
  .long 0x2a722a70, 0x2a742a72, 0x2a762a74, 0x2a782a76, 0x2a7a2a78, 0x2a7c2a7a, 0x2a7e2a7c, 0x2a802a7e
  .long 0x2a822a80, 0x2a842a82, 0x2a862a84, 0x2a882a86, 0x2a8a2a88, 0x2a8c2a8a, 0x2a8e2a8c, 0x2a902a8e
  .long 0x2a922a90, 0x2a942a92, 0x2a962a94, 0x2a982a96, 0x2a9a2a98, 0x2a9c2a9a, 0x2a9e2a9c, 0x2aa02a9e
  .long 0x2aa22aa0, 0x2aa42aa2, 0x2aa62aa4, 0x2aa82aa6, 0x2aaa2aa8, 0x2aac2aaa, 0x2aae2aac, 0x2ab02aae
  .long 0x2ab22ab0, 0x2ab42ab2, 0x2ab62ab4, 0x2ab82ab6, 0x2aba2ab8, 0x2abc2aba, 0x2abe2abc, 0x2ac02abe
  .long 0x2ac22ac0, 0x2ac42ac2, 0x2ac62ac4, 0x2ac82ac6, 0x2aca2ac8, 0x2acc2aca, 0x2ace2acc, 0x2ad02ace
  .long 0x2ad22ad0, 0x2ad42ad2, 0x2ad62ad4, 0x2ad82ad6, 0x2ada2ad8, 0x2adc2ada, 0x2ade2adc, 0x2ae02ade
  .long 0x2ae22ae0, 0x2ae42ae2, 0x2ae62ae4, 0x2ae82ae6, 0x2aea2ae8, 0x2aec2aea, 0x2aee2aec, 0x2af02aee
  .long 0x2af22af0, 0x2af42af2, 0x2af62af4, 0x2af82af6, 0x2afa2af8, 0x2afc2afa, 0x2afe2afc, 0x2b002afe
  .long 0x2b022b00, 0x2b042b02, 0x2b062b04, 0x2b082b06, 0x2b0a2b08, 0x2b0c2b0a, 0x2b0e2b0c, 0x2b102b0e
  .long 0x2b122b10, 0x2b142b12, 0x2b162b14, 0x2b182b16, 0x2b1a2b18, 0x2b1c2b1a, 0x2b1e2b1c, 0x2b202b1e
  .long 0x2b222b20, 0x2b242b22, 0x2b262b24, 0x2b282b26, 0x2b2a2b28, 0x2b2c2b2a, 0x2b2e2b2c, 0x2b302b2e
  .long 0x2b322b30, 0x2b342b32, 0x2b362b34, 0x2b382b36, 0x2b3a2b38, 0x2b3c2b3a, 0x2b3e2b3c, 0x2b402b3e
  .long 0x2b422b40, 0x2b442b42, 0x2b462b44, 0x2b482b46, 0x2b4a2b48, 0x2b4c2b4a, 0x2b4e2b4c, 0x2b502b4e
  .long 0x2b522b50, 0x2b542b52, 0x2b562b54, 0x2b582b56, 0x2b5a2b58, 0x2b5c2b5a, 0x2b5e2b5c, 0x2b602b5e
  .long 0x2b622b60, 0x2b642b62, 0x2b662b64, 0x2b682b66, 0x2b6a2b68, 0x2b6c2b6a, 0x2b6e2b6c, 0x2b702b6e
  .long 0x2b722b70, 0x2b742b72, 0x2b762b74, 0x2b782b76, 0x2b7a2b78, 0x2b7c2b7a, 0x2b7e2b7c, 0x2b802b7e
  .long 0x2b822b80, 0x2b842b82, 0x2b862b84, 0x2b882b86, 0x2b8a2b88, 0x2b8c2b8a, 0x2b8e2b8c, 0x2b902b8e
  .long 0x2b922b90, 0x2b942b92, 0x2b962b94, 0x2b982b96, 0x2b9a2b98, 0x2b9c2b9a, 0x2b9e2b9c, 0x2ba02b9e
  .long 0x2ba22ba0, 0x2ba42ba2, 0x2ba62ba4, 0x2ba82ba6, 0x2baa2ba8, 0x2bac2baa, 0x2bae2bac, 0x2bb02bae
  .long 0x2bb22bb0, 0x2bb42bb2, 0x2bb62bb4, 0x2bb82bb6, 0x2bba2bb8, 0x2bbc2bba, 0x2bbe2bbc, 0x2bc02bbe
  .long 0x2bc22bc0, 0x2bc42bc2, 0x2bc62bc4, 0x2bc82bc6, 0x2bca2bc8, 0x2bcc2bca, 0x2bce2bcc, 0x2bd02bce
  .long 0x2bd22bd0, 0x2bd42bd2, 0x2bd62bd4, 0x2bd82bd6, 0x2bda2bd8, 0x2bdc2bda, 0x2bde2bdc, 0x2be02bde
  .long 0x2be22be0, 0x2be42be2, 0x2be62be4, 0x2be82be6, 0x2bea2be8, 0x2bec2bea, 0x2bee2bec, 0x2bf02bee
  .long 0x2bf22bf0, 0x2bf42bf2, 0x2bf62bf4, 0x2bf82bf6, 0x2bfa2bf8, 0x2bfc2bfa, 0x2bfe2bfc, 0x2c002bfe
  .long 0x2c022c00, 0x2c042c02, 0x2c062c04, 0x2c082c06, 0x2c0a2c08, 0x2c0c2c0a, 0x2c0e2c0c, 0x2c102c0e
  .long 0x2c122c10, 0x2c142c12, 0x2c162c14, 0x2c182c16, 0x2c1a2c18, 0x2c1c2c1a, 0x2c1e2c1c, 0x2c202c1e
  .long 0x2c222c20, 0x2c242c22, 0x2c262c24, 0x2c282c26, 0x2c2a2c28, 0x2c2c2c2a, 0x2c2e2c2c, 0x2c302c2e
  .long 0x2c322c30, 0x2c342c32, 0x2c362c34, 0x2c382c36, 0x2c3a2c38, 0x2c3c2c3a, 0x2c3e2c3c, 0x2c402c3e
  .long 0x2c422c40, 0x2c442c42, 0x2c462c44, 0x2c482c46, 0x2c4a2c48, 0x2c4c2c4a, 0x2c4e2c4c, 0x2c502c4e
  .long 0x2c522c50, 0x2c542c52, 0x2c562c54, 0x2c582c56, 0x2c5a2c58, 0x2c5c2c5a, 0x2c5e2c5c, 0x2c602c5e
  .long 0x2c622c60, 0x2c642c62, 0x2c662c64, 0x2c682c66, 0x2c6a2c68, 0x2c6c2c6a, 0x2c6e2c6c, 0x2c702c6e
  .long 0x2c722c70, 0x2c742c72, 0x2c762c74, 0x2c782c76, 0x2c7a2c78, 0x2c7c2c7a, 0x2c7e2c7c, 0x2c802c7e
  .long 0x2c822c80, 0x2c842c82, 0x2c862c84, 0x2c882c86, 0x2c8a2c88, 0x2c8c2c8a, 0x2c8e2c8c, 0x2c902c8e
  .long 0x2c922c90, 0x2c942c92, 0x2c962c94, 0x2c982c96, 0x2c9a2c98, 0x2c9c2c9a, 0x2c9e2c9c, 0x2ca02c9e
  .long 0x2ca22ca0, 0x2ca42ca2, 0x2ca62ca4, 0x2ca82ca6, 0x2caa2ca8, 0x2cac2caa, 0x2cae2cac, 0x2cb02cae
  .long 0x2cb22cb0, 0x2cb42cb2, 0x2cb62cb4, 0x2cb82cb6, 0x2cba2cb8, 0x2cbc2cba, 0x2cbe2cbc, 0x2cc02cbe
  .long 0x2cc22cc0, 0x2cc42cc2, 0x2cc62cc4, 0x2cc82cc6, 0x2cca2cc8, 0x2ccc2cca, 0x2cce2ccc, 0x2cd02cce
  .long 0x2cd22cd0, 0x2cd42cd2, 0x2cd62cd4, 0x2cd82cd6, 0x2cda2cd8, 0x2cdc2cda, 0x2cde2cdc, 0x2ce02cde
  .long 0x2ce22ce0, 0x2ce42ce2, 0x2ce62ce4, 0x2ce82ce6, 0x2cea2ce8, 0x2cec2cea, 0x2cee2cec, 0x2cf02cee
  .long 0x2cf22cf0, 0x2cf42cf2, 0x2cf62cf4, 0x2cf82cf6, 0x2cfa2cf8, 0x2cfc2cfa, 0x2cfe2cfc, 0x2d002cfe
  .long 0x2d022d00, 0x2d042d02, 0x2d062d04, 0x2d082d06, 0x2d0a2d08, 0x2d0c2d0a, 0x2d0e2d0c, 0x2d102d0e
  .long 0x2d122d10, 0x2d142d12, 0x2d162d14, 0x2d182d16, 0x2d1a2d18, 0x2d1c2d1a, 0x2d1e2d1c, 0x2d202d1e
  .long 0x2d222d20, 0x2d242d22, 0x2d262d24, 0x2d282d26, 0x2d2a2d28, 0x2d2c2d2a, 0x2d2e2d2c, 0x2d302d2e
  .long 0x2d322d30, 0x2d342d32, 0x2d362d34, 0x2d382d36, 0x2d3a2d38, 0x2d3c2d3a, 0x2d3e2d3c, 0x2d402d3e
  .long 0x2d422d40, 0x2d442d42, 0x2d462d44, 0x2d482d46, 0x2d4a2d48, 0x2d4c2d4a, 0x2d4e2d4c, 0x2d502d4e
  .long 0x2d522d50, 0x2d542d52, 0x2d562d54, 0x2d582d56, 0x2d5a2d58, 0x2d5c2d5a, 0x2d5e2d5c, 0x2d602d5e
  .long 0x2d622d60, 0x2d642d62, 0x2d662d64, 0x2d682d66, 0x2d6a2d68, 0x2d6c2d6a, 0x2d6e2d6c, 0x2d702d6e
  .long 0x2d722d70, 0x2d742d72, 0x2d762d74, 0x2d782d76, 0x2d7a2d78, 0x2d7c2d7a, 0x2d7e2d7c, 0x2d802d7e
  .long 0x2d822d80, 0x2d842d82, 0x2d862d84, 0x2d882d86, 0x2d8a2d88, 0x2d8c2d8a, 0x2d8e2d8c, 0x2d902d8e
  .long 0x2d922d90, 0x2d942d92, 0x2d962d94, 0x2d982d96, 0x2d9a2d98, 0x2d9c2d9a, 0x2d9e2d9c, 0x2da02d9e
  .long 0x2da22da0, 0x2da42da2, 0x2da62da4, 0x2da82da6, 0x2daa2da8, 0x2dac2daa, 0x2dae2dac, 0x2db02dae
  .long 0x2db22db0, 0x2db42db2, 0x2db62db4, 0x2db82db6, 0x2dba2db8, 0x2dbc2dba, 0x2dbe2dbc, 0x2dc02dbe
  .long 0x2dc22dc0, 0x2dc42dc2, 0x2dc62dc4, 0x2dc82dc6, 0x2dca2dc8, 0x2dcc2dca, 0x2dce2dcc, 0x2dd02dce
  .long 0x2dd22dd0, 0x2dd42dd2, 0x2dd62dd4, 0x2dd82dd6, 0x2dda2dd8, 0x2ddc2dda, 0x2dde2ddc, 0x2de02dde
  .long 0x2de22de0, 0x2de42de2, 0x2de62de4, 0x2de82de6, 0x2dea2de8, 0x2dec2dea, 0x2dee2dec, 0x2df02dee
  .long 0x2df22df0, 0x2df42df2, 0x2df62df4, 0x2df82df6, 0x2dfa2df8, 0x2dfc2dfa, 0x2dfe2dfc, 0x2e002dfe
  .long 0x2e022e00, 0x2e042e02, 0x2e062e04, 0x2e082e06, 0x2e0a2e08, 0x2e0c2e0a, 0x2e0e2e0c, 0x2e102e0e
  .long 0x2e122e10, 0x2e142e12, 0x2e162e14, 0x2e182e16, 0x2e1a2e18, 0x2e1c2e1a, 0x2e1e2e1c, 0x2e202e1e
  .long 0x2e222e20, 0x2e242e22, 0x2e262e24, 0x2e282e26, 0x2e2a2e28, 0x2e2c2e2a, 0x2e2e2e2c, 0x2e302e2e
  .long 0x2e322e30, 0x2e342e32, 0x2e362e34, 0x2e382e36, 0x2e3a2e38, 0x2e3c2e3a, 0x2e3e2e3c, 0x2e402e3e
  .long 0x2e422e40, 0x2e442e42, 0x2e462e44, 0x2e482e46, 0x2e4a2e48, 0x2e4c2e4a, 0x2e4e2e4c, 0x2e502e4e
  .long 0x2e522e50, 0x2e542e52, 0x2e562e54, 0x2e582e56, 0x2e5a2e58, 0x2e5c2e5a, 0x2e5e2e5c, 0x2e602e5e
  .long 0x2e622e60, 0x2e642e62, 0x2e662e64, 0x2e682e66, 0x2e6a2e68, 0x2e6c2e6a, 0x2e6e2e6c, 0x2e702e6e
  .long 0x2e722e70, 0x2e742e72, 0x2e762e74, 0x2e782e76, 0x2e7a2e78, 0x2e7c2e7a, 0x2e7e2e7c, 0x2e802e7e
  .long 0x2e822e80, 0x2e842e82, 0x2e862e84, 0x2e882e86, 0x2e8a2e88, 0x2e8c2e8a, 0x2e8e2e8c, 0x2e902e8e
  .long 0x2e922e90, 0x2e942e92, 0x2e962e94, 0x2e982e96, 0x2e9a2e98, 0x2e9c2e9a, 0x2e9e2e9c, 0x2ea02e9e
  .long 0x2ea22ea0, 0x2ea42ea2, 0x2ea62ea4, 0x2ea82ea6, 0x2eaa2ea8, 0x2eac2eaa, 0x2eae2eac, 0x2eb02eae
  .long 0x2eb22eb0, 0x2eb42eb2, 0x2eb62eb4, 0x2eb82eb6, 0x2eba2eb8, 0x2ebc2eba, 0x2ebe2ebc, 0x2ec02ebe
  .long 0x2ec22ec0, 0x2ec42ec2, 0x2ec62ec4, 0x2ec82ec6, 0x2eca2ec8, 0x2ecc2eca, 0x2ece2ecc, 0x2ed02ece
  .long 0x2ed22ed0, 0x2ed42ed2, 0x2ed62ed4, 0x2ed82ed6, 0x2eda2ed8, 0x2edc2eda, 0x2ede2edc, 0x2ee02ede
  .long 0x2ee22ee0, 0x2ee42ee2, 0x2ee62ee4, 0x2ee82ee6, 0x2eea2ee8, 0x2eec2eea, 0x2eee2eec, 0x2ef02eee
  .long 0x2ef22ef0, 0x2ef42ef2, 0x2ef62ef4, 0x2ef82ef6, 0x2efa2ef8, 0x2efc2efa, 0x2efe2efc, 0x2f002efe
  .long 0x2f022f00, 0x2f042f02, 0x2f062f04, 0x2f082f06, 0x2f0a2f08, 0x2f0c2f0a, 0x2f0e2f0c, 0x2f102f0e
  .long 0x2f122f10, 0x2f142f12, 0x2f162f14, 0x2f182f16, 0x2f1a2f18, 0x2f1c2f1a, 0x2f1e2f1c, 0x2f202f1e
  .long 0x2f222f20, 0x2f242f22, 0x2f262f24, 0x2f282f26, 0x2f2a2f28, 0x2f2c2f2a, 0x2f2e2f2c, 0x2f302f2e
  .long 0x2f322f30, 0x2f342f32, 0x2f362f34, 0x2f382f36, 0x2f3a2f38, 0x2f3c2f3a, 0x2f3e2f3c, 0x2f402f3e
  .long 0x2f422f40, 0x2f442f42, 0x2f462f44, 0x2f482f46, 0x2f4a2f48, 0x2f4c2f4a, 0x2f4e2f4c, 0x2f502f4e
  .long 0x2f522f50, 0x2f542f52, 0x2f562f54, 0x2f582f56, 0x2f5a2f58, 0x2f5c2f5a, 0x2f5e2f5c, 0x2f602f5e
  .long 0x2f622f60, 0x2f642f62, 0x2f662f64, 0x2f682f66, 0x2f6a2f68, 0x2f6c2f6a, 0x2f6e2f6c, 0x2f702f6e
  .long 0x2f722f70, 0x2f742f72, 0x2f762f74, 0x2f782f76, 0x2f7a2f78, 0x2f7c2f7a, 0x2f7e2f7c, 0x2f802f7e
  .long 0x2f822f80, 0x2f842f82, 0x2f862f84, 0x2f882f86, 0x2f8a2f88, 0x2f8c2f8a, 0x2f8e2f8c, 0x2f902f8e
  .long 0x2f922f90, 0x2f942f92, 0x2f962f94, 0x2f982f96, 0x2f9a2f98, 0x2f9c2f9a, 0x2f9e2f9c, 0x2fa02f9e
  .long 0x2fa22fa0, 0x2fa42fa2, 0x2fa62fa4, 0x2fa82fa6, 0x2faa2fa8, 0x2fac2faa, 0x2fae2fac, 0x2fb02fae
  .long 0x2fb22fb0, 0x2fb42fb2, 0x2fb62fb4, 0x2fb82fb6, 0x2fba2fb8, 0x2fbc2fba, 0x2fbe2fbc, 0x2fc02fbe
  .long 0x2fc22fc0, 0x2fc42fc2, 0x2fc62fc4, 0x2fc82fc6, 0x2fca2fc8, 0x2fcc2fca, 0x2fce2fcc, 0x2fd02fce
  .long 0x2fd22fd0, 0x2fd42fd2, 0x2fd62fd4, 0x2fd82fd6, 0x2fda2fd8, 0x2fdc2fda, 0x2fde2fdc, 0x2fe02fde
  .long 0x2fe22fe0, 0x2fe42fe2, 0x2fe62fe4, 0x2fe82fe6, 0x2fea2fe8, 0x2fec2fea, 0x2fee2fec, 0x2ff02fee
  .long 0x2ff22ff0, 0x2ff42ff2, 0x2ff62ff4, 0x2ff82ff6, 0x2ffa2ff8, 0x2ffc2ffa, 0x2ffe2ffc, 0x30002ffe
  .long 0x30023000, 0x30043002, 0x30063004, 0x30083006, 0x300a3008, 0x300c300a, 0x300e300c, 0x3010300e
  .long 0x30123010, 0x30143012, 0x30163014, 0x30183016, 0x301a3018, 0x301c301a, 0x301e301c, 0x3020301e
  .long 0x30223020, 0x30243022, 0x30263024, 0x30283026, 0x302a3028, 0x302c302a, 0x302e302c, 0x3030302e
  .long 0x30323030, 0x30343032, 0x30363034, 0x30383036, 0x303a3038, 0x303c303a, 0x303e303c, 0x3040303e
  .long 0x30423040, 0x30443042, 0x30463044, 0x30483046, 0x304a3048, 0x304c304a, 0x304e304c, 0x3050304e
  .long 0x30523050, 0x30543052, 0x30563054, 0x30583056, 0x305a3058, 0x305c305a, 0x305e305c, 0x3060305e
  .long 0x30623060, 0x30643062, 0x30663064, 0x30683066, 0x306a3068, 0x306c306a, 0x306e306c, 0x3070306e
  .long 0x30723070, 0x30743072, 0x30763074, 0x30783076, 0x307a3078, 0x307c307a, 0x307e307c, 0x3080307e
  .long 0x30823080, 0x30843082, 0x30863084, 0x30883086, 0x308a3088, 0x308c308a, 0x308e308c, 0x3090308e
  .long 0x30923090, 0x30943092, 0x30963094, 0x30983096, 0x309a3098, 0x309c309a, 0x309e309c, 0x30a0309e
  .long 0x30a230a0, 0x30a430a2, 0x30a630a4, 0x30a830a6, 0x30aa30a8, 0x30ac30aa, 0x30ae30ac, 0x30b030ae
  .long 0x30b230b0, 0x30b430b2, 0x30b630b4, 0x30b830b6, 0x30ba30b8, 0x30bc30ba, 0x30be30bc, 0x30c030be
  .long 0x30c230c0, 0x30c430c2, 0x30c630c4, 0x30c830c6, 0x30ca30c8, 0x30cc30ca, 0x30ce30cc, 0x30d030ce
  .long 0x30d230d0, 0x30d430d2, 0x30d630d4, 0x30d830d6, 0x30da30d8, 0x30dc30da, 0x30de30dc, 0x30e030de
  .long 0x30e230e0, 0x30e430e2, 0x30e630e4, 0x30e830e6, 0x30ea30e8, 0x30ec30ea, 0x30ee30ec, 0x30f030ee
  .long 0x30f230f0, 0x30f430f2, 0x30f630f4, 0x30f830f6, 0x30fa30f8, 0x30fc30fa, 0x30fe30fc, 0x310030fe
  .long 0x31023100, 0x31043102, 0x31063104, 0x31083106, 0x310a3108, 0x310c310a, 0x310e310c, 0x3110310e
  .long 0x31123110, 0x31143112, 0x31163114, 0x31183116, 0x311a3118, 0x311c311a, 0x311e311c, 0x3120311e
  .long 0x31223120, 0x31243122, 0x31263124, 0x31283126, 0x312a3128, 0x312c312a, 0x312e312c, 0x3130312e
  .long 0x31323130, 0x31343132, 0x31363134, 0x31383136, 0x313a3138, 0x313c313a, 0x313e313c, 0x3140313e
  .long 0x31423140, 0x31443142, 0x31463144, 0x31483146, 0x314a3148, 0x314c314a, 0x314e314c, 0x3150314e
  .long 0x31523150, 0x31543152, 0x31563154, 0x31583156, 0x315a3158, 0x315c315a, 0x315e315c, 0x3160315e
  .long 0x31623160, 0x31643162, 0x31663164, 0x31683166, 0x316a3168, 0x316c316a, 0x316e316c, 0x3170316e
  .long 0x31723170, 0x31743172, 0x31763174, 0x31783176, 0x317a3178, 0x317c317a, 0x317e317c, 0x3180317e
  .long 0x31823180, 0x31843182, 0x31863184, 0x31883186, 0x318a3188, 0x318c318a, 0x318e318c, 0x3190318e
  .long 0x31923190, 0x31943192, 0x31963194, 0x31983196, 0x319a3198, 0x319c319a, 0x319e319c, 0x31a0319e
  .long 0x31a231a0, 0x31a431a2, 0x31a631a4, 0x31a831a6, 0x31aa31a8, 0x31ac31aa, 0x31ae31ac, 0x31b031ae
  .long 0x31b231b0, 0x31b431b2, 0x31b631b4, 0x31b831b6, 0x31ba31b8, 0x31bc31ba, 0x31be31bc, 0x31c031be
  .long 0x31c231c0, 0x31c431c2, 0x31c631c4, 0x31c831c6, 0x31ca31c8, 0x31cc31ca, 0x31ce31cc, 0x31d031ce
  .long 0x31d231d0, 0x31d431d2, 0x31d631d4, 0x31d831d6, 0x31da31d8, 0x31dc31da, 0x31de31dc, 0x31e031de
  .long 0x31e231e0, 0x31e431e2, 0x31e631e4, 0x31e831e6, 0x31ea31e8, 0x31ec31ea, 0x31ee31ec, 0x31f031ee
  .long 0x31f231f0, 0x31f431f2, 0x31f631f4, 0x31f831f6, 0x31fa31f8, 0x31fc31fa, 0x31fe31fc, 0x320031fe
  .long 0x32023200, 0x32043202, 0x32063204, 0x32083206, 0x320a3208, 0x320c320a, 0x320e320c, 0x3210320e
  .long 0x32123210, 0x32143212, 0x32163214, 0x32183216, 0x321a3218, 0x321c321a, 0x321e321c, 0x3220321e
  .long 0x32223220, 0x32243222, 0x32263224, 0x32283226, 0x322a3228, 0x322c322a, 0x322e322c, 0x3230322e
  .long 0x32323230, 0x32343232, 0x32363234, 0x32383236, 0x323a3238, 0x323c323a, 0x323e323c, 0x3240323e
  .long 0x32423240, 0x32443242, 0x32463244, 0x32483246, 0x324a3248, 0x324c324a, 0x324e324c, 0x3250324e
  .long 0x32523250, 0x32543252, 0x32563254, 0x32583256, 0x325a3258, 0x325c325a, 0x325e325c, 0x3260325e
  .long 0x32623260, 0x32643262, 0x32663264, 0x32683266, 0x326a3268, 0x326c326a, 0x326e326c, 0x3270326e
  .long 0x32723270, 0x32743272, 0x32763274, 0x32783276, 0x327a3278, 0x327c327a, 0x327e327c, 0x3280327e
  .long 0x32823280, 0x32843282, 0x32863284, 0x32883286, 0x328a3288, 0x328c328a, 0x328e328c, 0x3290328e
  .long 0x32923290, 0x32943292, 0x32963294, 0x32983296, 0x329a3298, 0x329c329a, 0x329e329c, 0x32a0329e
  .long 0x32a232a0, 0x32a432a2, 0x32a632a4, 0x32a832a6, 0x32aa32a8, 0x32ac32aa, 0x32ae32ac, 0x32b032ae
  .long 0x32b232b0, 0x32b432b2, 0x32b632b4, 0x32b832b6, 0x32ba32b8, 0x32bc32ba, 0x32be32bc, 0x32c032be
  .long 0x32c232c0, 0x32c432c2, 0x32c632c4, 0x32c832c6, 0x32ca32c8, 0x32cc32ca, 0x32ce32cc, 0x32d032ce
  .long 0x32d232d0, 0x32d432d2, 0x32d632d4, 0x32d832d6, 0x32da32d8, 0x32dc32da, 0x32de32dc, 0x32e032de
  .long 0x32e232e0, 0x32e432e2, 0x32e632e4, 0x32e832e6, 0x32ea32e8, 0x32ec32ea, 0x32ee32ec, 0x32f032ee
  .long 0x32f232f0, 0x32f432f2, 0x32f632f4, 0x32f832f6, 0x32fa32f8, 0x32fc32fa, 0x32fe32fc, 0x330032fe
  .long 0x33023300, 0x33043302, 0x33063304, 0x33083306, 0x330a3308, 0x330c330a, 0x330e330c, 0x3310330e
  .long 0x33123310, 0x33143312, 0x33163314, 0x33183316, 0x331a3318, 0x331c331a, 0x331e331c, 0x3320331e
  .long 0x33223320, 0x33243322, 0x33263324, 0x33283326, 0x332a3328, 0x332c332a, 0x332e332c, 0x3330332e
  .long 0x33323330, 0x33343332, 0x33363334, 0x33383336, 0x333a3338, 0x333c333a, 0x333e333c, 0x3340333e
  .long 0x33423340, 0x33443342, 0x33463344, 0x33483346, 0x334a3348, 0x334c334a, 0x334e334c, 0x3350334e
  .long 0x33523350, 0x33543352, 0x33563354, 0x33583356, 0x33593358, 0x335b335a, 0x335d335c, 0x335f335e
  .long 0x33613360, 0x33633362, 0x33653364, 0x33673366, 0x33693368, 0x336b336a, 0x336d336c, 0x336f336e
  .long 0x33713370, 0x33733372, 0x33753374, 0x33773376, 0x33793378, 0x337b337a, 0x337d337c, 0x337f337e
  .long 0x33823380, 0x33843382, 0x33863384, 0x33883386, 0x338a3388, 0x338c338a, 0x338e338c, 0x3390338e
  .long 0x33923390, 0x33943392, 0x33963394, 0x33983396, 0x339a3398, 0x339b339a, 0x339d339c, 0x339f339e
  .long 0x33a133a0, 0x33a333a2, 0x33a533a4, 0x33a733a6, 0x33a933a8, 0x33ab33aa, 0x33ad33ac, 0x33af33ae
  .long 0x33b133b0, 0x33b333b2, 0x33b533b4, 0x33b733b6, 0x33b933b8, 0x33bb33ba, 0x33bd33bc, 0x33bf33be
  .long 0x33c133c0, 0x33c333c2, 0x33c533c4, 0x33c733c6, 0x33c933c8, 0x33cb33ca, 0x33cd33cc, 0x33cf33ce
  .long 0x33d133d0, 0x33d333d2, 0x33d533d4, 0x33d733d6, 0x33d933d8, 0x33db33da, 0x33dd33dc, 0x33df33de
  .long 0x33e133e0, 0x33e333e2, 0x33e533e4, 0x33e733e6, 0x33e933e8, 0x33eb33ea, 0x33ed33ec, 0x33ef33ee
  .long 0x33f133f0, 0x33f333f2, 0x33f533f4, 0x33f733f6, 0x33f933f8, 0x33fb33fa, 0x33fd33fc, 0x33ff33fe
  .long 0x34013400, 0x34033402, 0x34053404, 0x34073406, 0x34093408, 0x340b340a, 0x340d340c, 0x340f340e
  .long 0x34113410, 0x34133412, 0x34153414, 0x34173416, 0x34193418, 0x341b341a, 0x341d341c, 0x341f341e
  .long 0x34213420, 0x34233422, 0x34253424, 0x34273426, 0x34293428, 0x342b342a, 0x342d342c, 0x342f342e
  .long 0x34313430, 0x34333432, 0x34353434, 0x34373436, 0x34393438, 0x343b343a, 0x343d343c, 0x343f343e
  .long 0x34413440, 0x34433442, 0x34453444, 0x34473446, 0x34493448, 0x344b344a, 0x344d344c, 0x344f344e
  .long 0x34513450, 0x34533452, 0x34553454, 0x34573456, 0x34593458, 0x345b345a, 0x345d345c, 0x345f345e
  .long 0x34613460, 0x34633462, 0x34653464, 0x34673466, 0x34693468, 0x346b346a, 0x346d346c, 0x346f346e
  .long 0x34713470, 0x34733472, 0x34753474, 0x34773476, 0x34793478, 0x347b347a, 0x347d347c, 0x347f347e
  .long 0x34813480, 0x34833482, 0x34853484, 0x34873486, 0x34893488, 0x348b348a, 0x348d348c, 0x348f348e
  .long 0x34913490, 0x34933492, 0x34953494, 0x34973496, 0x34993498, 0x349b349a, 0x349d349c, 0x349f349e
  .long 0x34a134a0, 0x34a334a2, 0x34a534a4, 0x34a734a6, 0x34a934a8, 0x34ab34aa, 0x34ad34ac, 0x34af34ae
  .long 0x34b134b0, 0x34b334b2, 0x34b534b4, 0x34b734b6, 0x34b934b8, 0x34bb34ba, 0x34bd34bc, 0x34bf34be
  .long 0x34c134c0, 0x34c334c2, 0x34c534c4, 0x34c734c6, 0x34c934c8, 0x34cb34ca, 0x34cd34cc, 0x34cf34ce
  .long 0x34d134d0, 0x34d334d2, 0x34d534d4, 0x34d734d6, 0x34d934d8, 0x34db34da, 0x34dd34dc, 0x34df34de
  .long 0x34e134e0, 0x34e334e2, 0x34e534e4, 0x34e734e6, 0x34e934e8, 0x34eb34ea, 0x34ed34ec, 0x34ef34ee
  .long 0x34f134f0, 0x34f334f2, 0x34f534f4, 0x34f734f6, 0x34f934f8, 0x34fb34fa, 0x34fd34fc, 0x34ff34fe
  .long 0x35013500, 0x35033502, 0x35053504, 0x35073506, 0x35093508, 0x350b350a, 0x350d350c, 0x350f350e
  .long 0x35113510, 0x35133512, 0x35153514, 0x35173516, 0x35193518, 0x351b351a, 0x351d351c, 0x351f351e
  .long 0x35213520, 0x35233522, 0x35253524, 0x35273526, 0x35293528, 0x352b352a, 0x352d352c, 0x352f352e
  .long 0x35313530, 0x35333532, 0x35353534, 0x35373536, 0x35393538, 0x353b353a, 0x353d353c, 0x353f353e
  .long 0x35413540, 0x35433542, 0x35453544, 0x35473546, 0x35493548, 0x354b354a, 0x354d354c, 0x354f354e
  .long 0x35513550, 0x35533552, 0x35553554, 0x35573556, 0x35593558, 0x355b355a, 0x355d355c, 0x355f355e
  .long 0x35613560, 0x35633562, 0x35653564, 0x35673566, 0x35693568, 0x356b356a, 0x356d356c, 0x356f356e
  .long 0x35713570, 0x35733572, 0x35753574, 0x35773576, 0x35793578, 0x357b357a, 0x357d357c, 0x357f357e
  .long 0x35813580, 0x35833582, 0x35853584, 0x35873586, 0x35893588, 0x358b358a, 0x358d358c, 0x358f358e
  .long 0x35913590, 0x35933592, 0x35953594, 0x35973596, 0x35993598, 0x359b359a, 0x359d359c, 0x359f359e
  .long 0x35a135a0, 0x35a335a2, 0x35a535a4, 0x35a735a6, 0x35a935a8, 0x35ab35aa, 0x35ad35ac, 0x35af35ae
  .long 0x35b135b0, 0x35b335b2, 0x35b535b4, 0x35b735b6, 0x35b935b8, 0x35bb35ba, 0x35bd35bc, 0x35bf35be
  .long 0x35c135c0, 0x35c335c2, 0x35c535c4, 0x35c735c6, 0x35c935c8, 0x35cb35ca, 0x35cd35cc, 0x35cf35ce
  .long 0x35d135d0, 0x35d335d2, 0x35d535d4, 0x35d735d6, 0x35d935d8, 0x35db35da, 0x35dd35dc, 0x35df35de
  .long 0x35e135e0, 0x35e335e2, 0x35e535e4, 0x35e735e6, 0x35e935e8, 0x35eb35ea, 0x35ed35ec, 0x35ef35ee
  .long 0x35f135f0, 0x35f335f2, 0x35f535f4, 0x35f735f6, 0x35f935f8, 0x35fb35fa, 0x35fd35fc, 0x35ff35fe
  .long 0x36013600, 0x36033602, 0x36053604, 0x36073606, 0x36093608, 0x360b360a, 0x360d360c, 0x360f360e
  .long 0x36113610, 0x36133612, 0x36153614, 0x36173616, 0x36193618, 0x361b361a, 0x361d361c, 0x361f361e
  .long 0x36213620, 0x36233622, 0x36253624, 0x36273626, 0x36293628, 0x362b362a, 0x362d362c, 0x362f362e
  .long 0x36313630, 0x36333632, 0x36353634, 0x36373636, 0x36393638, 0x363b363a, 0x363d363c, 0x363f363e
  .long 0x36413640, 0x36433642, 0x36453644, 0x36473646, 0x36493648, 0x364b364a, 0x364d364c, 0x364f364e
  .long 0x36513650, 0x36533652, 0x36553654, 0x36573656, 0x36593658, 0x365b365a, 0x365d365c, 0x365f365e
  .long 0x36613660, 0x36633662, 0x36653664, 0x36673666, 0x36693668, 0x366b366a, 0x366d366c, 0x366f366e
  .long 0x36713670, 0x36733672, 0x36753674, 0x36773676, 0x36793678, 0x367b367a, 0x367d367c, 0x367f367e
  .long 0x36813680, 0x36833682, 0x36853684, 0x36873686, 0x36893688, 0x368b368a, 0x368d368c, 0x368f368e
  .long 0x36913690, 0x36933692, 0x36953694, 0x36973696, 0x36993698, 0x369b369a, 0x369d369c, 0x369f369e
  .long 0x36a136a0, 0x36a336a2, 0x36a536a4, 0x36a736a6, 0x36a936a8, 0x36ab36aa, 0x36ad36ac, 0x36af36ae
  .long 0x36b136b0, 0x36b336b2, 0x36b536b4, 0x36b736b6, 0x36b936b8, 0x36bb36ba, 0x36bd36bc, 0x36bf36be
  .long 0x36c136c0, 0x36c336c2, 0x36c536c4, 0x36c736c6, 0x36c936c8, 0x36cb36ca, 0x36cd36cc, 0x36cf36ce
  .long 0x36d136d0, 0x36d336d2, 0x36d536d4, 0x36d736d6, 0x36d936d8, 0x36db36da, 0x36dd36dc, 0x36df36de
  .long 0x36e136e0, 0x36e336e2, 0x36e536e4, 0x36e736e6, 0x36e936e8, 0x36eb36ea, 0x36ed36ec, 0x36ef36ee
  .long 0x36f136f0, 0x36f336f2, 0x36f536f4, 0x36f736f6, 0x36f936f8, 0x36fb36fa, 0x36fd36fc, 0x36ff36fe
  .long 0x37013700, 0x37033702, 0x37053704, 0x37073706, 0x37093708, 0x370b370a, 0x370d370c, 0x370f370e
  .long 0x37113710, 0x37133712, 0x37153714, 0x37173716, 0x37193718, 0x371b371a, 0x371d371c, 0x371f371e
  .long 0x37213720, 0x37233722, 0x37253724, 0x37273726, 0x37293728, 0x372b372a, 0x372d372c, 0x372f372e
  .long 0x37313730, 0x37333732, 0x37353734, 0x37373736, 0x37393738, 0x373b373a, 0x373d373c, 0x373f373e
  .long 0x37413740, 0x37433742, 0x37453744, 0x37473746, 0x37493748, 0x374b374a, 0x374d374c, 0x374f374e
  .long 0x37513750, 0x37533752, 0x37553754, 0x37573756, 0x37593758, 0x375b375a, 0x375d375c, 0x375f375e
  .long 0x37613760, 0x37633762, 0x37653764, 0x37673766, 0x37693768, 0x376b376a, 0x376d376c, 0x376f376e
  .long 0x37713770, 0x37733772, 0x37753774, 0x37773776, 0x37793778, 0x377b377a, 0x377d377c, 0x377f377e
  .long 0x37813780, 0x37833782, 0x37853784, 0x37873786, 0x37893788, 0x378b378a, 0x378d378c, 0x378f378e
  .long 0x37913790, 0x37933792, 0x37953794, 0x37973796, 0x37993798, 0x379b379a, 0x379d379c, 0x379f379e
  .long 0x37a137a0, 0x37a337a2, 0x37a537a4, 0x37a737a6, 0x37a937a8, 0x37ab37aa, 0x37ad37ac, 0x37af37ae
  .long 0x37b137b0, 0x37b337b2, 0x37b537b4, 0x37b737b6, 0x37b937b8, 0x37bb37ba, 0x37bd37bc, 0x37bf37be
  .long 0x37c137c0, 0x37c337c2, 0x37c537c4, 0x37c737c6, 0x37c937c8, 0x37cb37ca, 0x37cd37cc, 0x37cf37ce
  .long 0x37d137d0, 0x37d337d2, 0x37d537d4, 0x37d737d6, 0x37d937d8, 0x37db37da, 0x37dd37dc, 0x37df37de
  .long 0x37e137e0, 0x37e337e2, 0x37e537e4, 0x37e737e6, 0x37e937e8, 0x37eb37ea, 0x37ed37ec, 0x37ef37ee
  .long 0x37f137f0, 0x37f337f2, 0x37f537f4, 0x37f737f6, 0x37f937f8, 0x37fb37fa, 0x37fd37fc, 0x37ff37fe
  .long 0x38013800, 0x38033802, 0x38053804, 0x38073806, 0x38093808, 0x380b380a, 0x380d380c, 0x380f380e
  .long 0x38113810, 0x38133812, 0x38153814, 0x38173816, 0x38193818, 0x381b381a, 0x381d381c, 0x381f381e
  .long 0x38213820, 0x38233822, 0x38253824, 0x38273826, 0x38293828, 0x382b382a, 0x382d382c, 0x382f382e
  .long 0x38313830, 0x38333832, 0x38353834, 0x38373836, 0x38393838, 0x383b383a, 0x383d383c, 0x383f383e
  .long 0x38413840, 0x38433842, 0x38453844, 0x38473846, 0x38493848, 0x384b384a, 0x384d384c, 0x384f384e
  .long 0x38513850, 0x38533852, 0x38553854, 0x38573856, 0x38593858, 0x385b385a, 0x385d385c, 0x385f385e
  .long 0x38613860, 0x38633862, 0x38653864, 0x38673866, 0x38693868, 0x386b386a, 0x386d386c, 0x386f386e
  .long 0x38713870, 0x38733872, 0x38753874, 0x38773876, 0x38793878, 0x387b387a, 0x387d387c, 0x387f387e
  .long 0x38813880, 0x38833882, 0x38853884, 0x38873886, 0x38893888, 0x388b388a, 0x388d388c, 0x388f388e
  .long 0x38913890, 0x38933892, 0x38953894, 0x38973896, 0x38993898, 0x389b389a, 0x389d389c, 0x389f389e
  .long 0x38a138a0, 0x38a338a2, 0x38a538a4, 0x38a738a6, 0x38a938a8, 0x38ab38aa, 0x38ad38ac, 0x38af38ae
  .long 0x38b138b0, 0x38b338b2, 0x38b538b4, 0x38b738b6, 0x38b938b8, 0x38bb38ba, 0x38bd38bc, 0x38bf38be
  .long 0x38c138c0, 0x38c338c2, 0x38c538c4, 0x38c738c6, 0x38c938c8, 0x38cb38ca, 0x38cd38cc, 0x38cf38ce
  .long 0x38d138d0, 0x38d338d2, 0x38d538d4, 0x38d738d6, 0x38d938d8, 0x38db38da, 0x38dd38dc, 0x38df38de
  .long 0x38e138e0, 0x38e338e2, 0x38e538e4, 0x38e738e6, 0x38e938e8, 0x38eb38ea, 0x38ed38ec, 0x38ef38ee
  .long 0x38f138f0, 0x38f338f2, 0x38f538f4, 0x38f738f6, 0x38f938f8, 0x38fb38fa, 0x38fd38fc, 0x38ff38fe
  .long 0x39013900, 0x39033902, 0x39053904, 0x39073906, 0x39093908, 0x390b390a, 0x390d390c, 0x390f390e
  .long 0x39113910, 0x39133912, 0x39153914, 0x39173916, 0x39193918, 0x391b391a, 0x391d391c, 0x391f391e
  .long 0x39213920, 0x39233922, 0x39253924, 0x39273926, 0x39293928, 0x392b392a, 0x392d392c, 0x392f392e
  .long 0x39313930, 0x39333932, 0x39353934, 0x39373936, 0x39393938, 0x393b393a, 0x393d393c, 0x393f393e
  .long 0x39413940, 0x39433942, 0x39453944, 0x39473946, 0x39493948, 0x394b394a, 0x394d394c, 0x394f394e
  .long 0x39513950, 0x39533952, 0x39553954, 0x39573956, 0x39593958, 0x395b395a, 0x395d395c, 0x395f395e
  .long 0x39613960, 0x39633962, 0x39653964, 0x39673966, 0x39693968, 0x396b396a, 0x396d396c, 0x396f396e
  .long 0x39713970, 0x39733972, 0x39753974, 0x39773976, 0x39793978, 0x397b397a, 0x397d397c, 0x397f397e
  .long 0x39813980, 0x39833982, 0x39853984, 0x39873986, 0x39893988, 0x398b398a, 0x398d398c, 0x398f398e
  .long 0x39913990, 0x39933992, 0x39953994, 0x39973996, 0x39993998, 0x399b399a, 0x399d399c, 0x399f399e
  .long 0x39a139a0, 0x39a339a2, 0x39a539a4, 0x39a739a6, 0x39a939a8, 0x39ab39aa, 0x39ad39ac, 0x39af39ae
  .long 0x39b139b0, 0x39b339b2, 0x39b539b4, 0x39b739b6, 0x39b939b8, 0x39bb39ba, 0x39bd39bc, 0x39bf39be
  .long 0x39c139c0, 0x39c339c2, 0x39c539c4, 0x39c739c6, 0x39c939c8, 0x39cb39ca, 0x39cd39cc, 0x39cf39ce
  .long 0x39d139d0, 0x39d339d2, 0x39d539d4, 0x39d739d6, 0x39d939d8, 0x39db39da, 0x39dd39dc, 0x39df39de
  .long 0x39e139e0, 0x39e339e2, 0x39e539e4, 0x39e739e6, 0x39e939e8, 0x39eb39ea, 0x39ed39ec, 0x39ef39ee
  .long 0x39f139f0, 0x39f339f2, 0x39f539f4, 0x39f739f6, 0x39f939f8, 0x39fb39fa, 0x39fd39fc, 0x39ff39fe
  .long 0x3a013a00, 0x3a033a02, 0x3a053a04, 0x3a073a06, 0x3a093a08, 0x3a0b3a0a, 0x3a0d3a0c, 0x3a0f3a0e
  .long 0x3a113a10, 0x3a133a12, 0x3a153a14, 0x3a173a16, 0x3a193a18, 0x3a1b3a1a, 0x3a1d3a1c, 0x3a1f3a1e
  .long 0x3a213a20, 0x3a233a22, 0x3a253a24, 0x3a273a26, 0x3a293a28, 0x3a2b3a2a, 0x3a2d3a2c, 0x3a2f3a2e
  .long 0x3a313a30, 0x3a333a32, 0x3a353a34, 0x3a373a36, 0x3a393a38, 0x3a3b3a3a, 0x3a3d3a3c, 0x3a3f3a3e
  .long 0x3a413a40, 0x3a433a42, 0x3a453a44, 0x3a473a46, 0x3a493a48, 0x3a4b3a4a, 0x3a4d3a4c, 0x3a4f3a4e
  .long 0x3a513a50, 0x3a533a52, 0x3a553a54, 0x3a573a56, 0x3a593a58, 0x3a5b3a5a, 0x3a5d3a5c, 0x3a5f3a5e
  .long 0x3a613a60, 0x3a633a62, 0x3a653a64, 0x3a673a66, 0x3a693a68, 0x3a6b3a6a, 0x3a6d3a6c, 0x3a6f3a6e
  .long 0x3a713a70, 0x3a733a72, 0x3a753a74, 0x3a773a76, 0x3a793a78, 0x3a7b3a7a, 0x3a7d3a7c, 0x3a7f3a7e
  .long 0x3a813a80, 0x3a833a82, 0x3a853a84, 0x3a873a86, 0x3a893a88, 0x3a8b3a8a, 0x3a8d3a8c, 0x3a8f3a8e
  .long 0x3a913a90, 0x3a933a92, 0x3a953a94, 0x3a973a96, 0x3a993a98, 0x3a9b3a9a, 0x3a9d3a9c, 0x3a9f3a9e
  .long 0x3aa13aa0, 0x3aa33aa2, 0x3aa53aa4, 0x3aa73aa6, 0x3aa93aa8, 0x3aab3aaa, 0x3aad3aac, 0x3aaf3aae
  .long 0x3ab13ab0, 0x3ab33ab2, 0x3ab53ab4, 0x3ab73ab6, 0x3ab93ab8, 0x3abb3aba, 0x3abd3abc, 0x3abf3abe
  .long 0x3ac13ac0, 0x3ac33ac2, 0x3ac53ac4, 0x3ac73ac6, 0x3ac93ac8, 0x3acb3aca, 0x3acd3acc, 0x3acf3ace
  .long 0x3ad13ad0, 0x3ad33ad2, 0x3ad53ad4, 0x3ad73ad6, 0x3ad93ad8, 0x3adb3ada, 0x3add3adc, 0x3adf3ade
  .long 0x3ae13ae0, 0x3ae33ae2, 0x3ae53ae4, 0x3ae73ae6, 0x3ae93ae8, 0x3aeb3aea, 0x3aed3aec, 0x3aef3aee
  .long 0x3af13af0, 0x3af33af2, 0x3af53af4, 0x3af73af6, 0x3af93af8, 0x3afb3afa, 0x3afd3afc, 0x3aff3afe
  .long 0x3b013b00, 0x3b033b02, 0x3b053b04, 0x3b073b06, 0x3b093b08, 0x3b0b3b0a, 0x3b0d3b0c, 0x3b0f3b0e
  .long 0x3b113b10, 0x3b133b12, 0x3b153b14, 0x3b173b16, 0x3b193b18, 0x3b1b3b1a, 0x3b1d3b1c, 0x3b1f3b1e
  .long 0x3b213b20, 0x3b233b22, 0x3b253b24, 0x3b273b26, 0x3b293b28, 0x3b2b3b2a, 0x3b2d3b2c, 0x3b2f3b2e
  .long 0x3b313b30, 0x3b333b32, 0x3b353b34, 0x3b373b36, 0x3b393b38, 0x3b3b3b3a, 0x3b3d3b3c, 0x3b3f3b3e
  .long 0x3b413b40, 0x3b433b42, 0x3b453b44, 0x3b473b46, 0x3b493b48, 0x3b4b3b4a, 0x3b4d3b4c, 0x3b4f3b4e
  .long 0x3b513b50, 0x3b533b52, 0x3b553b54, 0x3b573b56, 0x3b593b58, 0x3b5b3b5a, 0x3b5d3b5c, 0x3b5f3b5e
  .long 0x3b613b60, 0x3b633b62, 0x3b653b64, 0x3b673b66, 0x3b693b68, 0x3b6b3b6a, 0x3b6d3b6c, 0x3b6f3b6e
  .long 0x3b713b70, 0x3b733b72, 0x3b753b74, 0x3b773b76, 0x3b793b78, 0x3b7b3b7a, 0x3b7d3b7c, 0x3b7f3b7e
  .long 0x3b813b80, 0x3b833b82, 0x3b853b84, 0x3b873b86, 0x3b893b88, 0x3b8b3b8a, 0x3b8d3b8c, 0x3b8f3b8e
  .long 0x3b913b90, 0x3b933b92, 0x3b953b94, 0x3b973b96, 0x3b993b98, 0x3b9b3b9a, 0x3b9d3b9c, 0x3b9f3b9e
  .long 0x3ba13ba0, 0x3ba33ba2, 0x3ba53ba4, 0x3ba73ba6, 0x3ba93ba8, 0x3bab3baa, 0x3bad3bac, 0x3baf3bae
  .long 0x3bb13bb0, 0x3bb33bb2, 0x3bb53bb4, 0x3bb73bb6, 0x3bb93bb8, 0x3bbb3bba, 0x3bbd3bbc, 0x3bbf3bbe
  .long 0x3bc13bc0, 0x3bc33bc2, 0x3bc53bc4, 0x3bc73bc6, 0x3bc93bc8, 0x3bcb3bca, 0x3bcd3bcc, 0x3bcf3bce
  .long 0x3bd13bd0, 0x3bd33bd2, 0x3bd53bd4, 0x3bd73bd6, 0x3bd83bd8, 0x3bda3bd9, 0x3bdc3bdb, 0x3bde3bdd
  .long 0x3be03bdf, 0x3be23be1, 0x3be43be3, 0x3be63be5, 0x3be83be7, 0x3bea3be9, 0x3bec3beb, 0x3bee3bed
  .long 0x3bf03bef, 0x3bf23bf1, 0x3bf43bf3, 0x3bf63bf5, 0x3bf83bf7, 0x3bfa3bf9, 0x3bfc3bfb, 0x3bfe3bfd
  .long 0x3c013c00, 0x3c033c02, 0x3c053c04, 0x3c073c06, 0x3c093c08, 0x3c0b3c0a, 0x3c0d3c0c, 0x3c0f3c0e
  .long 0x3c113c10, 0x3c133c12, 0x3c153c14, 0x3c173c16, 0x3c193c18, 0x3c1a3c19, 0x3c1c3c1b, 0x3c1e3c1d
  .long 0x3c203c1f, 0x3c223c21, 0x3c243c23, 0x3c263c25, 0x3c283c27, 0x3c2a3c29, 0x3c2c3c2b, 0x3c2e3c2d
  .long 0x3c303c2f, 0x3c323c31, 0x3c343c33, 0x3c363c35, 0x3c383c37, 0x3c3a3c39, 0x3c3c3c3b, 0x3c3e3c3d
  .long 0x3c403c3f, 0x3c423c41, 0x3c443c43, 0x3c463c45, 0x3c483c47, 0x3c4a3c49, 0x3c4c3c4b, 0x3c4e3c4d
  .long 0x3c503c4f, 0x3c523c51, 0x3c543c53, 0x3c563c55, 0x3c573c57, 0x3c593c58, 0x3c5b3c5a, 0x3c5d3c5c
  .long 0x3c5f3c5e, 0x3c613c60, 0x3c633c62, 0x3c653c64, 0x3c673c66, 0x3c693c68, 0x3c6b3c6a, 0x3c6d3c6c
  .long 0x3c6f3c6e, 0x3c713c70, 0x3c733c72, 0x3c753c74, 0x3c773c76, 0x3c793c78, 0x3c7b3c7a, 0x3c7d3c7c
  .long 0x3c803c7e, 0x3c823c81, 0x3c843c83, 0x3c863c85, 0x3c883c87, 0x3c8a3c89, 0x3c8c3c8b, 0x3c8e3c8d
  .long 0x3c903c8f, 0x3c923c91, 0x3c943c93, 0x3c963c95, 0x3c983c97, 0x3c993c98, 0x3c9b3c9a, 0x3c9d3c9c
  .long 0x3c9f3c9e, 0x3ca13ca0, 0x3ca33ca2, 0x3ca53ca4, 0x3ca73ca6, 0x3ca93ca8, 0x3cab3caa, 0x3cad3cac
  .long 0x3caf3cae, 0x3cb13cb0, 0x3cb33cb2, 0x3cb53cb4, 0x3cb73cb6, 0x3cb93cb8, 0x3cba3cb9, 0x3cbc3cbb
  .long 0x3cbe3cbd, 0x3cc03cbf, 0x3cc23cc1, 0x3cc43cc3, 0x3cc63cc5, 0x3cc83cc7, 0x3cca3cc9, 0x3ccc3ccb
  .long 0x3cce3ccd, 0x3cd03ccf, 0x3cd23cd1, 0x3cd43cd3, 0x3cd53cd5, 0x3cd73cd6, 0x3cd93cd8, 0x3cdb3cda
  .long 0x3cdd3cdc, 0x3cdf3cde, 0x3ce13ce0, 0x3ce33ce2, 0x3ce53ce4, 0x3ce73ce6, 0x3ce93ce8, 0x3ceb3cea
  .long 0x3ced3cec, 0x3cee3cee, 0x3cf03cef, 0x3cf23cf1, 0x3cf43cf3, 0x3cf63cf5, 0x3cf83cf7, 0x3cfa3cf9
  .long 0x3cfd3cfb, 0x3d013cff, 0x3d023d02, 0x3d043d03, 0x3d063d05, 0x3d083d07, 0x3d0a3d09, 0x3d0c3d0b
  .long 0x3d0e3d0d, 0x3d103d0f, 0x3d123d11, 0x3d143d13, 0x3d163d15, 0x3d173d16, 0x3d193d18, 0x3d1b3d1a
  .long 0x3d1d3d1c, 0x3d1f3d1e, 0x3d213d20, 0x3d233d22, 0x3d253d24, 0x3d273d26, 0x3d283d27, 0x3d2a3d29
  .long 0x3d2c3d2b, 0x3d2e3d2d, 0x3d303d2f, 0x3d323d31, 0x3d343d33, 0x3d363d35, 0x3d373d36, 0x3d393d38
  .long 0x3d3b3d3a, 0x3d3d3d3c, 0x3d3f3d3e, 0x3d413d40, 0x3d433d42, 0x3d443d44, 0x3d463d45, 0x3d483d47
  .long 0x3d4a3d49, 0x3d4c3d4b, 0x3d4e3d4d, 0x3d503d4f, 0x3d513d51, 0x3d533d52, 0x3d553d54, 0x3d573d56
  .long 0x3d593d58, 0x3d5b3d5a, 0x3d5d3d5c, 0x3d5e3d5e, 0x3d603d5f, 0x3d623d61, 0x3d643d63, 0x3d663d65
  .long 0x3d683d67, 0x3d693d69, 0x3d6b3d6a, 0x3d6d3d6c, 0x3d6f3d6e, 0x3d713d70, 0x3d733d72, 0x3d743d74
  .long 0x3d783d76, 0x3d7b3d79, 0x3d7f3d7d, 0x3d813d80, 0x3d833d82, 0x3d853d84, 0x3d873d86, 0x3d893d88
  .long 0x3d8a3d89, 0x3d8c3d8b, 0x3d8e3d8d, 0x3d903d8f, 0x3d923d91, 0x3d933d92, 0x3d953d94, 0x3d973d96
  .long 0x3d993d98, 0x3d9a3d9a, 0x3d9c3d9b, 0x3d9e3d9d, 0x3da03d9f, 0x3da23da1, 0x3da33da2, 0x3da53da4
  .long 0x3da73da6, 0x3da93da8, 0x3daa3da9, 0x3dac3dab, 0x3dae3dad, 0x3db03daf, 0x3db13db0, 0x3db33db2
  .long 0x3db53db4, 0x3db73db6, 0x3db83db7, 0x3dba3db9, 0x3dbc3dbb, 0x3dbe3dbd, 0x3dbf3dbe, 0x3dc13dc0
  .long 0x3dc33dc2, 0x3dc43dc4, 0x3dc63dc5, 0x3dc83dc7, 0x3dca3dc9, 0x3dcb3dca, 0x3dcd3dcc, 0x3dcf3dce
  .long 0x3dd03dcf, 0x3dd23dd1, 0x3dd43dd3, 0x3dd53dd5, 0x3dd73dd6, 0x3dd93dd8, 0x3dda3dda, 0x3ddc3ddb
  .long 0x3dde3ddd, 0x3ddf3ddf, 0x3de13de0, 0x3de33de2, 0x3de43de4, 0x3de63de5, 0x3de83de7, 0x3de93de9
  .long 0x3dec3deb, 0x3df03dee, 0x3df33df1, 0x3df63df5, 0x3df93df8, 0x3dfd3dfb, 0x3e003dfe, 0x3e023e01
  .long 0x3e033e02, 0x3e053e04, 0x3e063e06, 0x3e083e07, 0x3e0a3e09, 0x3e0b3e0a, 0x3e0d3e0c, 0x3e0e3e0e
  .long 0x3e103e0f, 0x3e113e11, 0x3e133e12, 0x3e153e14, 0x3e163e15, 0x3e183e17, 0x3e193e18, 0x3e1b3e1a
  .long 0x3e1c3e1c, 0x3e1e3e1d, 0x3e1f3e1f, 0x3e213e20, 0x3e223e22, 0x3e243e23, 0x3e253e25, 0x3e273e26
  .long 0x3e283e28, 0x3e2a3e29, 0x3e2b3e2b, 0x3e2d3e2c, 0x3e2e3e2d, 0x3e303e2f, 0x3e313e30, 0x3e333e32
  .long 0x3e343e33, 0x3e353e35, 0x3e373e36, 0x3e383e38, 0x3e3a3e39, 0x3e3b3e3a, 0x3e3d3e3c, 0x3e3e3e3d
  .long 0x3e3f3e3f, 0x3e413e40, 0x3e423e41, 0x3e443e43, 0x3e453e44, 0x3e463e46, 0x3e483e47, 0x3e493e48
  .long 0x3e4a3e4a, 0x3e4c3e4b, 0x3e4d3e4c, 0x3e4e3e4e, 0x3e503e4f, 0x3e513e50, 0x3e523e52, 0x3e543e53
  .long 0x3e563e55, 0x3e593e57, 0x3e5b3e5a, 0x3e5e3e5d, 0x3e603e5f, 0x3e633e62, 0x3e653e64, 0x3e683e67
  .long 0x3e6a3e69, 0x3e6d3e6c, 0x3e6f3e6e, 0x3e723e71, 0x3e743e73, 0x3e763e75, 0x3e793e78, 0x3e7b3e7a
  .long 0x3e7d3e7c, 0x3e803e7f, 0x3e813e80, 0x3e823e82, 0x3e833e83, 0x3e843e84, 0x3e853e85, 0x3e873e86
  .long 0x3e883e87, 0x3e893e88, 0x3e8a3e89, 0x3e8b3e8a, 0x3e8c3e8b, 0x3e8d3e8c, 0x3e8e3e8d, 0x3e8f3e8e
  .long 0x3e903e8f, 0x3e913e90, 0x3e923e91, 0x3e933e92, 0x3e943e93, 0x3e953e94, 0x3e963e95, 0x3e973e96
  .long 0x3e983e97, 0x3e993e98, 0x3e993e99, 0x3e9a3e9a, 0x3e9b3e9b, 0x3e9c3e9c, 0x3e9d3e9d, 0x3e9e3e9d
  .long 0x3e9f3e9e, 0x3ea03e9f, 0x3ea03ea0, 0x3ea13ea1, 0x3ea23ea2, 0x3ea33ea2, 0x3ea43ea3, 0x3ea43ea4
  .long 0x3ea53ea5, 0x3ea63ea6, 0x3ea73ea6, 0x3ea83ea7, 0x3ea83ea8, 0x3ea93ea9, 0x3eaa3ea9, 0x3eaa3eaa
  .long 0x3eac3eab, 0x3ead3eac, 0x3eae3eae, 0x3eb03eaf, 0x3eb13eb0, 0x3eb23eb2, 0x3eb43eb3, 0x3eb53eb4
  .long 0x3eb63eb5, 0x3eb73eb7, 0x3eb83eb8, 0x3eb93eb9, 0x3eba3eba, 0x3ebb3ebb, 0x3ebc3ebc, 0x3ebd3ebd
  .long 0x3ebe3ebe, 0x3ebf3ebf, 0x3ec03ebf, 0x3ec13ec0, 0x3ec13ec1, 0x3ec23ec2, 0x3ec33ec3, 0x3ec43ec3
  .long 0x3ec43ec4, 0x3ec53ec5, 0x3ec63ec5, 0x3ec63ec6, 0x3ec73ec7, 0x3ec73ec7, 0x3ec83ec8, 0x3ec83ec8
  .long 0x3ec93ec9, 0x3ec93ec9, 0x3eca3eca, 0x3eca3eca, 0x3ecb3eca, 0x3ecb3ecb, 0x3ecb3ecb, 0x3ecc3ecb
  .long 0x3ecc3ecc, 0x3ecc3ecc, 0x3ecc3ecc, 0x3ecd3ecd, 0x3ecd3ecd, 0x3ecd3ecd, 0x3ecd3ecd, 0x3ecd3ecd
  .long 0x3ecd3ecd, 0x3ece3ecd, 0x3ece3ece, 0x3ece3ece, 0x3ece3ece, 0x3ece3ece, 0x3ece3ece, 0x3ece3ece
  .long 0x3ece3ece, 0x3ece3ece, 0x3ecd3ece, 0x3ecd3ecd, 0x3ecd3ecd, 0x3ecd3ecd, 0x3ecd3ecd, 0x3ecd3ecd
  .long 0x3ecd3ecd, 0x3ecc3ecc, 0x3ecc3ecc, 0x3ecb3ecb, 0x3eca3ecb, 0x3eca3eca, 0x3ec93ec9, 0x3ec83ec9
  .long 0x3ec73ec8, 0x3ec73ec7, 0x3ec63ec6, 0x3ec53ec5, 0x3ec43ec4, 0x3ec33ec3, 0x3ec23ec2, 0x3ec13ec1
  .long 0x3ebf3ec0, 0x3ebe3ebf, 0x3ebd3ebe, 0x3ebc3ebc, 0x3ebb3ebb, 0x3eb93eba, 0x3eb83eb9, 0x3eb73eb7
  .long 0x3eb53eb6, 0x3eb43eb4, 0x3eb23eb3, 0x3eb13eb2, 0x3eaf3eb0, 0x3eae3eaf, 0x3ead3ead, 0x3eab3eac
  .long 0x3eaa3eaa, 0x3ea83ea9, 0x3ea63ea7, 0x3ea53ea6, 0x3ea33ea4, 0x3ea23ea3, 0x3ea03ea1, 0x3e9f3e9f
  .long 0x3e9d3e9e, 0x3e9b3e9c, 0x3e9a3e9b, 0x3e983e99, 0x3e973e98, 0x3e953e96, 0x3e943e94, 0x3e923e93
  .long 0x3e903e91, 0x3e8f3e90, 0x3e8d3e8e, 0x3e8c3e8c, 0x3e8a3e8b, 0x3e883e89, 0x3e873e88, 0x3e853e86
  .long 0x3e843e84, 0x3e823e83, 0x3e813e81, 0x3e7e3e80, 0x3e7b3e7c, 0x3e783e79, 0x3e753e76, 0x3e723e73
  .long 0x3e6c3e6f, 0x3e663e69, 0x3e613e63, 0x3e5b3e5e, 0x3e553e58, 0x3e4f3e52, 0x3e4a3e4d, 0x3e443e47
  .long 0x3e3f3e42, 0x3e3a3e3c, 0x3e353e37, 0x3e303e32, 0x3e2b3e2d, 0x3e263e28, 0x3e213e23, 0x3e1c3e1f
  .long 0x3e183e1a, 0x3e133e16, 0x3e0f3e11, 0x3e0b3e0d, 0x3e073e09, 0x3e033e05, 0x3dfd3e01, 0x3df53df9
  .long 0x3dee3df2, 0x3de73dea, 0x3ddf3de3, 0x3dd93ddc, 0x3dd23dd5, 0x3dcb3dce, 0x3dc53dc8, 0x3dbf3dc2
  .long 0x3db93dbc, 0x3db33db6, 0x3dad3db0, 0x3da73daa, 0x3da23da5, 0x3d9d3d9f, 0x3d983d9a, 0x3d933d95
  .long 0x3d8e3d90, 0x3d893d8c, 0x3d853d87, 0x3d803d83, 0x3d783d7c, 0x3d703d74, 0x3d683d6c, 0x3d603d64
  .long 0x3d593d5c, 0x3d513d55, 0x3d4a3d4e, 0x3d433d47, 0x3d3d3d40, 0x3d363d3a, 0x3d303d33, 0x3d2a3d2d
  .long 0x3d243d27, 0x3d1f3d22, 0x3d193d1c, 0x3d143d17, 0x3d0f3d11, 0x3d0a3d0c, 0x3d053d08, 0x3d013d03
  .long 0x3cf23cfb, 0x3ce13ce9, 0x3cd23cd9, 0x3cc33cca, 0x3cb63cbc, 0x3ca93caf, 0x3c9d3ca3, 0x3c923c98
  .long 0x3c883c8d, 0x3c7d3c83, 0x3c6b3c74, 0x3c5b3c63, 0x3c4b3c53, 0x3c3d3c44, 0x3c2f3c36, 0x3c233c29
  .long 0x3c173c1d, 0x3c0c3c12, 0x3c023c07, 0x3bf23bfb, 0x3be03be9, 0x3bd03bd8, 0x3bc13bc9, 0x3bb33bba
  .long 0x3ba63bad, 0x3b9a3ba0, 0x3b8f3b94, 0x3b853b8a, 0x3b763b7f, 0x3b643b6d, 0x3b533b5b, 0x3b443b4b
  .long 0x3b353b3c, 0x3b283b2e, 0x3b1c3b22, 0x3b103b16, 0x3b053b0b, 0x3af73b00, 0x3ae53aee, 0x3ad43adc
  .long 0x3ac43acc, 0x3ab63abd, 0x3aa83aaf, 0x3a9c3aa2, 0x3a903a96, 0x3a853a8b, 0x3a773a80, 0x3a643a6d
  .long 0x3a533a5c, 0x3a433a4b, 0x3a353a3c, 0x3a273a2e, 0x3a1b3a21, 0x3a0f3a15, 0x3a043a0a, 0x39f539ff
  .long 0x39e239eb, 0x39d139da, 0x39c139c9, 0x39b339ba, 0x39a539ac, 0x3999399f, 0x398d3993, 0x39833988
  .long 0x39633976, 0x39423952, 0x39263933, 0x390d3919, 0x38f13903, 0x38ce38df, 0x38b038be, 0x389638a2
  .long 0x3880388a, 0x385a386c, 0x383a3849, 0x381e382b, 0x38073812, 0x37e637f9, 0x37c437d4, 0x37a737b4
  .long 0x378e379a, 0x37713783, 0x374e375f, 0x372f373e, 0x37153721, 0x36fd3709, 0x36d736ea, 0x36b736c7
  .long 0x369c36a9, 0x36853690, 0x36613674, 0x36403650, 0x36233631, 0x360a3616, 0x35eb35ff, 0x35c835d9
  .long 0x35aa35b8, 0x3590359d, 0x35753585, 0x35503562, 0x35313540, 0x35163523, 0x34ff350a, 0x34d934eb
  .long 0x34b834c8, 0x349c34aa, 0x34853490, 0x34613474, 0x343f344f, 0x34223430, 0x340a3415, 0x33e933fd
  .long 0x33c633d7, 0x33a833b6, 0x338f339b, 0x33723383, 0x334d335f, 0x332e333d, 0x33133320, 0x32fa3308
  .long 0x32d432e6, 0x32b432c3, 0x329832a6, 0x3281328c, 0x325b326e, 0x323a324a, 0x321d322b, 0x32053211
  .long 0x31c831ec, 0x318f31a9, 0x314e3173, 0x3114312e, 0x30d430fa, 0x309830b4, 0x305a3081, 0x301c3039
  .long 0x2fe03005, 0x2fa12fbe, 0x2f672f88, 0x2f252f43, 0x2eed2f0c, 0x2eaa2ec8, 0x2e732e90, 0x2e2e2e4e
  .long 0x2df92e13, 0x2db22dd3, 0x2d7f2d97, 0x2d372d58, 0x2d032d1b, 0x2cbb2cdd, 0x2c862c9e, 0x2c3f2c62
  .long 0x2c092c22, 0x2bc42be7, 0x2b8c2ba6, 0x2b482b6d, 0x2b0f2b29, 0x2acc2af2, 0x2a922aad, 0x2a512a77
  .long 0x2a152a31, 0x29d529fc, 0x299829b4, 0x295a2981, 0x291b2938, 0x28de2903, 0x289e28bc, 0x28622886
  .long 0x2822283f, 0x27e72808, 0x27a527c3, 0x276b278b, 0x27282747, 0x26ef270e, 0x26ab26ca, 0x26742690
  .long 0x262e264e, 0x25f82613, 0x25b125d2, 0x257c2595, 0x25342555, 0x25002518, 0x24b724d9, 0x2483249b
  .long 0x243a245d, 0x2405241d, 0x23bd23e0, 0x238723a0, 0x23402364, 0x23092322, 0x22c322e8, 0x228b22a5
  .long 0x221a2258, 0x219c21db, 0x211f215f, 0x20a120e2, 0x20242066, 0x1fa61fe9, 0x1f281f6c, 0x1eab1ef0
  .long 0x1e2d1e73, 0x1daf1df6, 0x1d321d7a, 0x1cb41cfd, 0x1c371c80, 0x1bb91c02, 0x1b3b1b84, 0x1abe1b05
  .long 0x1a401a87, 0x19c21a09, 0x1945198a, 0x18c7190c, 0x184a188e, 0x17cc180f, 0x174e1791, 0x16d11713
  .long 0x16531694, 0x15d51616, 0x15581598, 0x14da1519, 0x145d149b, 0x13df141d, 0x1361139f, 0x12e41320
  .long 0x126612a2, 0x11e81224, 0x116b11a5, 0x10ed1127, 0x107010a9, 0xff2102a, 0xf740fac, 0xef70f2e
  .long 0xe790eaf, 0xdfc0e31, 0xd7e0db3, 0xd000d34, 0xc810cb6, 0xc030c38, 0xb840bb9, 0xb050b3b
  .long 0xa860abd, 0xa070a3e, 0x98809c0, 0x90a0942, 0x88b08c4, 0x80c0845, 0x78d07c7, 0x70e0749
  .long 0x69006ca, 0x611064c, 0x59205ce, 0x513054f, 0x49404d1, 0x4160453, 0x39703d4, 0x3180356
  .long 0x23702b6, 0x13a01b9, 0x5e00bb, 0x180030, 0x6000c, 0x20003, 0x1, 0x0
  .long 0x0, 0x0, 0x0, 0x0, 0x0, 0x0, 0x0, 0x0
  .long 0x0, 0x0, 0x0, 0x0, 0x0, 0x0, 0x0, 0x0
  .long 0x0, 0x0, 0x0, 0x0, 0x0, 0x0, 0x0, 0x0
  .long 0x0, 0x0, 0x0, 0x0, 0x0, 0x0, 0x0, 0x0
  .long 0x0, 0x0, 0x0, 0x0, 0x0, 0x0, 0x0, 0x0
  .long 0x0, 0x0, 0x0, 0x0, 0x0, 0x0, 0x0, 0x0
  .long 0x0, 0x0, 0x0, 0x0, 0x0, 0x0, 0x0, 0x0
  .long 0x0, 0x0, 0x0, 0x0, 0x0, 0x0, 0x0, 0x0
  .long 0x0, 0x0, 0x0, 0x0, 0x0, 0x0, 0x0, 0x0
  .long 0x0, 0x0, 0x0, 0x0, 0x0, 0x0, 0x0, 0x0
  .long 0x0, 0x0, 0x0, 0x0, 0x0, 0x0, 0x0, 0x0
  .long 0x0, 0x0, 0x0, 0x0, 0x0, 0x0, 0x0, 0x0
  .long 0x0, 0x0, 0x0, 0x0, 0x0, 0x0, 0x0, 0x0
  .long 0x0, 0x0, 0x0, 0x0, 0x0, 0x0, 0x0, 0x0
  .long 0x0, 0x0, 0x0, 0x0, 0x0, 0x0, 0x0, 0x0
  .long 0x80018000, 0x80028001, 0x80038002, 0x80048003, 0x80058004, 0x80068005, 0x80078006, 0x80088007
  .long 0x80098008, 0x800a8009, 0x800b800a, 0x800c800b, 0x800d800c, 0x800e800d, 0x800f800e, 0x8010800f
  .long 0x80118010, 0x80128011, 0x80138012, 0x80148013, 0x80158014, 0x80168015, 0x80178016, 0x80188017
  .long 0x80198018, 0x801a8019, 0x801b801a, 0x801c801b, 0x801d801c, 0x801e801d, 0x801f801e, 0x8020801f
  .long 0x80218020, 0x80228021, 0x80238022, 0x80248023, 0x80258024, 0x80268025, 0x80278026, 0x80288027
  .long 0x80298028, 0x802a8029, 0x802b802a, 0x802c802b, 0x802d802c, 0x802e802d, 0x802f802e, 0x8030802f
  .long 0x80318030, 0x80328031, 0x80338032, 0x80348033, 0x80358034, 0x80368035, 0x80378036, 0x80388037
  .long 0x80398038, 0x803a8039, 0x803b803a, 0x803c803b, 0x803d803c, 0x803e803d, 0x803f803e, 0x8040803f
  .long 0x80418040, 0x80428041, 0x80438042, 0x80448043, 0x80458044, 0x80468045, 0x80478046, 0x80488047
  .long 0x80498048, 0x804a8049, 0x804b804a, 0x804c804b, 0x804d804c, 0x804e804d, 0x804f804e, 0x8050804f
  .long 0x80518050, 0x80528051, 0x80538052, 0x80548053, 0x80558054, 0x80568055, 0x80578056, 0x80588057
  .long 0x80598058, 0x805a8059, 0x805b805a, 0x805c805b, 0x805d805c, 0x805e805d, 0x805f805e, 0x8060805f
  .long 0x80618060, 0x80628061, 0x80638062, 0x80648063, 0x80658064, 0x80668065, 0x80678066, 0x80688067
  .long 0x80698068, 0x806a8069, 0x806b806a, 0x806c806b, 0x806d806c, 0x806e806d, 0x806f806e, 0x8070806f
  .long 0x80718070, 0x80728071, 0x80738072, 0x80748073, 0x80758074, 0x80768075, 0x80778076, 0x80788077
  .long 0x80798078, 0x807a8079, 0x807b807a, 0x807c807b, 0x807d807c, 0x807e807d, 0x807f807e, 0x8080807f
  .long 0x80828080, 0x80848082, 0x80868084, 0x80888086, 0x808a8088, 0x808c808a, 0x808e808c, 0x8090808e
  .long 0x80928090, 0x80948092, 0x80968094, 0x80988096, 0x809a8098, 0x809c809a, 0x809e809c, 0x80a0809e
  .long 0x80a280a0, 0x80a480a2, 0x80a680a4, 0x80a880a6, 0x80aa80a8, 0x80ac80aa, 0x80ae80ac, 0x80b080ae
  .long 0x80b280b0, 0x80b480b2, 0x80b680b4, 0x80b880b6, 0x80ba80b8, 0x80bc80ba, 0x80be80bc, 0x80c080be
  .long 0x80c280c0, 0x80c480c2, 0x80c680c4, 0x80c880c6, 0x80ca80c8, 0x80cc80ca, 0x80ce80cc, 0x80d080ce
  .long 0x80d280d0, 0x80d480d2, 0x80d680d4, 0x80d880d6, 0x80da80d8, 0x80dc80da, 0x80de80dc, 0x80e080de
  .long 0x80e280e0, 0x80e480e2, 0x80e680e4, 0x80e880e6, 0x80ea80e8, 0x80ec80ea, 0x80ee80ec, 0x80f080ee
  .long 0x80f280f0, 0x80f480f2, 0x80f680f4, 0x80f880f6, 0x80fa80f8, 0x80fc80fa, 0x80fe80fc, 0x810080fe
  .long 0x81028100, 0x81048102, 0x81068104, 0x81088106, 0x810a8108, 0x810c810a, 0x810e810c, 0x8110810e
  .long 0x81128110, 0x81148112, 0x81168114, 0x81188116, 0x811a8118, 0x811c811a, 0x811e811c, 0x8120811e
  .long 0x81228120, 0x81248122, 0x81268124, 0x81288126, 0x812a8128, 0x812c812a, 0x812e812c, 0x8130812e
  .long 0x81328130, 0x81348132, 0x81368134, 0x81388136, 0x813a8138, 0x813c813a, 0x813e813c, 0x8140813e
  .long 0x81428140, 0x81448142, 0x81468144, 0x81488146, 0x814a8148, 0x814c814a, 0x814e814c, 0x8150814e
  .long 0x81528150, 0x81548152, 0x81568154, 0x81588156, 0x815a8158, 0x815c815a, 0x815e815c, 0x8160815e
  .long 0x81628160, 0x81648162, 0x81668164, 0x81688166, 0x816a8168, 0x816c816a, 0x816e816c, 0x8170816e
  .long 0x81728170, 0x81748172, 0x81768174, 0x81788176, 0x817a8178, 0x817c817a, 0x817e817c, 0x8180817e
  .long 0x81828180, 0x81848182, 0x81868184, 0x81888186, 0x818a8188, 0x818c818a, 0x818e818c, 0x8190818e
  .long 0x81928190, 0x81948192, 0x81968194, 0x81988196, 0x819a8198, 0x819c819a, 0x819e819c, 0x81a0819e
  .long 0x81a281a0, 0x81a481a2, 0x81a681a4, 0x81a881a6, 0x81aa81a8, 0x81ac81aa, 0x81ae81ac, 0x81b081ae
  .long 0x81b281b0, 0x81b481b2, 0x81b681b4, 0x81b881b6, 0x81ba81b8, 0x81bc81ba, 0x81be81bc, 0x81c081be
  .long 0x81c281c0, 0x81c481c2, 0x81c681c4, 0x81c881c6, 0x81ca81c8, 0x81cc81ca, 0x81ce81cc, 0x81d081ce
  .long 0x81d281d0, 0x81d481d2, 0x81d681d4, 0x81d881d6, 0x81da81d8, 0x81dc81da, 0x81de81dc, 0x81e081de
  .long 0x81e281e0, 0x81e481e2, 0x81e681e4, 0x81e881e6, 0x81ea81e8, 0x81ec81ea, 0x81ee81ec, 0x81f081ee
  .long 0x81f281f0, 0x81f481f2, 0x81f681f4, 0x81f881f6, 0x81fa81f8, 0x81fc81fa, 0x81fe81fc, 0x820081fe
  .long 0x82028200, 0x82048202, 0x82068204, 0x82088206, 0x820a8208, 0x820c820a, 0x820e820c, 0x8210820e
  .long 0x82128210, 0x82148212, 0x82168214, 0x82188216, 0x821a8218, 0x821c821a, 0x821e821c, 0x8220821e
  .long 0x82228220, 0x82248222, 0x82268224, 0x82288226, 0x822a8228, 0x822c822a, 0x822e822c, 0x8230822e
  .long 0x82328230, 0x82348232, 0x82368234, 0x82388236, 0x823a8238, 0x823c823a, 0x823e823c, 0x8240823e
  .long 0x82428240, 0x82448242, 0x82468244, 0x82488246, 0x824a8248, 0x824c824a, 0x824e824c, 0x8250824e
  .long 0x82528250, 0x82548252, 0x82568254, 0x82588256, 0x825a8258, 0x825c825a, 0x825e825c, 0x8260825e
  .long 0x82628260, 0x82648262, 0x82668264, 0x82688266, 0x826a8268, 0x826c826a, 0x826e826c, 0x8270826e
  .long 0x82728270, 0x82748272, 0x82768274, 0x82788276, 0x827a8278, 0x827c827a, 0x827e827c, 0x8280827e
  .long 0x82828280, 0x82848282, 0x82868284, 0x82888286, 0x828a8288, 0x828c828a, 0x828e828c, 0x8290828e
  .long 0x82928290, 0x82948292, 0x82968294, 0x82988296, 0x829a8298, 0x829c829a, 0x829e829c, 0x82a0829e
  .long 0x82a282a0, 0x82a482a2, 0x82a682a4, 0x82a882a6, 0x82aa82a8, 0x82ac82aa, 0x82ae82ac, 0x82b082ae
  .long 0x82b282b0, 0x82b482b2, 0x82b682b4, 0x82b882b6, 0x82ba82b8, 0x82bc82ba, 0x82be82bc, 0x82c082be
  .long 0x82c282c0, 0x82c482c2, 0x82c682c4, 0x82c882c6, 0x82ca82c8, 0x82cc82ca, 0x82ce82cc, 0x82d082ce
  .long 0x82d282d0, 0x82d482d2, 0x82d682d4, 0x82d882d6, 0x82da82d8, 0x82dc82da, 0x82de82dc, 0x82e082de
  .long 0x82e282e0, 0x82e482e2, 0x82e682e4, 0x82e882e6, 0x82ea82e8, 0x82ec82ea, 0x82ee82ec, 0x82f082ee
  .long 0x82f282f0, 0x82f482f2, 0x82f682f4, 0x82f882f6, 0x82fa82f8, 0x82fc82fa, 0x82fe82fc, 0x830082fe
  .long 0x83028300, 0x83048302, 0x83068304, 0x83088306, 0x830a8308, 0x830c830a, 0x830e830c, 0x8310830e
  .long 0x83128310, 0x83148312, 0x83168314, 0x83188316, 0x831a8318, 0x831c831a, 0x831e831c, 0x8320831e
  .long 0x83228320, 0x83248322, 0x83268324, 0x83288326, 0x832a8328, 0x832c832a, 0x832e832c, 0x8330832e
  .long 0x83328330, 0x83348332, 0x83368334, 0x83388336, 0x833a8338, 0x833c833a, 0x833e833c, 0x8340833e
  .long 0x83428340, 0x83448342, 0x83468344, 0x83488346, 0x834a8348, 0x834c834a, 0x834e834c, 0x8350834e
  .long 0x83528350, 0x83548352, 0x83568354, 0x83588356, 0x835a8358, 0x835c835a, 0x835e835c, 0x8360835e
  .long 0x83628360, 0x83648362, 0x83668364, 0x83688366, 0x836a8368, 0x836c836a, 0x836e836c, 0x8370836e
  .long 0x83728370, 0x83748372, 0x83768374, 0x83788376, 0x837a8378, 0x837c837a, 0x837e837c, 0x8380837e
  .long 0x83828380, 0x83848382, 0x83868384, 0x83888386, 0x838a8388, 0x838c838a, 0x838e838c, 0x8390838e
  .long 0x83928390, 0x83948392, 0x83968394, 0x83988396, 0x839a8398, 0x839c839a, 0x839e839c, 0x83a0839e
  .long 0x83a283a0, 0x83a483a2, 0x83a683a4, 0x83a883a6, 0x83aa83a8, 0x83ac83aa, 0x83ae83ac, 0x83b083ae
  .long 0x83b283b0, 0x83b483b2, 0x83b683b4, 0x83b883b6, 0x83ba83b8, 0x83bc83ba, 0x83be83bc, 0x83c083be
  .long 0x83c283c0, 0x83c483c2, 0x83c683c4, 0x83c883c6, 0x83ca83c8, 0x83cc83ca, 0x83ce83cc, 0x83d083ce
  .long 0x83d283d0, 0x83d483d2, 0x83d683d4, 0x83d883d6, 0x83da83d8, 0x83dc83da, 0x83de83dc, 0x83e083de
  .long 0x83e283e0, 0x83e483e2, 0x83e683e4, 0x83e883e6, 0x83ea83e8, 0x83ec83ea, 0x83ee83ec, 0x83f083ee
  .long 0x83f283f0, 0x83f483f2, 0x83f683f4, 0x83f883f6, 0x83fa83f8, 0x83fc83fa, 0x83fe83fc, 0x840083fe
  .long 0x84028400, 0x84048402, 0x84068404, 0x84088406, 0x840a8408, 0x840c840a, 0x840e840c, 0x8410840e
  .long 0x84128410, 0x84148412, 0x84168414, 0x84188416, 0x841a8418, 0x841c841a, 0x841e841c, 0x8420841e
  .long 0x84228420, 0x84248422, 0x84268424, 0x84288426, 0x842a8428, 0x842c842a, 0x842e842c, 0x8430842e
  .long 0x84328430, 0x84348432, 0x84368434, 0x84388436, 0x843a8438, 0x843c843a, 0x843e843c, 0x8440843e
  .long 0x84428440, 0x84448442, 0x84468444, 0x84488446, 0x844a8448, 0x844c844a, 0x844e844c, 0x8450844e
  .long 0x84528450, 0x84548452, 0x84568454, 0x84588456, 0x845a8458, 0x845c845a, 0x845e845c, 0x8460845e
  .long 0x84628460, 0x84648462, 0x84668464, 0x84688466, 0x846a8468, 0x846c846a, 0x846e846c, 0x8470846e
  .long 0x84728470, 0x84748472, 0x84768474, 0x84788476, 0x847a8478, 0x847c847a, 0x847e847c, 0x8480847e
  .long 0x84828480, 0x84848482, 0x84868484, 0x84888486, 0x848a8488, 0x848c848a, 0x848e848c, 0x8490848e
  .long 0x84928490, 0x84948492, 0x84968494, 0x84988496, 0x849a8498, 0x849c849a, 0x849e849c, 0x84a0849e
  .long 0x84a284a0, 0x84a484a2, 0x84a684a4, 0x84a884a6, 0x84aa84a8, 0x84ac84aa, 0x84ae84ac, 0x84b084ae
  .long 0x84b284b0, 0x84b484b2, 0x84b684b4, 0x84b884b6, 0x84ba84b8, 0x84bc84ba, 0x84be84bc, 0x84c084be
  .long 0x84c284c0, 0x84c484c2, 0x84c684c4, 0x84c884c6, 0x84ca84c8, 0x84cc84ca, 0x84ce84cc, 0x84d084ce
  .long 0x84d284d0, 0x84d484d2, 0x84d684d4, 0x84d884d6, 0x84da84d8, 0x84dc84da, 0x84de84dc, 0x84e084de
  .long 0x84e284e0, 0x84e484e2, 0x84e684e4, 0x84e884e6, 0x84ea84e8, 0x84ec84ea, 0x84ee84ec, 0x84f084ee
  .long 0x84f284f0, 0x84f484f2, 0x84f684f4, 0x84f884f6, 0x84fa84f8, 0x84fc84fa, 0x84fe84fc, 0x850084fe
  .long 0x85028500, 0x85048502, 0x85068504, 0x85088506, 0x850a8508, 0x850c850a, 0x850e850c, 0x8510850e
  .long 0x85128510, 0x85148512, 0x85168514, 0x85188516, 0x851a8518, 0x851c851a, 0x851e851c, 0x8520851e
  .long 0x85228520, 0x85248522, 0x85268524, 0x85288526, 0x852a8528, 0x852c852a, 0x852e852c, 0x8530852e
  .long 0x85328530, 0x85348532, 0x85368534, 0x85388536, 0x853a8538, 0x853c853a, 0x853e853c, 0x8540853e
  .long 0x85428540, 0x85448542, 0x85468544, 0x85488546, 0x854a8548, 0x854c854a, 0x854e854c, 0x8550854e
  .long 0x85528550, 0x85548552, 0x85568554, 0x85588556, 0x855a8558, 0x855c855a, 0x855e855c, 0x8560855e
  .long 0x85628560, 0x85648562, 0x85668564, 0x85688566, 0x856a8568, 0x856c856a, 0x856e856c, 0x8570856e
  .long 0x85728570, 0x85748572, 0x85768574, 0x85788576, 0x857a8578, 0x857c857a, 0x857e857c, 0x8580857e
  .long 0x85828580, 0x85848582, 0x85868584, 0x85888586, 0x858a8588, 0x858c858a, 0x858e858c, 0x8590858e
  .long 0x85928590, 0x85948592, 0x85968594, 0x85988596, 0x859a8598, 0x859c859a, 0x859e859c, 0x85a0859e
  .long 0x85a285a0, 0x85a485a2, 0x85a685a4, 0x85a885a6, 0x85aa85a8, 0x85ac85aa, 0x85ae85ac, 0x85b085ae
  .long 0x85b285b0, 0x85b485b2, 0x85b685b4, 0x85b885b6, 0x85ba85b8, 0x85bc85ba, 0x85be85bc, 0x85c085be
  .long 0x85c285c0, 0x85c485c2, 0x85c685c4, 0x85c885c6, 0x85ca85c8, 0x85cc85ca, 0x85ce85cc, 0x85d085ce
  .long 0x85d285d0, 0x85d485d2, 0x85d685d4, 0x85d885d6, 0x85da85d8, 0x85dc85da, 0x85de85dc, 0x85e085de
  .long 0x85e285e0, 0x85e485e2, 0x85e685e4, 0x85e885e6, 0x85ea85e8, 0x85ec85ea, 0x85ee85ec, 0x85f085ee
  .long 0x85f285f0, 0x85f485f2, 0x85f685f4, 0x85f885f6, 0x85fa85f8, 0x85fc85fa, 0x85fe85fc, 0x860085fe
  .long 0x86028600, 0x86048602, 0x86068604, 0x86088606, 0x860a8608, 0x860c860a, 0x860e860c, 0x8610860e
  .long 0x86128610, 0x86148612, 0x86168614, 0x86188616, 0x861a8618, 0x861c861a, 0x861e861c, 0x8620861e
  .long 0x86228620, 0x86248622, 0x86268624, 0x86288626, 0x862a8628, 0x862c862a, 0x862e862c, 0x8630862e
  .long 0x86328630, 0x86348632, 0x86368634, 0x86388636, 0x863a8638, 0x863c863a, 0x863e863c, 0x8640863e
  .long 0x86428640, 0x86448642, 0x86468644, 0x86488646, 0x864a8648, 0x864c864a, 0x864e864c, 0x8650864e
  .long 0x86528650, 0x86548652, 0x86568654, 0x86588656, 0x865a8658, 0x865c865a, 0x865e865c, 0x8660865e
  .long 0x86628660, 0x86648662, 0x86668664, 0x86688666, 0x866a8668, 0x866c866a, 0x866e866c, 0x8670866e
  .long 0x86728670, 0x86748672, 0x86768674, 0x86788676, 0x867a8678, 0x867c867a, 0x867e867c, 0x8680867e
  .long 0x86828680, 0x86848682, 0x86868684, 0x86888686, 0x868a8688, 0x868c868a, 0x868e868c, 0x8690868e
  .long 0x86928690, 0x86948692, 0x86968694, 0x86988696, 0x869a8698, 0x869c869a, 0x869e869c, 0x86a0869e
  .long 0x86a286a0, 0x86a486a2, 0x86a686a4, 0x86a886a6, 0x86aa86a8, 0x86ac86aa, 0x86ae86ac, 0x86b086ae
  .long 0x86b286b0, 0x86b486b2, 0x86b686b4, 0x86b886b6, 0x86ba86b8, 0x86bc86ba, 0x86be86bc, 0x86c086be
  .long 0x86c286c0, 0x86c486c2, 0x86c686c4, 0x86c886c6, 0x86ca86c8, 0x86cc86ca, 0x86ce86cc, 0x86d086ce
  .long 0x86d286d0, 0x86d486d2, 0x86d686d4, 0x86d886d6, 0x86da86d8, 0x86dc86da, 0x86de86dc, 0x86e086de
  .long 0x86e286e0, 0x86e486e2, 0x86e686e4, 0x86e886e6, 0x86ea86e8, 0x86ec86ea, 0x86ee86ec, 0x86f086ee
  .long 0x86f286f0, 0x86f486f2, 0x86f686f4, 0x86f886f6, 0x86fa86f8, 0x86fc86fa, 0x86fe86fc, 0x870086fe
  .long 0x87028700, 0x87048702, 0x87068704, 0x87088706, 0x870a8708, 0x870c870a, 0x870e870c, 0x8710870e
  .long 0x87128710, 0x87148712, 0x87168714, 0x87188716, 0x871a8718, 0x871c871a, 0x871e871c, 0x8720871e
  .long 0x87228720, 0x87248722, 0x87268724, 0x87288726, 0x872a8728, 0x872c872a, 0x872e872c, 0x8730872e
  .long 0x87328730, 0x87348732, 0x87368734, 0x87388736, 0x873a8738, 0x873c873a, 0x873e873c, 0x8740873e
  .long 0x87428740, 0x87448742, 0x87468744, 0x87488746, 0x874a8748, 0x874c874a, 0x874e874c, 0x8750874e
  .long 0x87528750, 0x87548752, 0x87568754, 0x87588756, 0x875a8758, 0x875c875a, 0x875e875c, 0x8760875e
  .long 0x87628760, 0x87648762, 0x87668764, 0x87688766, 0x876a8768, 0x876c876a, 0x876e876c, 0x8770876e
  .long 0x87728770, 0x87748772, 0x87768774, 0x87788776, 0x877a8778, 0x877c877a, 0x877e877c, 0x8780877e
  .long 0x87828780, 0x87848782, 0x87868784, 0x87888786, 0x878a8788, 0x878c878a, 0x878e878c, 0x8790878e
  .long 0x87928790, 0x87948792, 0x87968794, 0x87988796, 0x879a8798, 0x879c879a, 0x879e879c, 0x87a0879e
  .long 0x87a287a0, 0x87a487a2, 0x87a687a4, 0x87a887a6, 0x87aa87a8, 0x87ac87aa, 0x87ae87ac, 0x87b087ae
  .long 0x87b287b0, 0x87b487b2, 0x87b687b4, 0x87b887b6, 0x87ba87b8, 0x87bc87ba, 0x87be87bc, 0x87c087be
  .long 0x87c287c0, 0x87c487c2, 0x87c687c4, 0x87c887c6, 0x87ca87c8, 0x87cc87ca, 0x87ce87cc, 0x87d087ce
  .long 0x87d287d0, 0x87d487d2, 0x87d687d4, 0x87d887d6, 0x87da87d8, 0x87dc87da, 0x87de87dc, 0x87e087de
  .long 0x87e287e0, 0x87e487e2, 0x87e687e4, 0x87e887e6, 0x87ea87e8, 0x87ec87ea, 0x87ee87ec, 0x87f087ee
  .long 0x87f287f0, 0x87f487f2, 0x87f687f4, 0x87f887f6, 0x87fa87f8, 0x87fc87fa, 0x87fe87fc, 0x880087fe
  .long 0x88028800, 0x88048802, 0x88068804, 0x88088806, 0x880a8808, 0x880c880a, 0x880e880c, 0x8810880e
  .long 0x88128810, 0x88148812, 0x88168814, 0x88188816, 0x881a8818, 0x881c881a, 0x881e881c, 0x8820881e
  .long 0x88228820, 0x88248822, 0x88268824, 0x88288826, 0x882a8828, 0x882c882a, 0x882e882c, 0x8830882e
  .long 0x88328830, 0x88348832, 0x88368834, 0x88388836, 0x883a8838, 0x883c883a, 0x883e883c, 0x8840883e
  .long 0x88428840, 0x88448842, 0x88468844, 0x88488846, 0x884a8848, 0x884c884a, 0x884e884c, 0x8850884e
  .long 0x88528850, 0x88548852, 0x88568854, 0x88588856, 0x885a8858, 0x885c885a, 0x885e885c, 0x8860885e
  .long 0x88628860, 0x88648862, 0x88668864, 0x88688866, 0x886a8868, 0x886c886a, 0x886e886c, 0x8870886e
  .long 0x88728870, 0x88748872, 0x88768874, 0x88788876, 0x887a8878, 0x887c887a, 0x887e887c, 0x8880887e
  .long 0x88828880, 0x88848882, 0x88868884, 0x88888886, 0x888a8888, 0x888c888a, 0x888e888c, 0x8890888e
  .long 0x88928890, 0x88948892, 0x88968894, 0x88988896, 0x889a8898, 0x889c889a, 0x889e889c, 0x88a0889e
  .long 0x88a288a0, 0x88a488a2, 0x88a688a4, 0x88a888a6, 0x88aa88a8, 0x88ac88aa, 0x88ae88ac, 0x88b088ae
  .long 0x88b288b0, 0x88b488b2, 0x88b688b4, 0x88b888b6, 0x88ba88b8, 0x88bc88ba, 0x88be88bc, 0x88c088be
  .long 0x88c288c0, 0x88c488c2, 0x88c688c4, 0x88c888c6, 0x88ca88c8, 0x88cc88ca, 0x88ce88cc, 0x88d088ce
  .long 0x88d288d0, 0x88d488d2, 0x88d688d4, 0x88d888d6, 0x88da88d8, 0x88dc88da, 0x88de88dc, 0x88e088de
  .long 0x88e288e0, 0x88e488e2, 0x88e688e4, 0x88e888e6, 0x88ea88e8, 0x88ec88ea, 0x88ee88ec, 0x88f088ee
  .long 0x88f288f0, 0x88f488f2, 0x88f688f4, 0x88f888f6, 0x88fa88f8, 0x88fc88fa, 0x88fe88fc, 0x890088fe
  .long 0x89028900, 0x89048902, 0x89068904, 0x89088906, 0x890a8908, 0x890c890a, 0x890e890c, 0x8910890e
  .long 0x89128910, 0x89148912, 0x89168914, 0x89188916, 0x891a8918, 0x891c891a, 0x891e891c, 0x8920891e
  .long 0x89228920, 0x89248922, 0x89268924, 0x89288926, 0x892a8928, 0x892c892a, 0x892e892c, 0x8930892e
  .long 0x89328930, 0x89348932, 0x89368934, 0x89388936, 0x893a8938, 0x893c893a, 0x893e893c, 0x8940893e
  .long 0x89428940, 0x89448942, 0x89468944, 0x89488946, 0x894a8948, 0x894c894a, 0x894e894c, 0x8950894e
  .long 0x89528950, 0x89548952, 0x89568954, 0x89588956, 0x895a8958, 0x895c895a, 0x895e895c, 0x8960895e
  .long 0x89628960, 0x89648962, 0x89668964, 0x89688966, 0x896a8968, 0x896c896a, 0x896e896c, 0x8970896e
  .long 0x89728970, 0x89748972, 0x89768974, 0x89788976, 0x897a8978, 0x897c897a, 0x897e897c, 0x8980897e
  .long 0x89828980, 0x89848982, 0x89868984, 0x89888986, 0x898a8988, 0x898c898a, 0x898e898c, 0x8990898e
  .long 0x89928990, 0x89948992, 0x89968994, 0x89988996, 0x899a8998, 0x899c899a, 0x899e899c, 0x89a0899e
  .long 0x89a289a0, 0x89a489a2, 0x89a689a4, 0x89a889a6, 0x89aa89a8, 0x89ac89aa, 0x89ae89ac, 0x89b089ae
  .long 0x89b289b0, 0x89b489b2, 0x89b689b4, 0x89b889b6, 0x89ba89b8, 0x89bc89ba, 0x89be89bc, 0x89c089be
  .long 0x89c289c0, 0x89c489c2, 0x89c689c4, 0x89c889c6, 0x89ca89c8, 0x89cc89ca, 0x89ce89cc, 0x89d089ce
  .long 0x89d289d0, 0x89d489d2, 0x89d689d4, 0x89d889d6, 0x89da89d8, 0x89dc89da, 0x89de89dc, 0x89e089de
  .long 0x89e289e0, 0x89e489e2, 0x89e689e4, 0x89e889e6, 0x89ea89e8, 0x89ec89ea, 0x89ee89ec, 0x89f089ee
  .long 0x89f289f0, 0x89f489f2, 0x89f689f4, 0x89f889f6, 0x89fa89f8, 0x89fc89fa, 0x89fe89fc, 0x8a0089fe
  .long 0x8a028a00, 0x8a048a02, 0x8a068a04, 0x8a088a06, 0x8a0a8a08, 0x8a0c8a0a, 0x8a0e8a0c, 0x8a108a0e
  .long 0x8a128a10, 0x8a148a12, 0x8a168a14, 0x8a188a16, 0x8a1a8a18, 0x8a1c8a1a, 0x8a1e8a1c, 0x8a208a1e
  .long 0x8a228a20, 0x8a248a22, 0x8a268a24, 0x8a288a26, 0x8a2a8a28, 0x8a2c8a2a, 0x8a2e8a2c, 0x8a308a2e
  .long 0x8a328a30, 0x8a348a32, 0x8a368a34, 0x8a388a36, 0x8a3a8a38, 0x8a3c8a3a, 0x8a3e8a3c, 0x8a408a3e
  .long 0x8a428a40, 0x8a448a42, 0x8a468a44, 0x8a488a46, 0x8a4a8a48, 0x8a4c8a4a, 0x8a4e8a4c, 0x8a508a4e
  .long 0x8a528a50, 0x8a548a52, 0x8a568a54, 0x8a588a56, 0x8a5a8a58, 0x8a5c8a5a, 0x8a5e8a5c, 0x8a608a5e
  .long 0x8a628a60, 0x8a648a62, 0x8a668a64, 0x8a688a66, 0x8a6a8a68, 0x8a6c8a6a, 0x8a6e8a6c, 0x8a708a6e
  .long 0x8a728a70, 0x8a748a72, 0x8a768a74, 0x8a788a76, 0x8a7a8a78, 0x8a7c8a7a, 0x8a7e8a7c, 0x8a808a7e
  .long 0x8a828a80, 0x8a848a82, 0x8a868a84, 0x8a888a86, 0x8a8a8a88, 0x8a8c8a8a, 0x8a8e8a8c, 0x8a908a8e
  .long 0x8a928a90, 0x8a948a92, 0x8a968a94, 0x8a988a96, 0x8a9a8a98, 0x8a9c8a9a, 0x8a9e8a9c, 0x8aa08a9e
  .long 0x8aa28aa0, 0x8aa48aa2, 0x8aa68aa4, 0x8aa88aa6, 0x8aaa8aa8, 0x8aac8aaa, 0x8aae8aac, 0x8ab08aae
  .long 0x8ab28ab0, 0x8ab48ab2, 0x8ab68ab4, 0x8ab88ab6, 0x8aba8ab8, 0x8abc8aba, 0x8abe8abc, 0x8ac08abe
  .long 0x8ac28ac0, 0x8ac48ac2, 0x8ac68ac4, 0x8ac88ac6, 0x8aca8ac8, 0x8acc8aca, 0x8ace8acc, 0x8ad08ace
  .long 0x8ad28ad0, 0x8ad48ad2, 0x8ad68ad4, 0x8ad88ad6, 0x8ada8ad8, 0x8adc8ada, 0x8ade8adc, 0x8ae08ade
  .long 0x8ae28ae0, 0x8ae48ae2, 0x8ae68ae4, 0x8ae88ae6, 0x8aea8ae8, 0x8aec8aea, 0x8aee8aec, 0x8af08aee
  .long 0x8af28af0, 0x8af48af2, 0x8af68af4, 0x8af88af6, 0x8afa8af8, 0x8afc8afa, 0x8afe8afc, 0x8b008afe
  .long 0x8b028b00, 0x8b048b02, 0x8b068b04, 0x8b088b06, 0x8b0a8b08, 0x8b0c8b0a, 0x8b0e8b0c, 0x8b108b0e
  .long 0x8b128b10, 0x8b148b12, 0x8b168b14, 0x8b188b16, 0x8b1a8b18, 0x8b1c8b1a, 0x8b1e8b1c, 0x8b208b1e
  .long 0x8b228b20, 0x8b248b22, 0x8b268b24, 0x8b288b26, 0x8b2a8b28, 0x8b2c8b2a, 0x8b2e8b2c, 0x8b308b2e
  .long 0x8b328b30, 0x8b348b32, 0x8b368b34, 0x8b388b36, 0x8b3a8b38, 0x8b3c8b3a, 0x8b3e8b3c, 0x8b408b3e
  .long 0x8b428b40, 0x8b448b42, 0x8b468b44, 0x8b488b46, 0x8b4a8b48, 0x8b4c8b4a, 0x8b4e8b4c, 0x8b508b4e
  .long 0x8b528b50, 0x8b548b52, 0x8b568b54, 0x8b588b56, 0x8b5a8b58, 0x8b5c8b5a, 0x8b5e8b5c, 0x8b608b5e
  .long 0x8b628b60, 0x8b648b62, 0x8b668b64, 0x8b688b66, 0x8b6a8b68, 0x8b6c8b6a, 0x8b6e8b6c, 0x8b708b6e
  .long 0x8b728b70, 0x8b748b72, 0x8b768b74, 0x8b788b76, 0x8b7a8b78, 0x8b7c8b7a, 0x8b7e8b7c, 0x8b808b7e
  .long 0x8b828b80, 0x8b848b82, 0x8b868b84, 0x8b888b86, 0x8b8a8b88, 0x8b8c8b8a, 0x8b8e8b8c, 0x8b908b8e
  .long 0x8b928b90, 0x8b948b92, 0x8b968b94, 0x8b988b96, 0x8b9a8b98, 0x8b9c8b9a, 0x8b9e8b9c, 0x8ba08b9e
  .long 0x8ba28ba0, 0x8ba48ba2, 0x8ba68ba4, 0x8ba88ba6, 0x8baa8ba8, 0x8bac8baa, 0x8bae8bac, 0x8bb08bae
  .long 0x8bb28bb0, 0x8bb48bb2, 0x8bb68bb4, 0x8bb88bb6, 0x8bba8bb8, 0x8bbc8bba, 0x8bbe8bbc, 0x8bc08bbe
  .long 0x8bc28bc0, 0x8bc48bc2, 0x8bc68bc4, 0x8bc88bc6, 0x8bca8bc8, 0x8bcc8bca, 0x8bce8bcc, 0x8bd08bce
  .long 0x8bd28bd0, 0x8bd48bd2, 0x8bd68bd4, 0x8bd88bd6, 0x8bda8bd8, 0x8bdc8bda, 0x8bde8bdc, 0x8be08bde
  .long 0x8be28be0, 0x8be48be2, 0x8be68be4, 0x8be88be6, 0x8bea8be8, 0x8bec8bea, 0x8bee8bec, 0x8bf08bee
  .long 0x8bf28bf0, 0x8bf48bf2, 0x8bf68bf4, 0x8bf88bf6, 0x8bfa8bf8, 0x8bfc8bfa, 0x8bfe8bfc, 0x8c008bfe
  .long 0x8c028c00, 0x8c048c02, 0x8c068c04, 0x8c088c06, 0x8c0a8c08, 0x8c0c8c0a, 0x8c0e8c0c, 0x8c108c0e
  .long 0x8c128c10, 0x8c148c12, 0x8c168c14, 0x8c188c16, 0x8c1a8c18, 0x8c1c8c1a, 0x8c1e8c1c, 0x8c208c1e
  .long 0x8c228c20, 0x8c248c22, 0x8c268c24, 0x8c288c26, 0x8c2a8c28, 0x8c2c8c2a, 0x8c2e8c2c, 0x8c308c2e
  .long 0x8c328c30, 0x8c348c32, 0x8c368c34, 0x8c388c36, 0x8c3a8c38, 0x8c3c8c3a, 0x8c3e8c3c, 0x8c408c3e
  .long 0x8c428c40, 0x8c448c42, 0x8c468c44, 0x8c488c46, 0x8c4a8c48, 0x8c4c8c4a, 0x8c4e8c4c, 0x8c508c4e
  .long 0x8c528c50, 0x8c548c52, 0x8c568c54, 0x8c588c56, 0x8c5a8c58, 0x8c5c8c5a, 0x8c5e8c5c, 0x8c608c5e
  .long 0x8c628c60, 0x8c648c62, 0x8c668c64, 0x8c688c66, 0x8c6a8c68, 0x8c6c8c6a, 0x8c6e8c6c, 0x8c708c6e
  .long 0x8c728c70, 0x8c748c72, 0x8c768c74, 0x8c788c76, 0x8c7a8c78, 0x8c7c8c7a, 0x8c7e8c7c, 0x8c808c7e
  .long 0x8c828c80, 0x8c848c82, 0x8c868c84, 0x8c888c86, 0x8c8a8c88, 0x8c8c8c8a, 0x8c8e8c8c, 0x8c908c8e
  .long 0x8c928c90, 0x8c948c92, 0x8c968c94, 0x8c988c96, 0x8c9a8c98, 0x8c9c8c9a, 0x8c9e8c9c, 0x8ca08c9e
  .long 0x8ca28ca0, 0x8ca48ca2, 0x8ca68ca4, 0x8ca88ca6, 0x8caa8ca8, 0x8cac8caa, 0x8cae8cac, 0x8cb08cae
  .long 0x8cb28cb0, 0x8cb48cb2, 0x8cb68cb4, 0x8cb88cb6, 0x8cba8cb8, 0x8cbc8cba, 0x8cbe8cbc, 0x8cc08cbe
  .long 0x8cc28cc0, 0x8cc48cc2, 0x8cc68cc4, 0x8cc88cc6, 0x8cca8cc8, 0x8ccc8cca, 0x8cce8ccc, 0x8cd08cce
  .long 0x8cd28cd0, 0x8cd48cd2, 0x8cd68cd4, 0x8cd88cd6, 0x8cda8cd8, 0x8cdc8cda, 0x8cde8cdc, 0x8ce08cde
  .long 0x8ce28ce0, 0x8ce48ce2, 0x8ce68ce4, 0x8ce88ce6, 0x8cea8ce8, 0x8cec8cea, 0x8cee8cec, 0x8cf08cee
  .long 0x8cf28cf0, 0x8cf48cf2, 0x8cf68cf4, 0x8cf88cf6, 0x8cfa8cf8, 0x8cfc8cfa, 0x8cfe8cfc, 0x8d008cfe
  .long 0x8d028d00, 0x8d048d02, 0x8d068d04, 0x8d088d06, 0x8d0a8d08, 0x8d0c8d0a, 0x8d0e8d0c, 0x8d108d0e
  .long 0x8d128d10, 0x8d148d12, 0x8d168d14, 0x8d188d16, 0x8d1a8d18, 0x8d1c8d1a, 0x8d1e8d1c, 0x8d208d1e
  .long 0x8d228d20, 0x8d248d22, 0x8d268d24, 0x8d288d26, 0x8d2a8d28, 0x8d2c8d2a, 0x8d2e8d2c, 0x8d308d2e
  .long 0x8d328d30, 0x8d348d32, 0x8d368d34, 0x8d388d36, 0x8d3a8d38, 0x8d3c8d3a, 0x8d3e8d3c, 0x8d408d3e
  .long 0x8d428d40, 0x8d448d42, 0x8d468d44, 0x8d488d46, 0x8d4a8d48, 0x8d4c8d4a, 0x8d4e8d4c, 0x8d508d4e
  .long 0x8d528d50, 0x8d548d52, 0x8d568d54, 0x8d588d56, 0x8d5a8d58, 0x8d5c8d5a, 0x8d5e8d5c, 0x8d608d5e
  .long 0x8d628d60, 0x8d648d62, 0x8d668d64, 0x8d688d66, 0x8d6a8d68, 0x8d6c8d6a, 0x8d6e8d6c, 0x8d708d6e
  .long 0x8d728d70, 0x8d748d72, 0x8d768d74, 0x8d788d76, 0x8d7a8d78, 0x8d7c8d7a, 0x8d7e8d7c, 0x8d808d7e
  .long 0x8d828d80, 0x8d848d82, 0x8d868d84, 0x8d888d86, 0x8d8a8d88, 0x8d8c8d8a, 0x8d8e8d8c, 0x8d908d8e
  .long 0x8d928d90, 0x8d948d92, 0x8d968d94, 0x8d988d96, 0x8d9a8d98, 0x8d9c8d9a, 0x8d9e8d9c, 0x8da08d9e
  .long 0x8da28da0, 0x8da48da2, 0x8da68da4, 0x8da88da6, 0x8daa8da8, 0x8dac8daa, 0x8dae8dac, 0x8db08dae
  .long 0x8db28db0, 0x8db48db2, 0x8db68db4, 0x8db88db6, 0x8dba8db8, 0x8dbc8dba, 0x8dbe8dbc, 0x8dc08dbe
  .long 0x8dc28dc0, 0x8dc48dc2, 0x8dc68dc4, 0x8dc88dc6, 0x8dca8dc8, 0x8dcc8dca, 0x8dce8dcc, 0x8dd08dce
  .long 0x8dd28dd0, 0x8dd48dd2, 0x8dd68dd4, 0x8dd88dd6, 0x8dda8dd8, 0x8ddc8dda, 0x8dde8ddc, 0x8de08dde
  .long 0x8de28de0, 0x8de48de2, 0x8de68de4, 0x8de88de6, 0x8dea8de8, 0x8dec8dea, 0x8dee8dec, 0x8df08dee
  .long 0x8df28df0, 0x8df48df2, 0x8df68df4, 0x8df88df6, 0x8dfa8df8, 0x8dfc8dfa, 0x8dfe8dfc, 0x8e008dfe
  .long 0x8e028e00, 0x8e048e02, 0x8e068e04, 0x8e088e06, 0x8e0a8e08, 0x8e0c8e0a, 0x8e0e8e0c, 0x8e108e0e
  .long 0x8e128e10, 0x8e148e12, 0x8e168e14, 0x8e188e16, 0x8e1a8e18, 0x8e1c8e1a, 0x8e1e8e1c, 0x8e208e1e
  .long 0x8e228e20, 0x8e248e22, 0x8e268e24, 0x8e288e26, 0x8e2a8e28, 0x8e2c8e2a, 0x8e2e8e2c, 0x8e308e2e
  .long 0x8e328e30, 0x8e348e32, 0x8e368e34, 0x8e388e36, 0x8e3a8e38, 0x8e3c8e3a, 0x8e3e8e3c, 0x8e408e3e
  .long 0x8e428e40, 0x8e448e42, 0x8e468e44, 0x8e488e46, 0x8e4a8e48, 0x8e4c8e4a, 0x8e4e8e4c, 0x8e508e4e
  .long 0x8e528e50, 0x8e548e52, 0x8e568e54, 0x8e588e56, 0x8e5a8e58, 0x8e5c8e5a, 0x8e5e8e5c, 0x8e608e5e
  .long 0x8e628e60, 0x8e648e62, 0x8e668e64, 0x8e688e66, 0x8e6a8e68, 0x8e6c8e6a, 0x8e6e8e6c, 0x8e708e6e
  .long 0x8e728e70, 0x8e748e72, 0x8e768e74, 0x8e788e76, 0x8e7a8e78, 0x8e7c8e7a, 0x8e7e8e7c, 0x8e808e7e
  .long 0x8e828e80, 0x8e848e82, 0x8e868e84, 0x8e888e86, 0x8e8a8e88, 0x8e8c8e8a, 0x8e8e8e8c, 0x8e908e8e
  .long 0x8e928e90, 0x8e948e92, 0x8e968e94, 0x8e988e96, 0x8e9a8e98, 0x8e9c8e9a, 0x8e9e8e9c, 0x8ea08e9e
  .long 0x8ea28ea0, 0x8ea48ea2, 0x8ea68ea4, 0x8ea88ea6, 0x8eaa8ea8, 0x8eac8eaa, 0x8eae8eac, 0x8eb08eae
  .long 0x8eb28eb0, 0x8eb48eb2, 0x8eb68eb4, 0x8eb88eb6, 0x8eba8eb8, 0x8ebc8eba, 0x8ebe8ebc, 0x8ec08ebe
  .long 0x8ec28ec0, 0x8ec48ec2, 0x8ec68ec4, 0x8ec88ec6, 0x8eca8ec8, 0x8ecc8eca, 0x8ece8ecc, 0x8ed08ece
  .long 0x8ed28ed0, 0x8ed48ed2, 0x8ed68ed4, 0x8ed88ed6, 0x8eda8ed8, 0x8edc8eda, 0x8ede8edc, 0x8ee08ede
  .long 0x8ee28ee0, 0x8ee48ee2, 0x8ee68ee4, 0x8ee88ee6, 0x8eea8ee8, 0x8eec8eea, 0x8eee8eec, 0x8ef08eee
  .long 0x8ef28ef0, 0x8ef48ef2, 0x8ef68ef4, 0x8ef88ef6, 0x8efa8ef8, 0x8efc8efa, 0x8efe8efc, 0x8f008efe
  .long 0x8f028f00, 0x8f048f02, 0x8f068f04, 0x8f088f06, 0x8f0a8f08, 0x8f0c8f0a, 0x8f0e8f0c, 0x8f108f0e
  .long 0x8f128f10, 0x8f148f12, 0x8f168f14, 0x8f188f16, 0x8f1a8f18, 0x8f1c8f1a, 0x8f1e8f1c, 0x8f208f1e
  .long 0x8f228f20, 0x8f248f22, 0x8f268f24, 0x8f288f26, 0x8f2a8f28, 0x8f2c8f2a, 0x8f2e8f2c, 0x8f308f2e
  .long 0x8f328f30, 0x8f348f32, 0x8f368f34, 0x8f388f36, 0x8f3a8f38, 0x8f3c8f3a, 0x8f3e8f3c, 0x8f408f3e
  .long 0x8f428f40, 0x8f448f42, 0x8f468f44, 0x8f488f46, 0x8f4a8f48, 0x8f4c8f4a, 0x8f4e8f4c, 0x8f508f4e
  .long 0x8f528f50, 0x8f548f52, 0x8f568f54, 0x8f588f56, 0x8f5a8f58, 0x8f5c8f5a, 0x8f5e8f5c, 0x8f608f5e
  .long 0x8f628f60, 0x8f648f62, 0x8f668f64, 0x8f688f66, 0x8f6a8f68, 0x8f6c8f6a, 0x8f6e8f6c, 0x8f708f6e
  .long 0x8f728f70, 0x8f748f72, 0x8f768f74, 0x8f788f76, 0x8f7a8f78, 0x8f7c8f7a, 0x8f7e8f7c, 0x8f808f7e
  .long 0x8f828f80, 0x8f848f82, 0x8f868f84, 0x8f888f86, 0x8f8a8f88, 0x8f8c8f8a, 0x8f8e8f8c, 0x8f908f8e
  .long 0x8f928f90, 0x8f948f92, 0x8f968f94, 0x8f988f96, 0x8f9a8f98, 0x8f9c8f9a, 0x8f9e8f9c, 0x8fa08f9e
  .long 0x8fa28fa0, 0x8fa48fa2, 0x8fa68fa4, 0x8fa88fa6, 0x8faa8fa8, 0x8fac8faa, 0x8fae8fac, 0x8fb08fae
  .long 0x8fb28fb0, 0x8fb48fb2, 0x8fb68fb4, 0x8fb88fb6, 0x8fba8fb8, 0x8fbc8fba, 0x8fbe8fbc, 0x8fc08fbe
  .long 0x8fc28fc0, 0x8fc48fc2, 0x8fc68fc4, 0x8fc88fc6, 0x8fca8fc8, 0x8fcc8fca, 0x8fce8fcc, 0x8fd08fce
  .long 0x8fd28fd0, 0x8fd48fd2, 0x8fd68fd4, 0x8fd88fd6, 0x8fda8fd8, 0x8fdc8fda, 0x8fde8fdc, 0x8fe08fde
  .long 0x8fe28fe0, 0x8fe48fe2, 0x8fe68fe4, 0x8fe88fe6, 0x8fea8fe8, 0x8fec8fea, 0x8fee8fec, 0x8ff08fee
  .long 0x8ff28ff0, 0x8ff48ff2, 0x8ff68ff4, 0x8ff88ff6, 0x8ffa8ff8, 0x8ffc8ffa, 0x8ffe8ffc, 0x90008ffe
  .long 0x90029000, 0x90049002, 0x90069004, 0x90089006, 0x900a9008, 0x900c900a, 0x900e900c, 0x9010900e
  .long 0x90129010, 0x90149012, 0x90169014, 0x90189016, 0x901a9018, 0x901c901a, 0x901e901c, 0x9020901e
  .long 0x90229020, 0x90249022, 0x90269024, 0x90289026, 0x902a9028, 0x902c902a, 0x902e902c, 0x9030902e
  .long 0x90329030, 0x90349032, 0x90369034, 0x90389036, 0x903a9038, 0x903c903a, 0x903e903c, 0x9040903e
  .long 0x90429040, 0x90449042, 0x90469044, 0x90489046, 0x904a9048, 0x904c904a, 0x904e904c, 0x9050904e
  .long 0x90529050, 0x90549052, 0x90569054, 0x90589056, 0x905a9058, 0x905c905a, 0x905e905c, 0x9060905e
  .long 0x90629060, 0x90649062, 0x90669064, 0x90689066, 0x906a9068, 0x906c906a, 0x906e906c, 0x9070906e
  .long 0x90729070, 0x90749072, 0x90769074, 0x90789076, 0x907a9078, 0x907c907a, 0x907e907c, 0x9080907e
  .long 0x90829080, 0x90849082, 0x90869084, 0x90889086, 0x908a9088, 0x908c908a, 0x908e908c, 0x9090908e
  .long 0x90929090, 0x90949092, 0x90969094, 0x90989096, 0x909a9098, 0x909c909a, 0x909e909c, 0x90a0909e
  .long 0x90a290a0, 0x90a490a2, 0x90a690a4, 0x90a890a6, 0x90aa90a8, 0x90ac90aa, 0x90ae90ac, 0x90b090ae
  .long 0x90b290b0, 0x90b490b2, 0x90b690b4, 0x90b890b6, 0x90ba90b8, 0x90bc90ba, 0x90be90bc, 0x90c090be
  .long 0x90c290c0, 0x90c490c2, 0x90c690c4, 0x90c890c6, 0x90ca90c8, 0x90cc90ca, 0x90ce90cc, 0x90d090ce
  .long 0x90d290d0, 0x90d490d2, 0x90d690d4, 0x90d890d6, 0x90da90d8, 0x90dc90da, 0x90de90dc, 0x90e090de
  .long 0x90e290e0, 0x90e490e2, 0x90e690e4, 0x90e890e6, 0x90ea90e8, 0x90ec90ea, 0x90ee90ec, 0x90f090ee
  .long 0x90f290f0, 0x90f490f2, 0x90f690f4, 0x90f890f6, 0x90fa90f8, 0x90fc90fa, 0x90fe90fc, 0x910090fe
  .long 0x91029100, 0x91049102, 0x91069104, 0x91089106, 0x910a9108, 0x910c910a, 0x910e910c, 0x9110910e
  .long 0x91129110, 0x91149112, 0x91169114, 0x91189116, 0x911a9118, 0x911c911a, 0x911e911c, 0x9120911e
  .long 0x91229120, 0x91249122, 0x91269124, 0x91289126, 0x912a9128, 0x912c912a, 0x912e912c, 0x9130912e
  .long 0x91329130, 0x91349132, 0x91369134, 0x91389136, 0x913a9138, 0x913c913a, 0x913e913c, 0x9140913e
  .long 0x91429140, 0x91449142, 0x91469144, 0x91489146, 0x914a9148, 0x914c914a, 0x914e914c, 0x9150914e
  .long 0x91529150, 0x91549152, 0x91569154, 0x91589156, 0x915a9158, 0x915c915a, 0x915e915c, 0x9160915e
  .long 0x91629160, 0x91649162, 0x91669164, 0x91689166, 0x916a9168, 0x916c916a, 0x916e916c, 0x9170916e
  .long 0x91729170, 0x91749172, 0x91769174, 0x91789176, 0x917a9178, 0x917c917a, 0x917e917c, 0x9180917e
  .long 0x91829180, 0x91849182, 0x91869184, 0x91889186, 0x918a9188, 0x918c918a, 0x918e918c, 0x9190918e
  .long 0x91929190, 0x91949192, 0x91969194, 0x91989196, 0x919a9198, 0x919c919a, 0x919e919c, 0x91a0919e
  .long 0x91a291a0, 0x91a491a2, 0x91a691a4, 0x91a891a6, 0x91aa91a8, 0x91ac91aa, 0x91ae91ac, 0x91b091ae
  .long 0x91b291b0, 0x91b491b2, 0x91b691b4, 0x91b891b6, 0x91ba91b8, 0x91bc91ba, 0x91be91bc, 0x91c091be
  .long 0x91c291c0, 0x91c491c2, 0x91c691c4, 0x91c891c6, 0x91ca91c8, 0x91cc91ca, 0x91ce91cc, 0x91d091ce
  .long 0x91d291d0, 0x91d491d2, 0x91d691d4, 0x91d891d6, 0x91da91d8, 0x91dc91da, 0x91de91dc, 0x91e091de
  .long 0x91e291e0, 0x91e491e2, 0x91e691e4, 0x91e891e6, 0x91ea91e8, 0x91ec91ea, 0x91ee91ec, 0x91f091ee
  .long 0x91f291f0, 0x91f491f2, 0x91f691f4, 0x91f891f6, 0x91fa91f8, 0x91fc91fa, 0x91fe91fc, 0x920091fe
  .long 0x92029200, 0x92049202, 0x92069204, 0x92089206, 0x920a9208, 0x920c920a, 0x920e920c, 0x9210920e
  .long 0x92129210, 0x92149212, 0x92169214, 0x92189216, 0x921a9218, 0x921c921a, 0x921e921c, 0x9220921e
  .long 0x92229220, 0x92249222, 0x92269224, 0x92289226, 0x922a9228, 0x922c922a, 0x922e922c, 0x9230922e
  .long 0x92329230, 0x92349232, 0x92369234, 0x92389236, 0x923a9238, 0x923c923a, 0x923e923c, 0x9240923e
  .long 0x92429240, 0x92449242, 0x92469244, 0x92489246, 0x924a9248, 0x924c924a, 0x924e924c, 0x9250924e
  .long 0x92529250, 0x92549252, 0x92569254, 0x92589256, 0x925a9258, 0x925c925a, 0x925e925c, 0x9260925e
  .long 0x92629260, 0x92649262, 0x92669264, 0x92689266, 0x926a9268, 0x926c926a, 0x926e926c, 0x9270926e
  .long 0x92729270, 0x92749272, 0x92769274, 0x92789276, 0x927a9278, 0x927c927a, 0x927e927c, 0x9280927e
  .long 0x92829280, 0x92849282, 0x92869284, 0x92889286, 0x928a9288, 0x928c928a, 0x928e928c, 0x9290928e
  .long 0x92929290, 0x92949292, 0x92969294, 0x92989296, 0x929a9298, 0x929c929a, 0x929e929c, 0x92a0929e
  .long 0x92a292a0, 0x92a492a2, 0x92a692a4, 0x92a892a6, 0x92aa92a8, 0x92ac92aa, 0x92ae92ac, 0x92b092ae
  .long 0x92b292b0, 0x92b492b2, 0x92b692b4, 0x92b892b6, 0x92ba92b8, 0x92bc92ba, 0x92be92bc, 0x92c092be
  .long 0x92c292c0, 0x92c492c2, 0x92c692c4, 0x92c892c6, 0x92ca92c8, 0x92cc92ca, 0x92ce92cc, 0x92d092ce
  .long 0x92d292d0, 0x92d492d2, 0x92d692d4, 0x92d892d6, 0x92da92d8, 0x92dc92da, 0x92de92dc, 0x92e092de
  .long 0x92e292e0, 0x92e492e2, 0x92e692e4, 0x92e892e6, 0x92ea92e8, 0x92ec92ea, 0x92ee92ec, 0x92f092ee
  .long 0x92f292f0, 0x92f492f2, 0x92f692f4, 0x92f892f6, 0x92fa92f8, 0x92fc92fa, 0x92fe92fc, 0x930092fe
  .long 0x93029300, 0x93049302, 0x93069304, 0x93089306, 0x930a9308, 0x930c930a, 0x930e930c, 0x9310930e
  .long 0x93129310, 0x93149312, 0x93169314, 0x93189316, 0x931a9318, 0x931c931a, 0x931e931c, 0x9320931e
  .long 0x93229320, 0x93249322, 0x93269324, 0x93289326, 0x932a9328, 0x932c932a, 0x932e932c, 0x9330932e
  .long 0x93329330, 0x93349332, 0x93369334, 0x93389336, 0x933a9338, 0x933c933a, 0x933e933c, 0x9340933e
  .long 0x93429340, 0x93449342, 0x93469344, 0x93489346, 0x934a9348, 0x934c934a, 0x934e934c, 0x9350934e
  .long 0x93529350, 0x93549352, 0x93569354, 0x93589356, 0x935a9358, 0x935c935a, 0x935e935c, 0x9360935e
  .long 0x93629360, 0x93649362, 0x93669364, 0x93689366, 0x936a9368, 0x936c936a, 0x936e936c, 0x9370936e
  .long 0x93729370, 0x93749372, 0x93769374, 0x93789376, 0x937a9378, 0x937c937a, 0x937e937c, 0x9380937e
  .long 0x93829380, 0x93849382, 0x93869384, 0x93889386, 0x938a9388, 0x938c938a, 0x938e938c, 0x9390938e
  .long 0x93929390, 0x93949392, 0x93969394, 0x93989396, 0x939a9398, 0x939c939a, 0x939e939c, 0x93a0939e
  .long 0x93a293a0, 0x93a493a2, 0x93a693a4, 0x93a893a6, 0x93aa93a8, 0x93ac93aa, 0x93ae93ac, 0x93b093ae
  .long 0x93b293b0, 0x93b493b2, 0x93b693b4, 0x93b893b6, 0x93ba93b8, 0x93bc93ba, 0x93be93bc, 0x93c093be
  .long 0x93c293c0, 0x93c493c2, 0x93c693c4, 0x93c893c6, 0x93ca93c8, 0x93cc93ca, 0x93ce93cc, 0x93d093ce
  .long 0x93d293d0, 0x93d493d2, 0x93d693d4, 0x93d893d6, 0x93da93d8, 0x93dc93da, 0x93de93dc, 0x93e093de
  .long 0x93e293e0, 0x93e493e2, 0x93e693e4, 0x93e893e6, 0x93ea93e8, 0x93ec93ea, 0x93ee93ec, 0x93f093ee
  .long 0x93f293f0, 0x93f493f2, 0x93f693f4, 0x93f893f6, 0x93fa93f8, 0x93fc93fa, 0x93fe93fc, 0x940093fe
  .long 0x94029400, 0x94049402, 0x94069404, 0x94089406, 0x940a9408, 0x940c940a, 0x940e940c, 0x9410940e
  .long 0x94129410, 0x94149412, 0x94169414, 0x94189416, 0x941a9418, 0x941c941a, 0x941e941c, 0x9420941e
  .long 0x94229420, 0x94249422, 0x94269424, 0x94289426, 0x942a9428, 0x942c942a, 0x942e942c, 0x9430942e
  .long 0x94329430, 0x94349432, 0x94369434, 0x94389436, 0x943a9438, 0x943c943a, 0x943e943c, 0x9440943e
  .long 0x94429440, 0x94449442, 0x94469444, 0x94489446, 0x944a9448, 0x944c944a, 0x944e944c, 0x9450944e
  .long 0x94529450, 0x94549452, 0x94569454, 0x94589456, 0x945a9458, 0x945c945a, 0x945e945c, 0x9460945e
  .long 0x94629460, 0x94649462, 0x94669464, 0x94689466, 0x946a9468, 0x946c946a, 0x946e946c, 0x9470946e
  .long 0x94729470, 0x94749472, 0x94769474, 0x94789476, 0x947a9478, 0x947c947a, 0x947e947c, 0x9480947e
  .long 0x94829480, 0x94849482, 0x94869484, 0x94889486, 0x948a9488, 0x948c948a, 0x948e948c, 0x9490948e
  .long 0x94929490, 0x94949492, 0x94969494, 0x94989496, 0x949a9498, 0x949c949a, 0x949e949c, 0x94a0949e
  .long 0x94a294a0, 0x94a494a2, 0x94a694a4, 0x94a894a6, 0x94aa94a8, 0x94ac94aa, 0x94ae94ac, 0x94b094ae
  .long 0x94b294b0, 0x94b494b2, 0x94b694b4, 0x94b894b6, 0x94ba94b8, 0x94bc94ba, 0x94be94bc, 0x94c094be
  .long 0x94c294c0, 0x94c494c2, 0x94c694c4, 0x94c894c6, 0x94ca94c8, 0x94cc94ca, 0x94ce94cc, 0x94d094ce
  .long 0x94d294d0, 0x94d494d2, 0x94d694d4, 0x94d894d6, 0x94da94d8, 0x94dc94da, 0x94de94dc, 0x94e094de
  .long 0x94e294e0, 0x94e494e2, 0x94e694e4, 0x94e894e6, 0x94ea94e8, 0x94ec94ea, 0x94ee94ec, 0x94f094ee
  .long 0x94f294f0, 0x94f494f2, 0x94f694f4, 0x94f894f6, 0x94fa94f8, 0x94fc94fa, 0x94fe94fc, 0x950094fe
  .long 0x95029500, 0x95049502, 0x95069504, 0x95089506, 0x950a9508, 0x950c950a, 0x950e950c, 0x9510950e
  .long 0x95129510, 0x95149512, 0x95169514, 0x95189516, 0x951a9518, 0x951c951a, 0x951e951c, 0x9520951e
  .long 0x95229520, 0x95249522, 0x95269524, 0x95289526, 0x952a9528, 0x952c952a, 0x952e952c, 0x9530952e
  .long 0x95329530, 0x95349532, 0x95369534, 0x95389536, 0x953a9538, 0x953c953a, 0x953e953c, 0x9540953e
  .long 0x95429540, 0x95449542, 0x95469544, 0x95489546, 0x954a9548, 0x954c954a, 0x954e954c, 0x9550954e
  .long 0x95529550, 0x95549552, 0x95569554, 0x95589556, 0x955a9558, 0x955c955a, 0x955e955c, 0x9560955e
  .long 0x95629560, 0x95649562, 0x95669564, 0x95689566, 0x956a9568, 0x956c956a, 0x956e956c, 0x9570956e
  .long 0x95729570, 0x95749572, 0x95769574, 0x95789576, 0x957a9578, 0x957c957a, 0x957e957c, 0x9580957e
  .long 0x95829580, 0x95849582, 0x95869584, 0x95889586, 0x958a9588, 0x958c958a, 0x958e958c, 0x9590958e
  .long 0x95929590, 0x95949592, 0x95969594, 0x95989596, 0x959a9598, 0x959c959a, 0x959e959c, 0x95a0959e
  .long 0x95a295a0, 0x95a495a2, 0x95a695a4, 0x95a895a6, 0x95aa95a8, 0x95ac95aa, 0x95ae95ac, 0x95b095ae
  .long 0x95b295b0, 0x95b495b2, 0x95b695b4, 0x95b895b6, 0x95ba95b8, 0x95bc95ba, 0x95be95bc, 0x95c095be
  .long 0x95c295c0, 0x95c495c2, 0x95c695c4, 0x95c895c6, 0x95ca95c8, 0x95cc95ca, 0x95ce95cc, 0x95d095ce
  .long 0x95d295d0, 0x95d495d2, 0x95d695d4, 0x95d895d6, 0x95da95d8, 0x95dc95da, 0x95de95dc, 0x95e095de
  .long 0x95e295e0, 0x95e495e2, 0x95e695e4, 0x95e895e6, 0x95ea95e8, 0x95ec95ea, 0x95ee95ec, 0x95f095ee
  .long 0x95f295f0, 0x95f495f2, 0x95f695f4, 0x95f895f6, 0x95fa95f8, 0x95fc95fa, 0x95fe95fc, 0x960095fe
  .long 0x96029600, 0x96049602, 0x96069604, 0x96089606, 0x960a9608, 0x960c960a, 0x960e960c, 0x9610960e
  .long 0x96129610, 0x96149612, 0x96169614, 0x96189616, 0x961a9618, 0x961c961a, 0x961e961c, 0x9620961e
  .long 0x96229620, 0x96249622, 0x96269624, 0x96289626, 0x962a9628, 0x962c962a, 0x962e962c, 0x9630962e
  .long 0x96329630, 0x96349632, 0x96369634, 0x96389636, 0x963a9638, 0x963c963a, 0x963e963c, 0x9640963e
  .long 0x96429640, 0x96449642, 0x96469644, 0x96489646, 0x964a9648, 0x964c964a, 0x964e964c, 0x9650964e
  .long 0x96529650, 0x96549652, 0x96569654, 0x96589656, 0x965a9658, 0x965c965a, 0x965e965c, 0x9660965e
  .long 0x96629660, 0x96649662, 0x96669664, 0x96689666, 0x966a9668, 0x966c966a, 0x966e966c, 0x9670966e
  .long 0x96729670, 0x96749672, 0x96769674, 0x96789676, 0x967a9678, 0x967c967a, 0x967e967c, 0x9680967e
  .long 0x96829680, 0x96849682, 0x96869684, 0x96889686, 0x968a9688, 0x968c968a, 0x968e968c, 0x9690968e
  .long 0x96929690, 0x96949692, 0x96969694, 0x96989696, 0x969a9698, 0x969c969a, 0x969e969c, 0x96a0969e
  .long 0x96a296a0, 0x96a496a2, 0x96a696a4, 0x96a896a6, 0x96aa96a8, 0x96ac96aa, 0x96ae96ac, 0x96b096ae
  .long 0x96b296b0, 0x96b496b2, 0x96b696b4, 0x96b896b6, 0x96ba96b8, 0x96bc96ba, 0x96be96bc, 0x96c096be
  .long 0x96c296c0, 0x96c496c2, 0x96c696c4, 0x96c896c6, 0x96ca96c8, 0x96cc96ca, 0x96ce96cc, 0x96d096ce
  .long 0x96d296d0, 0x96d496d2, 0x96d696d4, 0x96d896d6, 0x96da96d8, 0x96dc96da, 0x96de96dc, 0x96e096de
  .long 0x96e296e0, 0x96e496e2, 0x96e696e4, 0x96e896e6, 0x96ea96e8, 0x96ec96ea, 0x96ee96ec, 0x96f096ee
  .long 0x96f296f0, 0x96f496f2, 0x96f696f4, 0x96f896f6, 0x96fa96f8, 0x96fc96fa, 0x96fe96fc, 0x970096fe
  .long 0x97029700, 0x97049702, 0x97069704, 0x97089706, 0x970a9708, 0x970c970a, 0x970e970c, 0x9710970e
  .long 0x97129710, 0x97149712, 0x97169714, 0x97189716, 0x971a9718, 0x971c971a, 0x971e971c, 0x9720971e
  .long 0x97229720, 0x97249722, 0x97269724, 0x97289726, 0x972a9728, 0x972c972a, 0x972e972c, 0x9730972e
  .long 0x97329730, 0x97349732, 0x97369734, 0x97389736, 0x973a9738, 0x973c973a, 0x973e973c, 0x9740973e
  .long 0x97429740, 0x97449742, 0x97469744, 0x97489746, 0x974a9748, 0x974c974a, 0x974e974c, 0x9750974e
  .long 0x97529750, 0x97549752, 0x97569754, 0x97589756, 0x975a9758, 0x975c975a, 0x975e975c, 0x9760975e
  .long 0x97629760, 0x97649762, 0x97669764, 0x97689766, 0x976a9768, 0x976c976a, 0x976e976c, 0x9770976e
  .long 0x97729770, 0x97749772, 0x97769774, 0x97789776, 0x977a9778, 0x977c977a, 0x977e977c, 0x9780977e
  .long 0x97829780, 0x97849782, 0x97869784, 0x97889786, 0x978a9788, 0x978c978a, 0x978e978c, 0x9790978e
  .long 0x97929790, 0x97949792, 0x97969794, 0x97989796, 0x979a9798, 0x979c979a, 0x979e979c, 0x97a0979e
  .long 0x97a297a0, 0x97a497a2, 0x97a697a4, 0x97a897a6, 0x97aa97a8, 0x97ac97aa, 0x97ae97ac, 0x97b097ae
  .long 0x97b297b0, 0x97b497b2, 0x97b697b4, 0x97b897b6, 0x97ba97b8, 0x97bc97ba, 0x97be97bc, 0x97c097be
  .long 0x97c297c0, 0x97c497c2, 0x97c697c4, 0x97c897c6, 0x97ca97c8, 0x97cc97ca, 0x97ce97cc, 0x97d097ce
  .long 0x97d297d0, 0x97d497d2, 0x97d697d4, 0x97d897d6, 0x97da97d8, 0x97dc97da, 0x97de97dc, 0x97e097de
  .long 0x97e297e0, 0x97e497e2, 0x97e697e4, 0x97e897e6, 0x97ea97e8, 0x97ec97ea, 0x97ee97ec, 0x97f097ee
  .long 0x97f297f0, 0x97f497f2, 0x97f697f4, 0x97f897f6, 0x97fa97f8, 0x97fc97fa, 0x97fe97fc, 0x980097fe
  .long 0x98029800, 0x98049802, 0x98069804, 0x98089806, 0x980a9808, 0x980c980a, 0x980e980c, 0x9810980e
  .long 0x98129810, 0x98149812, 0x98169814, 0x98189816, 0x981a9818, 0x981c981a, 0x981e981c, 0x9820981e
  .long 0x98229820, 0x98249822, 0x98269824, 0x98289826, 0x982a9828, 0x982c982a, 0x982e982c, 0x9830982e
  .long 0x98329830, 0x98349832, 0x98369834, 0x98389836, 0x983a9838, 0x983c983a, 0x983e983c, 0x9840983e
  .long 0x98429840, 0x98449842, 0x98469844, 0x98489846, 0x984a9848, 0x984c984a, 0x984e984c, 0x9850984e
  .long 0x98529850, 0x98549852, 0x98569854, 0x98589856, 0x985a9858, 0x985c985a, 0x985e985c, 0x9860985e
  .long 0x98629860, 0x98649862, 0x98669864, 0x98689866, 0x986a9868, 0x986c986a, 0x986e986c, 0x9870986e
  .long 0x98729870, 0x98749872, 0x98769874, 0x98789876, 0x987a9878, 0x987c987a, 0x987e987c, 0x9880987e
  .long 0x98829880, 0x98849882, 0x98869884, 0x98889886, 0x988a9888, 0x988c988a, 0x988e988c, 0x9890988e
  .long 0x98929890, 0x98949892, 0x98969894, 0x98989896, 0x989a9898, 0x989c989a, 0x989e989c, 0x98a0989e
  .long 0x98a298a0, 0x98a498a2, 0x98a698a4, 0x98a898a6, 0x98aa98a8, 0x98ac98aa, 0x98ae98ac, 0x98b098ae
  .long 0x98b298b0, 0x98b498b2, 0x98b698b4, 0x98b898b6, 0x98ba98b8, 0x98bc98ba, 0x98be98bc, 0x98c098be
  .long 0x98c298c0, 0x98c498c2, 0x98c698c4, 0x98c898c6, 0x98ca98c8, 0x98cc98ca, 0x98ce98cc, 0x98d098ce
  .long 0x98d298d0, 0x98d498d2, 0x98d698d4, 0x98d898d6, 0x98da98d8, 0x98dc98da, 0x98de98dc, 0x98e098de
  .long 0x98e298e0, 0x98e498e2, 0x98e698e4, 0x98e898e6, 0x98ea98e8, 0x98ec98ea, 0x98ee98ec, 0x98f098ee
  .long 0x98f298f0, 0x98f498f2, 0x98f698f4, 0x98f898f6, 0x98fa98f8, 0x98fc98fa, 0x98fe98fc, 0x990098fe
  .long 0x99029900, 0x99049902, 0x99069904, 0x99089906, 0x990a9908, 0x990c990a, 0x990e990c, 0x9910990e
  .long 0x99129910, 0x99149912, 0x99169914, 0x99189916, 0x991a9918, 0x991c991a, 0x991e991c, 0x9920991e
  .long 0x99229920, 0x99249922, 0x99269924, 0x99289926, 0x992a9928, 0x992c992a, 0x992e992c, 0x9930992e
  .long 0x99329930, 0x99349932, 0x99369934, 0x99389936, 0x993a9938, 0x993c993a, 0x993e993c, 0x9940993e
  .long 0x99429940, 0x99449942, 0x99469944, 0x99489946, 0x994a9948, 0x994c994a, 0x994e994c, 0x9950994e
  .long 0x99529950, 0x99549952, 0x99569954, 0x99589956, 0x995a9958, 0x995c995a, 0x995e995c, 0x9960995e
  .long 0x99629960, 0x99649962, 0x99669964, 0x99689966, 0x996a9968, 0x996c996a, 0x996e996c, 0x9970996e
  .long 0x99729970, 0x99749972, 0x99769974, 0x99789976, 0x997a9978, 0x997c997a, 0x997e997c, 0x9980997e
  .long 0x99829980, 0x99849982, 0x99869984, 0x99889986, 0x998a9988, 0x998c998a, 0x998e998c, 0x9990998e
  .long 0x99929990, 0x99949992, 0x99969994, 0x99989996, 0x999a9998, 0x999c999a, 0x999e999c, 0x99a0999e
  .long 0x99a299a0, 0x99a499a2, 0x99a699a4, 0x99a899a6, 0x99aa99a8, 0x99ac99aa, 0x99ae99ac, 0x99b099ae
  .long 0x99b299b0, 0x99b499b2, 0x99b699b4, 0x99b899b6, 0x99ba99b8, 0x99bc99ba, 0x99be99bc, 0x99c099be
  .long 0x99c299c0, 0x99c499c2, 0x99c699c4, 0x99c899c6, 0x99ca99c8, 0x99cc99ca, 0x99ce99cc, 0x99d099ce
  .long 0x99d299d0, 0x99d499d2, 0x99d699d4, 0x99d899d6, 0x99da99d8, 0x99dc99da, 0x99de99dc, 0x99e099de
  .long 0x99e299e0, 0x99e499e2, 0x99e699e4, 0x99e899e6, 0x99ea99e8, 0x99ec99ea, 0x99ee99ec, 0x99f099ee
  .long 0x99f299f0, 0x99f499f2, 0x99f699f4, 0x99f899f6, 0x99fa99f8, 0x99fc99fa, 0x99fe99fc, 0x9a0099fe
  .long 0x9a029a00, 0x9a049a02, 0x9a069a04, 0x9a089a06, 0x9a0a9a08, 0x9a0c9a0a, 0x9a0e9a0c, 0x9a109a0e
  .long 0x9a129a10, 0x9a149a12, 0x9a169a14, 0x9a189a16, 0x9a1a9a18, 0x9a1c9a1a, 0x9a1e9a1c, 0x9a209a1e
  .long 0x9a229a20, 0x9a249a22, 0x9a269a24, 0x9a289a26, 0x9a2a9a28, 0x9a2c9a2a, 0x9a2e9a2c, 0x9a309a2e
  .long 0x9a329a30, 0x9a349a32, 0x9a369a34, 0x9a389a36, 0x9a3a9a38, 0x9a3c9a3a, 0x9a3e9a3c, 0x9a409a3e
  .long 0x9a429a40, 0x9a449a42, 0x9a469a44, 0x9a489a46, 0x9a4a9a48, 0x9a4c9a4a, 0x9a4e9a4c, 0x9a509a4e
  .long 0x9a529a50, 0x9a549a52, 0x9a569a54, 0x9a589a56, 0x9a5a9a58, 0x9a5c9a5a, 0x9a5e9a5c, 0x9a609a5e
  .long 0x9a629a60, 0x9a649a62, 0x9a669a64, 0x9a689a66, 0x9a6a9a68, 0x9a6c9a6a, 0x9a6e9a6c, 0x9a709a6e
  .long 0x9a729a70, 0x9a749a72, 0x9a769a74, 0x9a789a76, 0x9a7a9a78, 0x9a7c9a7a, 0x9a7e9a7c, 0x9a809a7e
  .long 0x9a829a80, 0x9a849a82, 0x9a869a84, 0x9a889a86, 0x9a8a9a88, 0x9a8c9a8a, 0x9a8e9a8c, 0x9a909a8e
  .long 0x9a929a90, 0x9a949a92, 0x9a969a94, 0x9a989a96, 0x9a9a9a98, 0x9a9c9a9a, 0x9a9e9a9c, 0x9aa09a9e
  .long 0x9aa29aa0, 0x9aa49aa2, 0x9aa69aa4, 0x9aa89aa6, 0x9aaa9aa8, 0x9aac9aaa, 0x9aae9aac, 0x9ab09aae
  .long 0x9ab29ab0, 0x9ab49ab2, 0x9ab69ab4, 0x9ab89ab6, 0x9aba9ab8, 0x9abc9aba, 0x9abe9abc, 0x9ac09abe
  .long 0x9ac29ac0, 0x9ac49ac2, 0x9ac69ac4, 0x9ac89ac6, 0x9aca9ac8, 0x9acc9aca, 0x9ace9acc, 0x9ad09ace
  .long 0x9ad29ad0, 0x9ad49ad2, 0x9ad69ad4, 0x9ad89ad6, 0x9ada9ad8, 0x9adc9ada, 0x9ade9adc, 0x9ae09ade
  .long 0x9ae29ae0, 0x9ae49ae2, 0x9ae69ae4, 0x9ae89ae6, 0x9aea9ae8, 0x9aec9aea, 0x9aee9aec, 0x9af09aee
  .long 0x9af29af0, 0x9af49af2, 0x9af69af4, 0x9af89af6, 0x9afa9af8, 0x9afc9afa, 0x9afe9afc, 0x9b009afe
  .long 0x9b029b00, 0x9b049b02, 0x9b069b04, 0x9b089b06, 0x9b0a9b08, 0x9b0c9b0a, 0x9b0e9b0c, 0x9b109b0e
  .long 0x9b129b10, 0x9b149b12, 0x9b169b14, 0x9b189b16, 0x9b1a9b18, 0x9b1c9b1a, 0x9b1e9b1c, 0x9b209b1e
  .long 0x9b229b20, 0x9b249b22, 0x9b269b24, 0x9b289b26, 0x9b2a9b28, 0x9b2c9b2a, 0x9b2e9b2c, 0x9b309b2e
  .long 0x9b329b30, 0x9b349b32, 0x9b369b34, 0x9b389b36, 0x9b3a9b38, 0x9b3c9b3a, 0x9b3e9b3c, 0x9b409b3e
  .long 0x9b429b40, 0x9b449b42, 0x9b469b44, 0x9b489b46, 0x9b4a9b48, 0x9b4c9b4a, 0x9b4e9b4c, 0x9b509b4e
  .long 0x9b529b50, 0x9b549b52, 0x9b569b54, 0x9b589b56, 0x9b5a9b58, 0x9b5c9b5a, 0x9b5e9b5c, 0x9b609b5e
  .long 0x9b629b60, 0x9b649b62, 0x9b669b64, 0x9b689b66, 0x9b6a9b68, 0x9b6c9b6a, 0x9b6e9b6c, 0x9b709b6e
  .long 0x9b729b70, 0x9b749b72, 0x9b769b74, 0x9b789b76, 0x9b7a9b78, 0x9b7c9b7a, 0x9b7e9b7c, 0x9b809b7e
  .long 0x9b829b80, 0x9b849b82, 0x9b869b84, 0x9b889b86, 0x9b8a9b88, 0x9b8c9b8a, 0x9b8e9b8c, 0x9b909b8e
  .long 0x9b929b90, 0x9b949b92, 0x9b969b94, 0x9b989b96, 0x9b9a9b98, 0x9b9c9b9a, 0x9b9e9b9c, 0x9ba09b9e
  .long 0x9ba29ba0, 0x9ba49ba2, 0x9ba69ba4, 0x9ba89ba6, 0x9baa9ba8, 0x9bac9baa, 0x9bae9bac, 0x9bb09bae
  .long 0x9bb29bb0, 0x9bb49bb2, 0x9bb69bb4, 0x9bb89bb6, 0x9bba9bb8, 0x9bbc9bba, 0x9bbe9bbc, 0x9bc09bbe
  .long 0x9bc29bc0, 0x9bc49bc2, 0x9bc69bc4, 0x9bc89bc6, 0x9bca9bc8, 0x9bcc9bca, 0x9bce9bcc, 0x9bd09bce
  .long 0x9bd29bd0, 0x9bd49bd2, 0x9bd69bd4, 0x9bd89bd6, 0x9bda9bd8, 0x9bdc9bda, 0x9bde9bdc, 0x9be09bde
  .long 0x9be29be0, 0x9be49be2, 0x9be69be4, 0x9be89be6, 0x9bea9be8, 0x9bec9bea, 0x9bee9bec, 0x9bf09bee
  .long 0x9bf29bf0, 0x9bf49bf2, 0x9bf69bf4, 0x9bf89bf6, 0x9bfa9bf8, 0x9bfc9bfa, 0x9bfe9bfc, 0x9c009bfe
  .long 0x9c029c00, 0x9c049c02, 0x9c069c04, 0x9c089c06, 0x9c0a9c08, 0x9c0c9c0a, 0x9c0e9c0c, 0x9c109c0e
  .long 0x9c129c10, 0x9c149c12, 0x9c169c14, 0x9c189c16, 0x9c1a9c18, 0x9c1c9c1a, 0x9c1e9c1c, 0x9c209c1e
  .long 0x9c229c20, 0x9c249c22, 0x9c269c24, 0x9c289c26, 0x9c2a9c28, 0x9c2c9c2a, 0x9c2e9c2c, 0x9c309c2e
  .long 0x9c329c30, 0x9c349c32, 0x9c369c34, 0x9c389c36, 0x9c3a9c38, 0x9c3c9c3a, 0x9c3e9c3c, 0x9c409c3e
  .long 0x9c429c40, 0x9c449c42, 0x9c469c44, 0x9c489c46, 0x9c4a9c48, 0x9c4c9c4a, 0x9c4e9c4c, 0x9c509c4e
  .long 0x9c529c50, 0x9c549c52, 0x9c569c54, 0x9c589c56, 0x9c5a9c58, 0x9c5c9c5a, 0x9c5e9c5c, 0x9c609c5e
  .long 0x9c629c60, 0x9c649c62, 0x9c669c64, 0x9c689c66, 0x9c6a9c68, 0x9c6c9c6a, 0x9c6e9c6c, 0x9c709c6e
  .long 0x9c729c70, 0x9c749c72, 0x9c769c74, 0x9c789c76, 0x9c7a9c78, 0x9c7c9c7a, 0x9c7e9c7c, 0x9c809c7e
  .long 0x9c829c80, 0x9c849c82, 0x9c869c84, 0x9c889c86, 0x9c8a9c88, 0x9c8c9c8a, 0x9c8e9c8c, 0x9c909c8e
  .long 0x9c929c90, 0x9c949c92, 0x9c969c94, 0x9c989c96, 0x9c9a9c98, 0x9c9c9c9a, 0x9c9e9c9c, 0x9ca09c9e
  .long 0x9ca29ca0, 0x9ca49ca2, 0x9ca69ca4, 0x9ca89ca6, 0x9caa9ca8, 0x9cac9caa, 0x9cae9cac, 0x9cb09cae
  .long 0x9cb29cb0, 0x9cb49cb2, 0x9cb69cb4, 0x9cb89cb6, 0x9cba9cb8, 0x9cbc9cba, 0x9cbe9cbc, 0x9cc09cbe
  .long 0x9cc29cc0, 0x9cc49cc2, 0x9cc69cc4, 0x9cc89cc6, 0x9cca9cc8, 0x9ccc9cca, 0x9cce9ccc, 0x9cd09cce
  .long 0x9cd29cd0, 0x9cd49cd2, 0x9cd69cd4, 0x9cd89cd6, 0x9cda9cd8, 0x9cdc9cda, 0x9cde9cdc, 0x9ce09cde
  .long 0x9ce29ce0, 0x9ce49ce2, 0x9ce69ce4, 0x9ce89ce6, 0x9cea9ce8, 0x9cec9cea, 0x9cee9cec, 0x9cf09cee
  .long 0x9cf29cf0, 0x9cf49cf2, 0x9cf69cf4, 0x9cf89cf6, 0x9cfa9cf8, 0x9cfc9cfa, 0x9cfe9cfc, 0x9d009cfe
  .long 0x9d029d00, 0x9d049d02, 0x9d069d04, 0x9d089d06, 0x9d0a9d08, 0x9d0c9d0a, 0x9d0e9d0c, 0x9d109d0e
  .long 0x9d129d10, 0x9d149d12, 0x9d169d14, 0x9d189d16, 0x9d1a9d18, 0x9d1c9d1a, 0x9d1e9d1c, 0x9d209d1e
  .long 0x9d229d20, 0x9d249d22, 0x9d269d24, 0x9d289d26, 0x9d2a9d28, 0x9d2c9d2a, 0x9d2e9d2c, 0x9d309d2e
  .long 0x9d329d30, 0x9d349d32, 0x9d369d34, 0x9d389d36, 0x9d3a9d38, 0x9d3c9d3a, 0x9d3e9d3c, 0x9d409d3e
  .long 0x9d429d40, 0x9d449d42, 0x9d469d44, 0x9d489d46, 0x9d4a9d48, 0x9d4c9d4a, 0x9d4e9d4c, 0x9d509d4e
  .long 0x9d529d50, 0x9d549d52, 0x9d569d54, 0x9d589d56, 0x9d5a9d58, 0x9d5c9d5a, 0x9d5e9d5c, 0x9d609d5e
  .long 0x9d629d60, 0x9d649d62, 0x9d669d64, 0x9d689d66, 0x9d6a9d68, 0x9d6c9d6a, 0x9d6e9d6c, 0x9d709d6e
  .long 0x9d729d70, 0x9d749d72, 0x9d769d74, 0x9d789d76, 0x9d7a9d78, 0x9d7c9d7a, 0x9d7e9d7c, 0x9d809d7e
  .long 0x9d829d80, 0x9d849d82, 0x9d869d84, 0x9d889d86, 0x9d8a9d88, 0x9d8c9d8a, 0x9d8e9d8c, 0x9d909d8e
  .long 0x9d929d90, 0x9d949d92, 0x9d969d94, 0x9d989d96, 0x9d9a9d98, 0x9d9c9d9a, 0x9d9e9d9c, 0x9da09d9e
  .long 0x9da29da0, 0x9da49da2, 0x9da69da4, 0x9da89da6, 0x9daa9da8, 0x9dac9daa, 0x9dae9dac, 0x9db09dae
  .long 0x9db29db0, 0x9db49db2, 0x9db69db4, 0x9db89db6, 0x9dba9db8, 0x9dbc9dba, 0x9dbe9dbc, 0x9dc09dbe
  .long 0x9dc29dc0, 0x9dc49dc2, 0x9dc69dc4, 0x9dc89dc6, 0x9dca9dc8, 0x9dcc9dca, 0x9dce9dcc, 0x9dd09dce
  .long 0x9dd29dd0, 0x9dd49dd2, 0x9dd69dd4, 0x9dd89dd6, 0x9dda9dd8, 0x9ddc9dda, 0x9dde9ddc, 0x9de09dde
  .long 0x9de29de0, 0x9de49de2, 0x9de69de4, 0x9de89de6, 0x9dea9de8, 0x9dec9dea, 0x9dee9dec, 0x9df09dee
  .long 0x9df29df0, 0x9df49df2, 0x9df69df4, 0x9df89df6, 0x9dfa9df8, 0x9dfc9dfa, 0x9dfe9dfc, 0x9e009dfe
  .long 0x9e029e00, 0x9e049e02, 0x9e069e04, 0x9e089e06, 0x9e0a9e08, 0x9e0c9e0a, 0x9e0e9e0c, 0x9e109e0e
  .long 0x9e129e10, 0x9e149e12, 0x9e169e14, 0x9e189e16, 0x9e1a9e18, 0x9e1c9e1a, 0x9e1e9e1c, 0x9e209e1e
  .long 0x9e229e20, 0x9e249e22, 0x9e269e24, 0x9e289e26, 0x9e2a9e28, 0x9e2c9e2a, 0x9e2e9e2c, 0x9e309e2e
  .long 0x9e329e30, 0x9e349e32, 0x9e369e34, 0x9e389e36, 0x9e3a9e38, 0x9e3c9e3a, 0x9e3e9e3c, 0x9e409e3e
  .long 0x9e429e40, 0x9e449e42, 0x9e469e44, 0x9e489e46, 0x9e4a9e48, 0x9e4c9e4a, 0x9e4e9e4c, 0x9e509e4e
  .long 0x9e529e50, 0x9e549e52, 0x9e569e54, 0x9e589e56, 0x9e5a9e58, 0x9e5c9e5a, 0x9e5e9e5c, 0x9e609e5e
  .long 0x9e629e60, 0x9e649e62, 0x9e669e64, 0x9e689e66, 0x9e6a9e68, 0x9e6c9e6a, 0x9e6e9e6c, 0x9e709e6e
  .long 0x9e729e70, 0x9e749e72, 0x9e769e74, 0x9e789e76, 0x9e7a9e78, 0x9e7c9e7a, 0x9e7e9e7c, 0x9e809e7e
  .long 0x9e829e80, 0x9e849e82, 0x9e869e84, 0x9e889e86, 0x9e8a9e88, 0x9e8c9e8a, 0x9e8e9e8c, 0x9e909e8e
  .long 0x9e929e90, 0x9e949e92, 0x9e969e94, 0x9e989e96, 0x9e9a9e98, 0x9e9c9e9a, 0x9e9e9e9c, 0x9ea09e9e
  .long 0x9ea29ea0, 0x9ea49ea2, 0x9ea69ea4, 0x9ea89ea6, 0x9eaa9ea8, 0x9eac9eaa, 0x9eae9eac, 0x9eb09eae
  .long 0x9eb29eb0, 0x9eb49eb2, 0x9eb69eb4, 0x9eb89eb6, 0x9eba9eb8, 0x9ebc9eba, 0x9ebe9ebc, 0x9ec09ebe
  .long 0x9ec29ec0, 0x9ec49ec2, 0x9ec69ec4, 0x9ec89ec6, 0x9eca9ec8, 0x9ecc9eca, 0x9ece9ecc, 0x9ed09ece
  .long 0x9ed29ed0, 0x9ed49ed2, 0x9ed69ed4, 0x9ed89ed6, 0x9eda9ed8, 0x9edc9eda, 0x9ede9edc, 0x9ee09ede
  .long 0x9ee29ee0, 0x9ee49ee2, 0x9ee69ee4, 0x9ee89ee6, 0x9eea9ee8, 0x9eec9eea, 0x9eee9eec, 0x9ef09eee
  .long 0x9ef29ef0, 0x9ef49ef2, 0x9ef69ef4, 0x9ef89ef6, 0x9efa9ef8, 0x9efc9efa, 0x9efe9efc, 0x9f009efe
  .long 0x9f029f00, 0x9f049f02, 0x9f069f04, 0x9f089f06, 0x9f0a9f08, 0x9f0c9f0a, 0x9f0e9f0c, 0x9f109f0e
  .long 0x9f129f10, 0x9f149f12, 0x9f169f14, 0x9f189f16, 0x9f1a9f18, 0x9f1c9f1a, 0x9f1e9f1c, 0x9f209f1e
  .long 0x9f229f20, 0x9f249f22, 0x9f269f24, 0x9f289f26, 0x9f2a9f28, 0x9f2c9f2a, 0x9f2e9f2c, 0x9f309f2e
  .long 0x9f329f30, 0x9f349f32, 0x9f369f34, 0x9f389f36, 0x9f3a9f38, 0x9f3c9f3a, 0x9f3e9f3c, 0x9f409f3e
  .long 0x9f429f40, 0x9f449f42, 0x9f469f44, 0x9f489f46, 0x9f4a9f48, 0x9f4c9f4a, 0x9f4e9f4c, 0x9f509f4e
  .long 0x9f529f50, 0x9f549f52, 0x9f569f54, 0x9f589f56, 0x9f5a9f58, 0x9f5c9f5a, 0x9f5e9f5c, 0x9f609f5e
  .long 0x9f629f60, 0x9f649f62, 0x9f669f64, 0x9f689f66, 0x9f6a9f68, 0x9f6c9f6a, 0x9f6e9f6c, 0x9f709f6e
  .long 0x9f729f70, 0x9f749f72, 0x9f769f74, 0x9f789f76, 0x9f7a9f78, 0x9f7c9f7a, 0x9f7e9f7c, 0x9f809f7e
  .long 0x9f829f80, 0x9f849f82, 0x9f869f84, 0x9f889f86, 0x9f8a9f88, 0x9f8c9f8a, 0x9f8e9f8c, 0x9f909f8e
  .long 0x9f929f90, 0x9f949f92, 0x9f969f94, 0x9f989f96, 0x9f9a9f98, 0x9f9c9f9a, 0x9f9e9f9c, 0x9fa09f9e
  .long 0x9fa29fa0, 0x9fa49fa2, 0x9fa69fa4, 0x9fa89fa6, 0x9faa9fa8, 0x9fac9faa, 0x9fae9fac, 0x9fb09fae
  .long 0x9fb29fb0, 0x9fb49fb2, 0x9fb69fb4, 0x9fb89fb6, 0x9fba9fb8, 0x9fbc9fba, 0x9fbe9fbc, 0x9fc09fbe
  .long 0x9fc29fc0, 0x9fc49fc2, 0x9fc69fc4, 0x9fc89fc6, 0x9fca9fc8, 0x9fcc9fca, 0x9fce9fcc, 0x9fd09fce
  .long 0x9fd29fd0, 0x9fd49fd2, 0x9fd69fd4, 0x9fd89fd6, 0x9fda9fd8, 0x9fdc9fda, 0x9fde9fdc, 0x9fe09fde
  .long 0x9fe29fe0, 0x9fe49fe2, 0x9fe69fe4, 0x9fe89fe6, 0x9fea9fe8, 0x9fec9fea, 0x9fee9fec, 0x9ff09fee
  .long 0x9ff29ff0, 0x9ff49ff2, 0x9ff69ff4, 0x9ff89ff6, 0x9ffa9ff8, 0x9ffc9ffa, 0x9ffe9ffc, 0xa0009ffe
  .long 0xa002a000, 0xa004a002, 0xa006a004, 0xa008a006, 0xa00aa008, 0xa00ca00a, 0xa00ea00c, 0xa010a00e
  .long 0xa012a010, 0xa014a012, 0xa016a014, 0xa018a016, 0xa01aa018, 0xa01ca01a, 0xa01ea01c, 0xa020a01e
  .long 0xa022a020, 0xa024a022, 0xa026a024, 0xa028a026, 0xa02aa028, 0xa02ca02a, 0xa02ea02c, 0xa030a02e
  .long 0xa032a030, 0xa034a032, 0xa036a034, 0xa038a036, 0xa03aa038, 0xa03ca03a, 0xa03ea03c, 0xa040a03e
  .long 0xa042a040, 0xa044a042, 0xa046a044, 0xa048a046, 0xa04aa048, 0xa04ca04a, 0xa04ea04c, 0xa050a04e
  .long 0xa052a050, 0xa054a052, 0xa056a054, 0xa058a056, 0xa05aa058, 0xa05ca05a, 0xa05ea05c, 0xa060a05e
  .long 0xa062a060, 0xa064a062, 0xa066a064, 0xa068a066, 0xa06aa068, 0xa06ca06a, 0xa06ea06c, 0xa070a06e
  .long 0xa072a070, 0xa074a072, 0xa076a074, 0xa078a076, 0xa07aa078, 0xa07ca07a, 0xa07ea07c, 0xa080a07e
  .long 0xa082a080, 0xa084a082, 0xa086a084, 0xa088a086, 0xa08aa088, 0xa08ca08a, 0xa08ea08c, 0xa090a08e
  .long 0xa092a090, 0xa094a092, 0xa096a094, 0xa098a096, 0xa09aa098, 0xa09ca09a, 0xa09ea09c, 0xa0a0a09e
  .long 0xa0a2a0a0, 0xa0a4a0a2, 0xa0a6a0a4, 0xa0a8a0a6, 0xa0aaa0a8, 0xa0aca0aa, 0xa0aea0ac, 0xa0b0a0ae
  .long 0xa0b2a0b0, 0xa0b4a0b2, 0xa0b6a0b4, 0xa0b8a0b6, 0xa0baa0b8, 0xa0bca0ba, 0xa0bea0bc, 0xa0c0a0be
  .long 0xa0c2a0c0, 0xa0c4a0c2, 0xa0c6a0c4, 0xa0c8a0c6, 0xa0caa0c8, 0xa0cca0ca, 0xa0cea0cc, 0xa0d0a0ce
  .long 0xa0d2a0d0, 0xa0d4a0d2, 0xa0d6a0d4, 0xa0d8a0d6, 0xa0daa0d8, 0xa0dca0da, 0xa0dea0dc, 0xa0e0a0de
  .long 0xa0e2a0e0, 0xa0e4a0e2, 0xa0e6a0e4, 0xa0e8a0e6, 0xa0eaa0e8, 0xa0eca0ea, 0xa0eea0ec, 0xa0f0a0ee
  .long 0xa0f2a0f0, 0xa0f4a0f2, 0xa0f6a0f4, 0xa0f8a0f6, 0xa0faa0f8, 0xa0fca0fa, 0xa0fea0fc, 0xa100a0fe
  .long 0xa102a100, 0xa104a102, 0xa106a104, 0xa108a106, 0xa10aa108, 0xa10ca10a, 0xa10ea10c, 0xa110a10e
  .long 0xa112a110, 0xa114a112, 0xa116a114, 0xa118a116, 0xa11aa118, 0xa11ca11a, 0xa11ea11c, 0xa120a11e
  .long 0xa122a120, 0xa124a122, 0xa126a124, 0xa128a126, 0xa12aa128, 0xa12ca12a, 0xa12ea12c, 0xa130a12e
  .long 0xa132a130, 0xa134a132, 0xa136a134, 0xa138a136, 0xa13aa138, 0xa13ca13a, 0xa13ea13c, 0xa140a13e
  .long 0xa142a140, 0xa144a142, 0xa146a144, 0xa148a146, 0xa14aa148, 0xa14ca14a, 0xa14ea14c, 0xa150a14e
  .long 0xa152a150, 0xa154a152, 0xa156a154, 0xa158a156, 0xa15aa158, 0xa15ca15a, 0xa15ea15c, 0xa160a15e
  .long 0xa162a160, 0xa164a162, 0xa166a164, 0xa168a166, 0xa16aa168, 0xa16ca16a, 0xa16ea16c, 0xa170a16e
  .long 0xa172a170, 0xa174a172, 0xa176a174, 0xa178a176, 0xa17aa178, 0xa17ca17a, 0xa17ea17c, 0xa180a17e
  .long 0xa182a180, 0xa184a182, 0xa186a184, 0xa188a186, 0xa18aa188, 0xa18ca18a, 0xa18ea18c, 0xa190a18e
  .long 0xa192a190, 0xa194a192, 0xa196a194, 0xa198a196, 0xa19aa198, 0xa19ca19a, 0xa19ea19c, 0xa1a0a19e
  .long 0xa1a2a1a0, 0xa1a4a1a2, 0xa1a6a1a4, 0xa1a8a1a6, 0xa1aaa1a8, 0xa1aca1aa, 0xa1aea1ac, 0xa1b0a1ae
  .long 0xa1b2a1b0, 0xa1b4a1b2, 0xa1b6a1b4, 0xa1b8a1b6, 0xa1baa1b8, 0xa1bca1ba, 0xa1bea1bc, 0xa1c0a1be
  .long 0xa1c2a1c0, 0xa1c4a1c2, 0xa1c6a1c4, 0xa1c8a1c6, 0xa1caa1c8, 0xa1cca1ca, 0xa1cea1cc, 0xa1d0a1ce
  .long 0xa1d2a1d0, 0xa1d4a1d2, 0xa1d6a1d4, 0xa1d8a1d6, 0xa1daa1d8, 0xa1dca1da, 0xa1dea1dc, 0xa1e0a1de
  .long 0xa1e2a1e0, 0xa1e4a1e2, 0xa1e6a1e4, 0xa1e8a1e6, 0xa1eaa1e8, 0xa1eca1ea, 0xa1eea1ec, 0xa1f0a1ee
  .long 0xa1f2a1f0, 0xa1f4a1f2, 0xa1f6a1f4, 0xa1f8a1f6, 0xa1faa1f8, 0xa1fca1fa, 0xa1fea1fc, 0xa200a1fe
  .long 0xa202a200, 0xa204a202, 0xa206a204, 0xa208a206, 0xa20aa208, 0xa20ca20a, 0xa20ea20c, 0xa210a20e
  .long 0xa212a210, 0xa214a212, 0xa216a214, 0xa218a216, 0xa21aa218, 0xa21ca21a, 0xa21ea21c, 0xa220a21e
  .long 0xa222a220, 0xa224a222, 0xa226a224, 0xa228a226, 0xa22aa228, 0xa22ca22a, 0xa22ea22c, 0xa230a22e
  .long 0xa232a230, 0xa234a232, 0xa236a234, 0xa238a236, 0xa23aa238, 0xa23ca23a, 0xa23ea23c, 0xa240a23e
  .long 0xa242a240, 0xa244a242, 0xa246a244, 0xa248a246, 0xa24aa248, 0xa24ca24a, 0xa24ea24c, 0xa250a24e
  .long 0xa252a250, 0xa254a252, 0xa256a254, 0xa258a256, 0xa25aa258, 0xa25ca25a, 0xa25ea25c, 0xa260a25e
  .long 0xa262a260, 0xa264a262, 0xa266a264, 0xa268a266, 0xa26aa268, 0xa26ca26a, 0xa26ea26c, 0xa270a26e
  .long 0xa272a270, 0xa274a272, 0xa276a274, 0xa278a276, 0xa27aa278, 0xa27ca27a, 0xa27ea27c, 0xa280a27e
  .long 0xa282a280, 0xa284a282, 0xa286a284, 0xa288a286, 0xa28aa288, 0xa28ca28a, 0xa28ea28c, 0xa290a28e
  .long 0xa292a290, 0xa294a292, 0xa296a294, 0xa298a296, 0xa29aa298, 0xa29ca29a, 0xa29ea29c, 0xa2a0a29e
  .long 0xa2a2a2a0, 0xa2a4a2a2, 0xa2a6a2a4, 0xa2a8a2a6, 0xa2aaa2a8, 0xa2aca2aa, 0xa2aea2ac, 0xa2b0a2ae
  .long 0xa2b2a2b0, 0xa2b4a2b2, 0xa2b6a2b4, 0xa2b8a2b6, 0xa2baa2b8, 0xa2bca2ba, 0xa2bea2bc, 0xa2c0a2be
  .long 0xa2c2a2c0, 0xa2c4a2c2, 0xa2c6a2c4, 0xa2c8a2c6, 0xa2caa2c8, 0xa2cca2ca, 0xa2cea2cc, 0xa2d0a2ce
  .long 0xa2d2a2d0, 0xa2d4a2d2, 0xa2d6a2d4, 0xa2d8a2d6, 0xa2daa2d8, 0xa2dca2da, 0xa2dea2dc, 0xa2e0a2de
  .long 0xa2e2a2e0, 0xa2e4a2e2, 0xa2e6a2e4, 0xa2e8a2e6, 0xa2eaa2e8, 0xa2eca2ea, 0xa2eea2ec, 0xa2f0a2ee
  .long 0xa2f2a2f0, 0xa2f4a2f2, 0xa2f6a2f4, 0xa2f8a2f6, 0xa2faa2f8, 0xa2fca2fa, 0xa2fea2fc, 0xa300a2fe
  .long 0xa302a300, 0xa304a302, 0xa306a304, 0xa308a306, 0xa30aa308, 0xa30ca30a, 0xa30ea30c, 0xa310a30e
  .long 0xa312a310, 0xa314a312, 0xa316a314, 0xa318a316, 0xa31aa318, 0xa31ca31a, 0xa31ea31c, 0xa320a31e
  .long 0xa322a320, 0xa324a322, 0xa326a324, 0xa328a326, 0xa32aa328, 0xa32ca32a, 0xa32ea32c, 0xa330a32e
  .long 0xa332a330, 0xa334a332, 0xa336a334, 0xa338a336, 0xa33aa338, 0xa33ca33a, 0xa33ea33c, 0xa340a33e
  .long 0xa342a340, 0xa344a342, 0xa346a344, 0xa348a346, 0xa34aa348, 0xa34ca34a, 0xa34ea34c, 0xa350a34e
  .long 0xa352a350, 0xa354a352, 0xa356a354, 0xa358a356, 0xa35aa358, 0xa35ca35a, 0xa35ea35c, 0xa360a35e
  .long 0xa362a360, 0xa364a362, 0xa366a364, 0xa368a366, 0xa36aa368, 0xa36ca36a, 0xa36ea36c, 0xa370a36e
  .long 0xa372a370, 0xa374a372, 0xa376a374, 0xa378a376, 0xa37aa378, 0xa37ca37a, 0xa37ea37c, 0xa380a37e
  .long 0xa382a380, 0xa384a382, 0xa386a384, 0xa388a386, 0xa38aa388, 0xa38ca38a, 0xa38ea38c, 0xa390a38e
  .long 0xa392a390, 0xa394a392, 0xa396a394, 0xa398a396, 0xa39aa398, 0xa39ca39a, 0xa39ea39c, 0xa3a0a39e
  .long 0xa3a2a3a0, 0xa3a4a3a2, 0xa3a6a3a4, 0xa3a8a3a6, 0xa3aaa3a8, 0xa3aca3aa, 0xa3aea3ac, 0xa3b0a3ae
  .long 0xa3b2a3b0, 0xa3b4a3b2, 0xa3b6a3b4, 0xa3b8a3b6, 0xa3baa3b8, 0xa3bca3ba, 0xa3bea3bc, 0xa3c0a3be
  .long 0xa3c2a3c0, 0xa3c4a3c2, 0xa3c6a3c4, 0xa3c8a3c6, 0xa3caa3c8, 0xa3cca3ca, 0xa3cea3cc, 0xa3d0a3ce
  .long 0xa3d2a3d0, 0xa3d4a3d2, 0xa3d6a3d4, 0xa3d8a3d6, 0xa3daa3d8, 0xa3dca3da, 0xa3dea3dc, 0xa3e0a3de
  .long 0xa3e2a3e0, 0xa3e4a3e2, 0xa3e6a3e4, 0xa3e8a3e6, 0xa3eaa3e8, 0xa3eca3ea, 0xa3eea3ec, 0xa3f0a3ee
  .long 0xa3f2a3f0, 0xa3f4a3f2, 0xa3f6a3f4, 0xa3f8a3f6, 0xa3faa3f8, 0xa3fca3fa, 0xa3fea3fc, 0xa400a3fe
  .long 0xa402a400, 0xa404a402, 0xa406a404, 0xa408a406, 0xa40aa408, 0xa40ca40a, 0xa40ea40c, 0xa410a40e
  .long 0xa412a410, 0xa414a412, 0xa416a414, 0xa418a416, 0xa41aa418, 0xa41ca41a, 0xa41ea41c, 0xa420a41e
  .long 0xa422a420, 0xa424a422, 0xa426a424, 0xa428a426, 0xa42aa428, 0xa42ca42a, 0xa42ea42c, 0xa430a42e
  .long 0xa432a430, 0xa434a432, 0xa436a434, 0xa438a436, 0xa43aa438, 0xa43ca43a, 0xa43ea43c, 0xa440a43e
  .long 0xa442a440, 0xa444a442, 0xa446a444, 0xa448a446, 0xa44aa448, 0xa44ca44a, 0xa44ea44c, 0xa450a44e
  .long 0xa452a450, 0xa454a452, 0xa456a454, 0xa458a456, 0xa45aa458, 0xa45ca45a, 0xa45ea45c, 0xa460a45e
  .long 0xa462a460, 0xa464a462, 0xa466a464, 0xa468a466, 0xa46aa468, 0xa46ca46a, 0xa46ea46c, 0xa470a46e
  .long 0xa472a470, 0xa474a472, 0xa476a474, 0xa478a476, 0xa47aa478, 0xa47ca47a, 0xa47ea47c, 0xa480a47e
  .long 0xa482a480, 0xa484a482, 0xa486a484, 0xa488a486, 0xa48aa488, 0xa48ca48a, 0xa48ea48c, 0xa490a48e
  .long 0xa492a490, 0xa494a492, 0xa496a494, 0xa498a496, 0xa49aa498, 0xa49ca49a, 0xa49ea49c, 0xa4a0a49e
  .long 0xa4a2a4a0, 0xa4a4a4a2, 0xa4a6a4a4, 0xa4a8a4a6, 0xa4aaa4a8, 0xa4aca4aa, 0xa4aea4ac, 0xa4b0a4ae
  .long 0xa4b2a4b0, 0xa4b4a4b2, 0xa4b6a4b4, 0xa4b8a4b6, 0xa4baa4b8, 0xa4bca4ba, 0xa4bea4bc, 0xa4c0a4be
  .long 0xa4c2a4c0, 0xa4c4a4c2, 0xa4c6a4c4, 0xa4c8a4c6, 0xa4caa4c8, 0xa4cca4ca, 0xa4cea4cc, 0xa4d0a4ce
  .long 0xa4d2a4d0, 0xa4d4a4d2, 0xa4d6a4d4, 0xa4d8a4d6, 0xa4daa4d8, 0xa4dca4da, 0xa4dea4dc, 0xa4e0a4de
  .long 0xa4e2a4e0, 0xa4e4a4e2, 0xa4e6a4e4, 0xa4e8a4e6, 0xa4eaa4e8, 0xa4eca4ea, 0xa4eea4ec, 0xa4f0a4ee
  .long 0xa4f2a4f0, 0xa4f4a4f2, 0xa4f6a4f4, 0xa4f8a4f6, 0xa4faa4f8, 0xa4fca4fa, 0xa4fea4fc, 0xa500a4fe
  .long 0xa502a500, 0xa504a502, 0xa506a504, 0xa508a506, 0xa50aa508, 0xa50ca50a, 0xa50ea50c, 0xa510a50e
  .long 0xa512a510, 0xa514a512, 0xa516a514, 0xa518a516, 0xa51aa518, 0xa51ca51a, 0xa51ea51c, 0xa520a51e
  .long 0xa522a520, 0xa524a522, 0xa526a524, 0xa528a526, 0xa52aa528, 0xa52ca52a, 0xa52ea52c, 0xa530a52e
  .long 0xa532a530, 0xa534a532, 0xa536a534, 0xa538a536, 0xa53aa538, 0xa53ca53a, 0xa53ea53c, 0xa540a53e
  .long 0xa542a540, 0xa544a542, 0xa546a544, 0xa548a546, 0xa54aa548, 0xa54ca54a, 0xa54ea54c, 0xa550a54e
  .long 0xa552a550, 0xa554a552, 0xa556a554, 0xa558a556, 0xa55aa558, 0xa55ca55a, 0xa55ea55c, 0xa560a55e
  .long 0xa562a560, 0xa564a562, 0xa566a564, 0xa568a566, 0xa56aa568, 0xa56ca56a, 0xa56ea56c, 0xa570a56e
  .long 0xa572a570, 0xa574a572, 0xa576a574, 0xa578a576, 0xa57aa578, 0xa57ca57a, 0xa57ea57c, 0xa580a57e
  .long 0xa582a580, 0xa584a582, 0xa586a584, 0xa588a586, 0xa58aa588, 0xa58ca58a, 0xa58ea58c, 0xa590a58e
  .long 0xa592a590, 0xa594a592, 0xa596a594, 0xa598a596, 0xa59aa598, 0xa59ca59a, 0xa59ea59c, 0xa5a0a59e
  .long 0xa5a2a5a0, 0xa5a4a5a2, 0xa5a6a5a4, 0xa5a8a5a6, 0xa5aaa5a8, 0xa5aca5aa, 0xa5aea5ac, 0xa5b0a5ae
  .long 0xa5b2a5b0, 0xa5b4a5b2, 0xa5b6a5b4, 0xa5b8a5b6, 0xa5baa5b8, 0xa5bca5ba, 0xa5bea5bc, 0xa5c0a5be
  .long 0xa5c2a5c0, 0xa5c4a5c2, 0xa5c6a5c4, 0xa5c8a5c6, 0xa5caa5c8, 0xa5cca5ca, 0xa5cea5cc, 0xa5d0a5ce
  .long 0xa5d2a5d0, 0xa5d4a5d2, 0xa5d6a5d4, 0xa5d8a5d6, 0xa5daa5d8, 0xa5dca5da, 0xa5dea5dc, 0xa5e0a5de
  .long 0xa5e2a5e0, 0xa5e4a5e2, 0xa5e6a5e4, 0xa5e8a5e6, 0xa5eaa5e8, 0xa5eca5ea, 0xa5eea5ec, 0xa5f0a5ee
  .long 0xa5f2a5f0, 0xa5f4a5f2, 0xa5f6a5f4, 0xa5f8a5f6, 0xa5faa5f8, 0xa5fca5fa, 0xa5fea5fc, 0xa600a5fe
  .long 0xa602a600, 0xa604a602, 0xa606a604, 0xa608a606, 0xa60aa608, 0xa60ca60a, 0xa60ea60c, 0xa610a60e
  .long 0xa612a610, 0xa614a612, 0xa616a614, 0xa618a616, 0xa61aa618, 0xa61ca61a, 0xa61ea61c, 0xa620a61e
  .long 0xa622a620, 0xa624a622, 0xa626a624, 0xa628a626, 0xa62aa628, 0xa62ca62a, 0xa62ea62c, 0xa630a62e
  .long 0xa632a630, 0xa634a632, 0xa636a634, 0xa638a636, 0xa63aa638, 0xa63ca63a, 0xa63ea63c, 0xa640a63e
  .long 0xa642a640, 0xa644a642, 0xa646a644, 0xa648a646, 0xa64aa648, 0xa64ca64a, 0xa64ea64c, 0xa650a64e
  .long 0xa652a650, 0xa654a652, 0xa656a654, 0xa658a656, 0xa65aa658, 0xa65ca65a, 0xa65ea65c, 0xa660a65e
  .long 0xa662a660, 0xa664a662, 0xa666a664, 0xa668a666, 0xa66aa668, 0xa66ca66a, 0xa66ea66c, 0xa670a66e
  .long 0xa672a670, 0xa674a672, 0xa676a674, 0xa678a676, 0xa67aa678, 0xa67ca67a, 0xa67ea67c, 0xa680a67e
  .long 0xa682a680, 0xa684a682, 0xa686a684, 0xa688a686, 0xa68aa688, 0xa68ca68a, 0xa68ea68c, 0xa690a68e
  .long 0xa692a690, 0xa694a692, 0xa696a694, 0xa698a696, 0xa69aa698, 0xa69ca69a, 0xa69ea69c, 0xa6a0a69e
  .long 0xa6a2a6a0, 0xa6a4a6a2, 0xa6a6a6a4, 0xa6a8a6a6, 0xa6aaa6a8, 0xa6aca6aa, 0xa6aea6ac, 0xa6b0a6ae
  .long 0xa6b2a6b0, 0xa6b4a6b2, 0xa6b6a6b4, 0xa6b8a6b6, 0xa6baa6b8, 0xa6bca6ba, 0xa6bea6bc, 0xa6c0a6be
  .long 0xa6c2a6c0, 0xa6c4a6c2, 0xa6c6a6c4, 0xa6c8a6c6, 0xa6caa6c8, 0xa6cca6ca, 0xa6cea6cc, 0xa6d0a6ce
  .long 0xa6d2a6d0, 0xa6d4a6d2, 0xa6d6a6d4, 0xa6d8a6d6, 0xa6daa6d8, 0xa6dca6da, 0xa6dea6dc, 0xa6e0a6de
  .long 0xa6e2a6e0, 0xa6e4a6e2, 0xa6e6a6e4, 0xa6e8a6e6, 0xa6eaa6e8, 0xa6eca6ea, 0xa6eea6ec, 0xa6f0a6ee
  .long 0xa6f2a6f0, 0xa6f4a6f2, 0xa6f6a6f4, 0xa6f8a6f6, 0xa6faa6f8, 0xa6fca6fa, 0xa6fea6fc, 0xa700a6fe
  .long 0xa702a700, 0xa704a702, 0xa706a704, 0xa708a706, 0xa70aa708, 0xa70ca70a, 0xa70ea70c, 0xa710a70e
  .long 0xa712a710, 0xa714a712, 0xa716a714, 0xa718a716, 0xa71aa718, 0xa71ca71a, 0xa71ea71c, 0xa720a71e
  .long 0xa722a720, 0xa724a722, 0xa726a724, 0xa728a726, 0xa72aa728, 0xa72ca72a, 0xa72ea72c, 0xa730a72e
  .long 0xa732a730, 0xa734a732, 0xa736a734, 0xa738a736, 0xa73aa738, 0xa73ca73a, 0xa73ea73c, 0xa740a73e
  .long 0xa742a740, 0xa744a742, 0xa746a744, 0xa748a746, 0xa74aa748, 0xa74ca74a, 0xa74ea74c, 0xa750a74e
  .long 0xa752a750, 0xa754a752, 0xa756a754, 0xa758a756, 0xa75aa758, 0xa75ca75a, 0xa75ea75c, 0xa760a75e
  .long 0xa762a760, 0xa764a762, 0xa766a764, 0xa768a766, 0xa76aa768, 0xa76ca76a, 0xa76ea76c, 0xa770a76e
  .long 0xa772a770, 0xa774a772, 0xa776a774, 0xa778a776, 0xa77aa778, 0xa77ca77a, 0xa77ea77c, 0xa780a77e
  .long 0xa782a780, 0xa784a782, 0xa786a784, 0xa788a786, 0xa78aa788, 0xa78ca78a, 0xa78ea78c, 0xa790a78e
  .long 0xa792a790, 0xa794a792, 0xa796a794, 0xa798a796, 0xa79aa798, 0xa79ca79a, 0xa79ea79c, 0xa7a0a79e
  .long 0xa7a2a7a0, 0xa7a4a7a2, 0xa7a6a7a4, 0xa7a8a7a6, 0xa7aaa7a8, 0xa7aca7aa, 0xa7aea7ac, 0xa7b0a7ae
  .long 0xa7b2a7b0, 0xa7b4a7b2, 0xa7b6a7b4, 0xa7b8a7b6, 0xa7baa7b8, 0xa7bca7ba, 0xa7bea7bc, 0xa7c0a7be
  .long 0xa7c2a7c0, 0xa7c4a7c2, 0xa7c6a7c4, 0xa7c8a7c6, 0xa7caa7c8, 0xa7cca7ca, 0xa7cea7cc, 0xa7d0a7ce
  .long 0xa7d2a7d0, 0xa7d4a7d2, 0xa7d6a7d4, 0xa7d8a7d6, 0xa7daa7d8, 0xa7dca7da, 0xa7dea7dc, 0xa7e0a7de
  .long 0xa7e2a7e0, 0xa7e4a7e2, 0xa7e6a7e4, 0xa7e8a7e6, 0xa7eaa7e8, 0xa7eca7ea, 0xa7eea7ec, 0xa7f0a7ee
  .long 0xa7f2a7f0, 0xa7f4a7f2, 0xa7f6a7f4, 0xa7f8a7f6, 0xa7faa7f8, 0xa7fca7fa, 0xa7fea7fc, 0xa800a7fe
  .long 0xa802a800, 0xa804a802, 0xa806a804, 0xa808a806, 0xa80aa808, 0xa80ca80a, 0xa80ea80c, 0xa810a80e
  .long 0xa812a810, 0xa814a812, 0xa816a814, 0xa818a816, 0xa81aa818, 0xa81ca81a, 0xa81ea81c, 0xa820a81e
  .long 0xa822a820, 0xa824a822, 0xa826a824, 0xa828a826, 0xa82aa828, 0xa82ca82a, 0xa82ea82c, 0xa830a82e
  .long 0xa832a830, 0xa834a832, 0xa836a834, 0xa838a836, 0xa83aa838, 0xa83ca83a, 0xa83ea83c, 0xa840a83e
  .long 0xa842a840, 0xa844a842, 0xa846a844, 0xa848a846, 0xa84aa848, 0xa84ca84a, 0xa84ea84c, 0xa850a84e
  .long 0xa852a850, 0xa854a852, 0xa856a854, 0xa858a856, 0xa85aa858, 0xa85ca85a, 0xa85ea85c, 0xa860a85e
  .long 0xa862a860, 0xa864a862, 0xa866a864, 0xa868a866, 0xa86aa868, 0xa86ca86a, 0xa86ea86c, 0xa870a86e
  .long 0xa872a870, 0xa874a872, 0xa876a874, 0xa878a876, 0xa87aa878, 0xa87ca87a, 0xa87ea87c, 0xa880a87e
  .long 0xa882a880, 0xa884a882, 0xa886a884, 0xa888a886, 0xa88aa888, 0xa88ca88a, 0xa88ea88c, 0xa890a88e
  .long 0xa892a890, 0xa894a892, 0xa896a894, 0xa898a896, 0xa89aa898, 0xa89ca89a, 0xa89ea89c, 0xa8a0a89e
  .long 0xa8a2a8a0, 0xa8a4a8a2, 0xa8a6a8a4, 0xa8a8a8a6, 0xa8aaa8a8, 0xa8aca8aa, 0xa8aea8ac, 0xa8b0a8ae
  .long 0xa8b2a8b0, 0xa8b4a8b2, 0xa8b6a8b4, 0xa8b8a8b6, 0xa8baa8b8, 0xa8bca8ba, 0xa8bea8bc, 0xa8c0a8be
  .long 0xa8c2a8c0, 0xa8c4a8c2, 0xa8c6a8c4, 0xa8c8a8c6, 0xa8caa8c8, 0xa8cca8ca, 0xa8cea8cc, 0xa8d0a8ce
  .long 0xa8d2a8d0, 0xa8d4a8d2, 0xa8d6a8d4, 0xa8d8a8d6, 0xa8daa8d8, 0xa8dca8da, 0xa8dea8dc, 0xa8e0a8de
  .long 0xa8e2a8e0, 0xa8e4a8e2, 0xa8e6a8e4, 0xa8e8a8e6, 0xa8eaa8e8, 0xa8eca8ea, 0xa8eea8ec, 0xa8f0a8ee
  .long 0xa8f2a8f0, 0xa8f4a8f2, 0xa8f6a8f4, 0xa8f8a8f6, 0xa8faa8f8, 0xa8fca8fa, 0xa8fea8fc, 0xa900a8fe
  .long 0xa902a900, 0xa904a902, 0xa906a904, 0xa908a906, 0xa90aa908, 0xa90ca90a, 0xa90ea90c, 0xa910a90e
  .long 0xa912a910, 0xa914a912, 0xa916a914, 0xa918a916, 0xa91aa918, 0xa91ca91a, 0xa91ea91c, 0xa920a91e
  .long 0xa922a920, 0xa924a922, 0xa926a924, 0xa928a926, 0xa92aa928, 0xa92ca92a, 0xa92ea92c, 0xa930a92e
  .long 0xa932a930, 0xa934a932, 0xa936a934, 0xa938a936, 0xa93aa938, 0xa93ca93a, 0xa93ea93c, 0xa940a93e
  .long 0xa942a940, 0xa944a942, 0xa946a944, 0xa948a946, 0xa94aa948, 0xa94ca94a, 0xa94ea94c, 0xa950a94e
  .long 0xa952a950, 0xa954a952, 0xa956a954, 0xa958a956, 0xa95aa958, 0xa95ca95a, 0xa95ea95c, 0xa960a95e
  .long 0xa962a960, 0xa964a962, 0xa966a964, 0xa968a966, 0xa96aa968, 0xa96ca96a, 0xa96ea96c, 0xa970a96e
  .long 0xa972a970, 0xa974a972, 0xa976a974, 0xa978a976, 0xa97aa978, 0xa97ca97a, 0xa97ea97c, 0xa980a97e
  .long 0xa982a980, 0xa984a982, 0xa986a984, 0xa988a986, 0xa98aa988, 0xa98ca98a, 0xa98ea98c, 0xa990a98e
  .long 0xa992a990, 0xa994a992, 0xa996a994, 0xa998a996, 0xa99aa998, 0xa99ca99a, 0xa99ea99c, 0xa9a0a99e
  .long 0xa9a2a9a0, 0xa9a4a9a2, 0xa9a6a9a4, 0xa9a8a9a6, 0xa9aaa9a8, 0xa9aca9aa, 0xa9aea9ac, 0xa9b0a9ae
  .long 0xa9b2a9b0, 0xa9b4a9b2, 0xa9b6a9b4, 0xa9b8a9b6, 0xa9baa9b8, 0xa9bca9ba, 0xa9bea9bc, 0xa9c0a9be
  .long 0xa9c2a9c0, 0xa9c4a9c2, 0xa9c6a9c4, 0xa9c8a9c6, 0xa9caa9c8, 0xa9cca9ca, 0xa9cea9cc, 0xa9d0a9ce
  .long 0xa9d2a9d0, 0xa9d4a9d2, 0xa9d6a9d4, 0xa9d8a9d6, 0xa9daa9d8, 0xa9dca9da, 0xa9dea9dc, 0xa9e0a9de
  .long 0xa9e2a9e0, 0xa9e4a9e2, 0xa9e6a9e4, 0xa9e8a9e6, 0xa9eaa9e8, 0xa9eca9ea, 0xa9eea9ec, 0xa9f0a9ee
  .long 0xa9f2a9f0, 0xa9f4a9f2, 0xa9f6a9f4, 0xa9f8a9f6, 0xa9faa9f8, 0xa9fca9fa, 0xa9fea9fc, 0xaa00a9fe
  .long 0xaa02aa00, 0xaa04aa02, 0xaa06aa04, 0xaa08aa06, 0xaa0aaa08, 0xaa0caa0a, 0xaa0eaa0c, 0xaa10aa0e
  .long 0xaa12aa10, 0xaa14aa12, 0xaa16aa14, 0xaa18aa16, 0xaa1aaa18, 0xaa1caa1a, 0xaa1eaa1c, 0xaa20aa1e
  .long 0xaa22aa20, 0xaa24aa22, 0xaa26aa24, 0xaa28aa26, 0xaa2aaa28, 0xaa2caa2a, 0xaa2eaa2c, 0xaa30aa2e
  .long 0xaa32aa30, 0xaa34aa32, 0xaa36aa34, 0xaa38aa36, 0xaa3aaa38, 0xaa3caa3a, 0xaa3eaa3c, 0xaa40aa3e
  .long 0xaa42aa40, 0xaa44aa42, 0xaa46aa44, 0xaa48aa46, 0xaa4aaa48, 0xaa4caa4a, 0xaa4eaa4c, 0xaa50aa4e
  .long 0xaa52aa50, 0xaa54aa52, 0xaa56aa54, 0xaa58aa56, 0xaa5aaa58, 0xaa5caa5a, 0xaa5eaa5c, 0xaa60aa5e
  .long 0xaa62aa60, 0xaa64aa62, 0xaa66aa64, 0xaa68aa66, 0xaa6aaa68, 0xaa6caa6a, 0xaa6eaa6c, 0xaa70aa6e
  .long 0xaa72aa70, 0xaa74aa72, 0xaa76aa74, 0xaa78aa76, 0xaa7aaa78, 0xaa7caa7a, 0xaa7eaa7c, 0xaa80aa7e
  .long 0xaa82aa80, 0xaa84aa82, 0xaa86aa84, 0xaa88aa86, 0xaa8aaa88, 0xaa8caa8a, 0xaa8eaa8c, 0xaa90aa8e
  .long 0xaa92aa90, 0xaa94aa92, 0xaa96aa94, 0xaa98aa96, 0xaa9aaa98, 0xaa9caa9a, 0xaa9eaa9c, 0xaaa0aa9e
  .long 0xaaa2aaa0, 0xaaa4aaa2, 0xaaa6aaa4, 0xaaa8aaa6, 0xaaaaaaa8, 0xaaacaaaa, 0xaaaeaaac, 0xaab0aaae
  .long 0xaab2aab0, 0xaab4aab2, 0xaab6aab4, 0xaab8aab6, 0xaabaaab8, 0xaabcaaba, 0xaabeaabc, 0xaac0aabe
  .long 0xaac2aac0, 0xaac4aac2, 0xaac6aac4, 0xaac8aac6, 0xaacaaac8, 0xaaccaaca, 0xaaceaacc, 0xaad0aace
  .long 0xaad2aad0, 0xaad4aad2, 0xaad6aad4, 0xaad8aad6, 0xaadaaad8, 0xaadcaada, 0xaadeaadc, 0xaae0aade
  .long 0xaae2aae0, 0xaae4aae2, 0xaae6aae4, 0xaae8aae6, 0xaaeaaae8, 0xaaecaaea, 0xaaeeaaec, 0xaaf0aaee
  .long 0xaaf2aaf0, 0xaaf4aaf2, 0xaaf6aaf4, 0xaaf8aaf6, 0xaafaaaf8, 0xaafcaafa, 0xaafeaafc, 0xab00aafe
  .long 0xab02ab00, 0xab04ab02, 0xab06ab04, 0xab08ab06, 0xab0aab08, 0xab0cab0a, 0xab0eab0c, 0xab10ab0e
  .long 0xab12ab10, 0xab14ab12, 0xab16ab14, 0xab18ab16, 0xab1aab18, 0xab1cab1a, 0xab1eab1c, 0xab20ab1e
  .long 0xab22ab20, 0xab24ab22, 0xab26ab24, 0xab28ab26, 0xab2aab28, 0xab2cab2a, 0xab2eab2c, 0xab30ab2e
  .long 0xab32ab30, 0xab34ab32, 0xab36ab34, 0xab38ab36, 0xab3aab38, 0xab3cab3a, 0xab3eab3c, 0xab40ab3e
  .long 0xab42ab40, 0xab44ab42, 0xab46ab44, 0xab48ab46, 0xab4aab48, 0xab4cab4a, 0xab4eab4c, 0xab50ab4e
  .long 0xab52ab50, 0xab54ab52, 0xab56ab54, 0xab58ab56, 0xab5aab58, 0xab5cab5a, 0xab5eab5c, 0xab60ab5e
  .long 0xab62ab60, 0xab64ab62, 0xab66ab64, 0xab68ab66, 0xab6aab68, 0xab6cab6a, 0xab6eab6c, 0xab70ab6e
  .long 0xab72ab70, 0xab74ab72, 0xab76ab74, 0xab78ab76, 0xab7aab78, 0xab7cab7a, 0xab7eab7c, 0xab80ab7e
  .long 0xab82ab80, 0xab84ab82, 0xab86ab84, 0xab88ab86, 0xab8aab88, 0xab8cab8a, 0xab8eab8c, 0xab90ab8e
  .long 0xab92ab90, 0xab94ab92, 0xab96ab94, 0xab98ab96, 0xab9aab98, 0xab9cab9a, 0xab9eab9c, 0xaba0ab9e
  .long 0xaba2aba0, 0xaba4aba2, 0xaba6aba4, 0xaba8aba6, 0xabaaaba8, 0xabacabaa, 0xabaeabac, 0xabb0abae
  .long 0xabb2abb0, 0xabb4abb2, 0xabb6abb4, 0xabb8abb6, 0xabbaabb8, 0xabbcabba, 0xabbeabbc, 0xabc0abbe
  .long 0xabc2abc0, 0xabc4abc2, 0xabc6abc4, 0xabc8abc6, 0xabcaabc8, 0xabccabca, 0xabceabcc, 0xabd0abce
  .long 0xabd2abd0, 0xabd4abd2, 0xabd6abd4, 0xabd8abd6, 0xabdaabd8, 0xabdcabda, 0xabdeabdc, 0xabe0abde
  .long 0xabe2abe0, 0xabe4abe2, 0xabe6abe4, 0xabe8abe6, 0xabeaabe8, 0xabecabea, 0xabeeabec, 0xabf0abee
  .long 0xabf2abf0, 0xabf4abf2, 0xabf6abf4, 0xabf8abf6, 0xabfaabf8, 0xabfcabfa, 0xabfeabfc, 0xac00abfe
  .long 0xac02ac00, 0xac04ac02, 0xac06ac04, 0xac08ac06, 0xac0aac08, 0xac0cac0a, 0xac0eac0c, 0xac10ac0e
  .long 0xac12ac10, 0xac14ac12, 0xac16ac14, 0xac18ac16, 0xac1aac18, 0xac1cac1a, 0xac1eac1c, 0xac20ac1e
  .long 0xac22ac20, 0xac24ac22, 0xac26ac24, 0xac28ac26, 0xac2aac28, 0xac2cac2a, 0xac2eac2c, 0xac30ac2e
  .long 0xac32ac30, 0xac34ac32, 0xac36ac34, 0xac38ac36, 0xac3aac38, 0xac3cac3a, 0xac3eac3c, 0xac40ac3e
  .long 0xac42ac40, 0xac44ac42, 0xac46ac44, 0xac48ac46, 0xac4aac48, 0xac4cac4a, 0xac4eac4c, 0xac50ac4e
  .long 0xac52ac50, 0xac54ac52, 0xac56ac54, 0xac58ac56, 0xac5aac58, 0xac5cac5a, 0xac5eac5c, 0xac60ac5e
  .long 0xac62ac60, 0xac64ac62, 0xac66ac64, 0xac68ac66, 0xac6aac68, 0xac6cac6a, 0xac6eac6c, 0xac70ac6e
  .long 0xac72ac70, 0xac74ac72, 0xac76ac74, 0xac78ac76, 0xac7aac78, 0xac7cac7a, 0xac7eac7c, 0xac80ac7e
  .long 0xac82ac80, 0xac84ac82, 0xac86ac84, 0xac88ac86, 0xac8aac88, 0xac8cac8a, 0xac8eac8c, 0xac90ac8e
  .long 0xac92ac90, 0xac94ac92, 0xac96ac94, 0xac98ac96, 0xac9aac98, 0xac9cac9a, 0xac9eac9c, 0xaca0ac9e
  .long 0xaca2aca0, 0xaca4aca2, 0xaca6aca4, 0xaca8aca6, 0xacaaaca8, 0xacacacaa, 0xacaeacac, 0xacb0acae
  .long 0xacb2acb0, 0xacb4acb2, 0xacb6acb4, 0xacb8acb6, 0xacbaacb8, 0xacbcacba, 0xacbeacbc, 0xacc0acbe
  .long 0xacc2acc0, 0xacc4acc2, 0xacc6acc4, 0xacc8acc6, 0xaccaacc8, 0xacccacca, 0xacceaccc, 0xacd0acce
  .long 0xacd2acd0, 0xacd4acd2, 0xacd6acd4, 0xacd8acd6, 0xacdaacd8, 0xacdcacda, 0xacdeacdc, 0xace0acde
  .long 0xace2ace0, 0xace4ace2, 0xace6ace4, 0xace8ace6, 0xaceaace8, 0xacecacea, 0xaceeacec, 0xacf0acee
  .long 0xacf2acf0, 0xacf4acf2, 0xacf6acf4, 0xacf8acf6, 0xacfaacf8, 0xacfcacfa, 0xacfeacfc, 0xad00acfe
  .long 0xad02ad00, 0xad04ad02, 0xad06ad04, 0xad08ad06, 0xad0aad08, 0xad0cad0a, 0xad0ead0c, 0xad10ad0e
  .long 0xad12ad10, 0xad14ad12, 0xad16ad14, 0xad18ad16, 0xad1aad18, 0xad1cad1a, 0xad1ead1c, 0xad20ad1e
  .long 0xad22ad20, 0xad24ad22, 0xad26ad24, 0xad28ad26, 0xad2aad28, 0xad2cad2a, 0xad2ead2c, 0xad30ad2e
  .long 0xad32ad30, 0xad34ad32, 0xad36ad34, 0xad38ad36, 0xad3aad38, 0xad3cad3a, 0xad3ead3c, 0xad40ad3e
  .long 0xad42ad40, 0xad44ad42, 0xad46ad44, 0xad48ad46, 0xad4aad48, 0xad4cad4a, 0xad4ead4c, 0xad50ad4e
  .long 0xad52ad50, 0xad54ad52, 0xad56ad54, 0xad58ad56, 0xad5aad58, 0xad5cad5a, 0xad5ead5c, 0xad60ad5e
  .long 0xad62ad60, 0xad64ad62, 0xad66ad64, 0xad68ad66, 0xad6aad68, 0xad6cad6a, 0xad6ead6c, 0xad70ad6e
  .long 0xad72ad70, 0xad74ad72, 0xad76ad74, 0xad78ad76, 0xad7aad78, 0xad7cad7a, 0xad7ead7c, 0xad80ad7e
  .long 0xad82ad80, 0xad84ad82, 0xad86ad84, 0xad88ad86, 0xad8aad88, 0xad8cad8a, 0xad8ead8c, 0xad90ad8e
  .long 0xad92ad90, 0xad94ad92, 0xad96ad94, 0xad98ad96, 0xad9aad98, 0xad9cad9a, 0xad9ead9c, 0xada0ad9e
  .long 0xada2ada0, 0xada4ada2, 0xada6ada4, 0xada8ada6, 0xadaaada8, 0xadacadaa, 0xadaeadac, 0xadb0adae
  .long 0xadb2adb0, 0xadb4adb2, 0xadb6adb4, 0xadb8adb6, 0xadbaadb8, 0xadbcadba, 0xadbeadbc, 0xadc0adbe
  .long 0xadc2adc0, 0xadc4adc2, 0xadc6adc4, 0xadc8adc6, 0xadcaadc8, 0xadccadca, 0xadceadcc, 0xadd0adce
  .long 0xadd2add0, 0xadd4add2, 0xadd6add4, 0xadd8add6, 0xaddaadd8, 0xaddcadda, 0xaddeaddc, 0xade0adde
  .long 0xade2ade0, 0xade4ade2, 0xade6ade4, 0xade8ade6, 0xadeaade8, 0xadecadea, 0xadeeadec, 0xadf0adee
  .long 0xadf2adf0, 0xadf4adf2, 0xadf6adf4, 0xadf8adf6, 0xadfaadf8, 0xadfcadfa, 0xadfeadfc, 0xae00adfe
  .long 0xae02ae00, 0xae04ae02, 0xae06ae04, 0xae08ae06, 0xae0aae08, 0xae0cae0a, 0xae0eae0c, 0xae10ae0e
  .long 0xae12ae10, 0xae14ae12, 0xae16ae14, 0xae18ae16, 0xae1aae18, 0xae1cae1a, 0xae1eae1c, 0xae20ae1e
  .long 0xae22ae20, 0xae24ae22, 0xae26ae24, 0xae28ae26, 0xae2aae28, 0xae2cae2a, 0xae2eae2c, 0xae30ae2e
  .long 0xae32ae30, 0xae34ae32, 0xae36ae34, 0xae38ae36, 0xae3aae38, 0xae3cae3a, 0xae3eae3c, 0xae40ae3e
  .long 0xae42ae40, 0xae44ae42, 0xae46ae44, 0xae48ae46, 0xae4aae48, 0xae4cae4a, 0xae4eae4c, 0xae50ae4e
  .long 0xae52ae50, 0xae54ae52, 0xae56ae54, 0xae58ae56, 0xae5aae58, 0xae5cae5a, 0xae5eae5c, 0xae60ae5e
  .long 0xae62ae60, 0xae64ae62, 0xae66ae64, 0xae68ae66, 0xae6aae68, 0xae6cae6a, 0xae6eae6c, 0xae70ae6e
  .long 0xae72ae70, 0xae74ae72, 0xae76ae74, 0xae78ae76, 0xae7aae78, 0xae7cae7a, 0xae7eae7c, 0xae80ae7e
  .long 0xae82ae80, 0xae84ae82, 0xae86ae84, 0xae88ae86, 0xae8aae88, 0xae8cae8a, 0xae8eae8c, 0xae90ae8e
  .long 0xae92ae90, 0xae94ae92, 0xae96ae94, 0xae98ae96, 0xae9aae98, 0xae9cae9a, 0xae9eae9c, 0xaea0ae9e
  .long 0xaea2aea0, 0xaea4aea2, 0xaea6aea4, 0xaea8aea6, 0xaeaaaea8, 0xaeacaeaa, 0xaeaeaeac, 0xaeb0aeae
  .long 0xaeb2aeb0, 0xaeb4aeb2, 0xaeb6aeb4, 0xaeb8aeb6, 0xaebaaeb8, 0xaebcaeba, 0xaebeaebc, 0xaec0aebe
  .long 0xaec2aec0, 0xaec4aec2, 0xaec6aec4, 0xaec8aec6, 0xaecaaec8, 0xaeccaeca, 0xaeceaecc, 0xaed0aece
  .long 0xaed2aed0, 0xaed4aed2, 0xaed6aed4, 0xaed8aed6, 0xaedaaed8, 0xaedcaeda, 0xaedeaedc, 0xaee0aede
  .long 0xaee2aee0, 0xaee4aee2, 0xaee6aee4, 0xaee8aee6, 0xaeeaaee8, 0xaeecaeea, 0xaeeeaeec, 0xaef0aeee
  .long 0xaef2aef0, 0xaef4aef2, 0xaef6aef4, 0xaef8aef6, 0xaefaaef8, 0xaefcaefa, 0xaefeaefc, 0xaf00aefe
  .long 0xaf02af00, 0xaf04af02, 0xaf06af04, 0xaf08af06, 0xaf0aaf08, 0xaf0caf0a, 0xaf0eaf0c, 0xaf10af0e
  .long 0xaf12af10, 0xaf14af12, 0xaf16af14, 0xaf18af16, 0xaf1aaf18, 0xaf1caf1a, 0xaf1eaf1c, 0xaf20af1e
  .long 0xaf22af20, 0xaf24af22, 0xaf26af24, 0xaf28af26, 0xaf2aaf28, 0xaf2caf2a, 0xaf2eaf2c, 0xaf30af2e
  .long 0xaf32af30, 0xaf34af32, 0xaf36af34, 0xaf38af36, 0xaf3aaf38, 0xaf3caf3a, 0xaf3eaf3c, 0xaf40af3e
  .long 0xaf42af40, 0xaf44af42, 0xaf46af44, 0xaf48af46, 0xaf4aaf48, 0xaf4caf4a, 0xaf4eaf4c, 0xaf50af4e
  .long 0xaf52af50, 0xaf54af52, 0xaf56af54, 0xaf58af56, 0xaf5aaf58, 0xaf5caf5a, 0xaf5eaf5c, 0xaf60af5e
  .long 0xaf62af60, 0xaf64af62, 0xaf66af64, 0xaf68af66, 0xaf6aaf68, 0xaf6caf6a, 0xaf6eaf6c, 0xaf70af6e
  .long 0xaf72af70, 0xaf74af72, 0xaf76af74, 0xaf78af76, 0xaf7aaf78, 0xaf7caf7a, 0xaf7eaf7c, 0xaf80af7e
  .long 0xaf82af80, 0xaf84af82, 0xaf86af84, 0xaf88af86, 0xaf8aaf88, 0xaf8caf8a, 0xaf8eaf8c, 0xaf90af8e
  .long 0xaf92af90, 0xaf94af92, 0xaf96af94, 0xaf98af96, 0xaf9aaf98, 0xaf9caf9a, 0xaf9eaf9c, 0xafa0af9e
  .long 0xafa2afa0, 0xafa4afa2, 0xafa6afa4, 0xafa8afa6, 0xafaaafa8, 0xafacafaa, 0xafaeafac, 0xafb0afae
  .long 0xafb2afb0, 0xafb4afb2, 0xafb6afb4, 0xafb8afb6, 0xafbaafb8, 0xafbcafba, 0xafbeafbc, 0xafc0afbe
  .long 0xafc2afc0, 0xafc4afc2, 0xafc6afc4, 0xafc8afc6, 0xafcaafc8, 0xafccafca, 0xafceafcc, 0xafd0afce
  .long 0xafd2afd0, 0xafd4afd2, 0xafd6afd4, 0xafd8afd6, 0xafdaafd8, 0xafdcafda, 0xafdeafdc, 0xafe0afde
  .long 0xafe2afe0, 0xafe4afe2, 0xafe6afe4, 0xafe8afe6, 0xafeaafe8, 0xafecafea, 0xafeeafec, 0xaff0afee
  .long 0xaff2aff0, 0xaff4aff2, 0xaff6aff4, 0xaff8aff6, 0xaffaaff8, 0xaffcaffa, 0xaffeaffc, 0xb000affe
  .long 0xb002b000, 0xb004b002, 0xb006b004, 0xb008b006, 0xb00ab008, 0xb00cb00a, 0xb00eb00c, 0xb010b00e
  .long 0xb012b010, 0xb014b012, 0xb016b014, 0xb018b016, 0xb01ab018, 0xb01cb01a, 0xb01eb01c, 0xb020b01e
  .long 0xb022b020, 0xb024b022, 0xb026b024, 0xb028b026, 0xb02ab028, 0xb02cb02a, 0xb02eb02c, 0xb030b02e
  .long 0xb032b030, 0xb034b032, 0xb036b034, 0xb038b036, 0xb03ab038, 0xb03cb03a, 0xb03eb03c, 0xb040b03e
  .long 0xb042b040, 0xb044b042, 0xb046b044, 0xb048b046, 0xb04ab048, 0xb04cb04a, 0xb04eb04c, 0xb050b04e
  .long 0xb052b050, 0xb054b052, 0xb056b054, 0xb058b056, 0xb05ab058, 0xb05cb05a, 0xb05eb05c, 0xb060b05e
  .long 0xb062b060, 0xb064b062, 0xb066b064, 0xb068b066, 0xb06ab068, 0xb06cb06a, 0xb06eb06c, 0xb070b06e
  .long 0xb072b070, 0xb074b072, 0xb076b074, 0xb078b076, 0xb07ab078, 0xb07cb07a, 0xb07eb07c, 0xb080b07e
  .long 0xb082b080, 0xb084b082, 0xb086b084, 0xb088b086, 0xb08ab088, 0xb08cb08a, 0xb08eb08c, 0xb090b08e
  .long 0xb092b090, 0xb094b092, 0xb096b094, 0xb098b096, 0xb09ab098, 0xb09cb09a, 0xb09eb09c, 0xb0a0b09e
  .long 0xb0a2b0a0, 0xb0a4b0a2, 0xb0a6b0a4, 0xb0a8b0a6, 0xb0aab0a8, 0xb0acb0aa, 0xb0aeb0ac, 0xb0b0b0ae
  .long 0xb0b2b0b0, 0xb0b4b0b2, 0xb0b6b0b4, 0xb0b8b0b6, 0xb0bab0b8, 0xb0bcb0ba, 0xb0beb0bc, 0xb0c0b0be
  .long 0xb0c2b0c0, 0xb0c4b0c2, 0xb0c6b0c4, 0xb0c8b0c6, 0xb0cab0c8, 0xb0ccb0ca, 0xb0ceb0cc, 0xb0d0b0ce
  .long 0xb0d2b0d0, 0xb0d4b0d2, 0xb0d6b0d4, 0xb0d8b0d6, 0xb0dab0d8, 0xb0dcb0da, 0xb0deb0dc, 0xb0e0b0de
  .long 0xb0e2b0e0, 0xb0e4b0e2, 0xb0e6b0e4, 0xb0e8b0e6, 0xb0eab0e8, 0xb0ecb0ea, 0xb0eeb0ec, 0xb0f0b0ee
  .long 0xb0f2b0f0, 0xb0f4b0f2, 0xb0f6b0f4, 0xb0f8b0f6, 0xb0fab0f8, 0xb0fcb0fa, 0xb0feb0fc, 0xb100b0fe
  .long 0xb102b100, 0xb104b102, 0xb106b104, 0xb108b106, 0xb10ab108, 0xb10cb10a, 0xb10eb10c, 0xb110b10e
  .long 0xb112b110, 0xb114b112, 0xb116b114, 0xb118b116, 0xb11ab118, 0xb11cb11a, 0xb11eb11c, 0xb120b11e
  .long 0xb122b120, 0xb124b122, 0xb126b124, 0xb128b126, 0xb12ab128, 0xb12cb12a, 0xb12eb12c, 0xb130b12e
  .long 0xb132b130, 0xb134b132, 0xb136b134, 0xb138b136, 0xb13ab138, 0xb13cb13a, 0xb13eb13c, 0xb140b13e
  .long 0xb142b140, 0xb144b142, 0xb146b144, 0xb148b146, 0xb14ab148, 0xb14cb14a, 0xb14eb14c, 0xb150b14e
  .long 0xb152b150, 0xb154b152, 0xb156b154, 0xb158b156, 0xb15ab158, 0xb15cb15a, 0xb15eb15c, 0xb160b15e
  .long 0xb162b160, 0xb164b162, 0xb166b164, 0xb168b166, 0xb16ab168, 0xb16cb16a, 0xb16eb16c, 0xb170b16e
  .long 0xb172b170, 0xb174b172, 0xb176b174, 0xb178b176, 0xb17ab178, 0xb17cb17a, 0xb17eb17c, 0xb180b17e
  .long 0xb182b180, 0xb184b182, 0xb186b184, 0xb188b186, 0xb18ab188, 0xb18cb18a, 0xb18eb18c, 0xb190b18e
  .long 0xb192b190, 0xb194b192, 0xb196b194, 0xb198b196, 0xb19ab198, 0xb19cb19a, 0xb19eb19c, 0xb1a0b19e
  .long 0xb1a2b1a0, 0xb1a4b1a2, 0xb1a6b1a4, 0xb1a8b1a6, 0xb1aab1a8, 0xb1acb1aa, 0xb1aeb1ac, 0xb1b0b1ae
  .long 0xb1b2b1b0, 0xb1b4b1b2, 0xb1b6b1b4, 0xb1b8b1b6, 0xb1bab1b8, 0xb1bcb1ba, 0xb1beb1bc, 0xb1c0b1be
  .long 0xb1c2b1c0, 0xb1c4b1c2, 0xb1c6b1c4, 0xb1c8b1c6, 0xb1cab1c8, 0xb1ccb1ca, 0xb1ceb1cc, 0xb1d0b1ce
  .long 0xb1d2b1d0, 0xb1d4b1d2, 0xb1d6b1d4, 0xb1d8b1d6, 0xb1dab1d8, 0xb1dcb1da, 0xb1deb1dc, 0xb1e0b1de
  .long 0xb1e2b1e0, 0xb1e4b1e2, 0xb1e6b1e4, 0xb1e8b1e6, 0xb1eab1e8, 0xb1ecb1ea, 0xb1eeb1ec, 0xb1f0b1ee
  .long 0xb1f2b1f0, 0xb1f4b1f2, 0xb1f6b1f4, 0xb1f8b1f6, 0xb1fab1f8, 0xb1fcb1fa, 0xb1feb1fc, 0xb200b1fe
  .long 0xb202b200, 0xb204b202, 0xb206b204, 0xb208b206, 0xb20ab208, 0xb20cb20a, 0xb20eb20c, 0xb210b20e
  .long 0xb212b210, 0xb214b212, 0xb216b214, 0xb218b216, 0xb21ab218, 0xb21cb21a, 0xb21eb21c, 0xb220b21e
  .long 0xb222b220, 0xb224b222, 0xb226b224, 0xb228b226, 0xb22ab228, 0xb22cb22a, 0xb22eb22c, 0xb230b22e
  .long 0xb232b230, 0xb234b232, 0xb236b234, 0xb238b236, 0xb23ab238, 0xb23cb23a, 0xb23eb23c, 0xb240b23e
  .long 0xb242b240, 0xb244b242, 0xb246b244, 0xb248b246, 0xb24ab248, 0xb24cb24a, 0xb24eb24c, 0xb250b24e
  .long 0xb252b250, 0xb254b252, 0xb256b254, 0xb258b256, 0xb25ab258, 0xb25cb25a, 0xb25eb25c, 0xb260b25e
  .long 0xb262b260, 0xb264b262, 0xb266b264, 0xb268b266, 0xb26ab268, 0xb26cb26a, 0xb26eb26c, 0xb270b26e
  .long 0xb272b270, 0xb274b272, 0xb276b274, 0xb278b276, 0xb27ab278, 0xb27cb27a, 0xb27eb27c, 0xb280b27e
  .long 0xb282b280, 0xb284b282, 0xb286b284, 0xb288b286, 0xb28ab288, 0xb28cb28a, 0xb28eb28c, 0xb290b28e
  .long 0xb292b290, 0xb294b292, 0xb296b294, 0xb298b296, 0xb29ab298, 0xb29cb29a, 0xb29eb29c, 0xb2a0b29e
  .long 0xb2a2b2a0, 0xb2a4b2a2, 0xb2a6b2a4, 0xb2a8b2a6, 0xb2aab2a8, 0xb2acb2aa, 0xb2aeb2ac, 0xb2b0b2ae
  .long 0xb2b2b2b0, 0xb2b4b2b2, 0xb2b6b2b4, 0xb2b8b2b6, 0xb2bab2b8, 0xb2bcb2ba, 0xb2beb2bc, 0xb2c0b2be
  .long 0xb2c2b2c0, 0xb2c4b2c2, 0xb2c6b2c4, 0xb2c8b2c6, 0xb2cab2c8, 0xb2ccb2ca, 0xb2ceb2cc, 0xb2d0b2ce
  .long 0xb2d2b2d0, 0xb2d4b2d2, 0xb2d6b2d4, 0xb2d8b2d6, 0xb2dab2d8, 0xb2dcb2da, 0xb2deb2dc, 0xb2e0b2de
  .long 0xb2e2b2e0, 0xb2e4b2e2, 0xb2e6b2e4, 0xb2e8b2e6, 0xb2eab2e8, 0xb2ecb2ea, 0xb2eeb2ec, 0xb2f0b2ee
  .long 0xb2f2b2f0, 0xb2f4b2f2, 0xb2f6b2f4, 0xb2f8b2f6, 0xb2fab2f8, 0xb2fcb2fa, 0xb2feb2fc, 0xb300b2fe
  .long 0xb302b300, 0xb304b302, 0xb306b304, 0xb308b306, 0xb30ab308, 0xb30cb30a, 0xb30eb30c, 0xb310b30e
  .long 0xb312b310, 0xb314b312, 0xb316b314, 0xb318b316, 0xb31ab318, 0xb31cb31a, 0xb31eb31c, 0xb320b31e
  .long 0xb322b320, 0xb324b322, 0xb326b324, 0xb328b326, 0xb32ab328, 0xb32cb32a, 0xb32eb32c, 0xb330b32e
  .long 0xb332b330, 0xb334b332, 0xb336b334, 0xb338b336, 0xb33ab338, 0xb33cb33a, 0xb33eb33c, 0xb340b33e
  .long 0xb342b340, 0xb344b342, 0xb346b344, 0xb348b346, 0xb34ab348, 0xb34cb34a, 0xb34eb34c, 0xb350b34e
  .long 0xb352b350, 0xb354b352, 0xb356b354, 0xb358b356, 0xb35ab358, 0xb35cb35b, 0xb35eb35d, 0xb360b35f
  .long 0xb362b361, 0xb364b363, 0xb366b365, 0xb368b367, 0xb36ab369, 0xb36cb36b, 0xb36eb36d, 0xb370b36f
  .long 0xb372b371, 0xb374b373, 0xb376b375, 0xb378b377, 0xb37ab379, 0xb37cb37b, 0xb37eb37d, 0xb380b37f
  .long 0xb382b380, 0xb384b382, 0xb386b384, 0xb388b386, 0xb38ab388, 0xb38cb38a, 0xb38eb38c, 0xb390b38e
  .long 0xb392b390, 0xb394b392, 0xb396b394, 0xb398b396, 0xb39ab398, 0xb39cb39b, 0xb39eb39d, 0xb3a0b39f
  .long 0xb3a2b3a1, 0xb3a4b3a3, 0xb3a6b3a5, 0xb3a8b3a7, 0xb3aab3a9, 0xb3acb3ab, 0xb3aeb3ad, 0xb3b0b3af
  .long 0xb3b2b3b1, 0xb3b4b3b3, 0xb3b6b3b5, 0xb3b8b3b7, 0xb3bab3b9, 0xb3bcb3bb, 0xb3beb3bd, 0xb3c0b3bf
  .long 0xb3c2b3c1, 0xb3c4b3c3, 0xb3c6b3c5, 0xb3c8b3c7, 0xb3cab3c9, 0xb3ccb3cb, 0xb3ceb3cd, 0xb3d0b3cf
  .long 0xb3d2b3d1, 0xb3d4b3d3, 0xb3d6b3d5, 0xb3d8b3d7, 0xb3dab3d9, 0xb3dcb3db, 0xb3deb3dd, 0xb3e0b3df
  .long 0xb3e2b3e1, 0xb3e4b3e3, 0xb3e6b3e5, 0xb3e8b3e7, 0xb3eab3e9, 0xb3ecb3eb, 0xb3eeb3ed, 0xb3f0b3ef
  .long 0xb3f2b3f1, 0xb3f4b3f3, 0xb3f6b3f5, 0xb3f8b3f7, 0xb3fab3f9, 0xb3fcb3fb, 0xb3feb3fd, 0xb400b3ff
  .long 0xb402b401, 0xb404b403, 0xb406b405, 0xb408b407, 0xb40ab409, 0xb40cb40b, 0xb40eb40d, 0xb410b40f
  .long 0xb412b411, 0xb414b413, 0xb416b415, 0xb418b417, 0xb41ab419, 0xb41cb41b, 0xb41eb41d, 0xb420b41f
  .long 0xb422b421, 0xb424b423, 0xb426b425, 0xb428b427, 0xb42ab429, 0xb42cb42b, 0xb42eb42d, 0xb430b42f
  .long 0xb432b431, 0xb434b433, 0xb436b435, 0xb438b437, 0xb43ab439, 0xb43cb43b, 0xb43eb43d, 0xb440b43f
  .long 0xb442b441, 0xb444b443, 0xb446b445, 0xb448b447, 0xb44ab449, 0xb44cb44b, 0xb44eb44d, 0xb450b44f
  .long 0xb452b451, 0xb454b453, 0xb456b455, 0xb458b457, 0xb45ab459, 0xb45cb45b, 0xb45eb45d, 0xb460b45f
  .long 0xb462b461, 0xb464b463, 0xb466b465, 0xb468b467, 0xb46ab469, 0xb46cb46b, 0xb46eb46d, 0xb470b46f
  .long 0xb472b471, 0xb474b473, 0xb476b475, 0xb478b477, 0xb47ab479, 0xb47cb47b, 0xb47eb47d, 0xb480b47f
  .long 0xb482b481, 0xb484b483, 0xb486b485, 0xb488b487, 0xb48ab489, 0xb48cb48b, 0xb48eb48d, 0xb490b48f
  .long 0xb492b491, 0xb494b493, 0xb496b495, 0xb498b497, 0xb49ab499, 0xb49cb49b, 0xb49eb49d, 0xb4a0b49f
  .long 0xb4a2b4a1, 0xb4a4b4a3, 0xb4a6b4a5, 0xb4a8b4a7, 0xb4aab4a9, 0xb4acb4ab, 0xb4aeb4ad, 0xb4b0b4af
  .long 0xb4b2b4b1, 0xb4b4b4b3, 0xb4b6b4b5, 0xb4b8b4b7, 0xb4bab4b9, 0xb4bcb4bb, 0xb4beb4bd, 0xb4c0b4bf
  .long 0xb4c2b4c1, 0xb4c4b4c3, 0xb4c6b4c5, 0xb4c8b4c7, 0xb4cab4c9, 0xb4ccb4cb, 0xb4ceb4cd, 0xb4d0b4cf
  .long 0xb4d2b4d1, 0xb4d4b4d3, 0xb4d6b4d5, 0xb4d8b4d7, 0xb4dab4d9, 0xb4dcb4db, 0xb4deb4dd, 0xb4e0b4df
  .long 0xb4e2b4e1, 0xb4e4b4e3, 0xb4e6b4e5, 0xb4e8b4e7, 0xb4eab4e9, 0xb4ecb4eb, 0xb4eeb4ed, 0xb4f0b4ef
  .long 0xb4f2b4f1, 0xb4f4b4f3, 0xb4f6b4f5, 0xb4f8b4f7, 0xb4fab4f9, 0xb4fcb4fb, 0xb4feb4fd, 0xb500b4ff
  .long 0xb502b501, 0xb504b503, 0xb506b505, 0xb508b507, 0xb50ab509, 0xb50cb50b, 0xb50eb50d, 0xb510b50f
  .long 0xb512b511, 0xb514b513, 0xb516b515, 0xb518b517, 0xb51ab519, 0xb51cb51b, 0xb51eb51d, 0xb520b51f
  .long 0xb522b521, 0xb524b523, 0xb526b525, 0xb528b527, 0xb52ab529, 0xb52cb52b, 0xb52eb52d, 0xb530b52f
  .long 0xb532b531, 0xb534b533, 0xb536b535, 0xb538b537, 0xb53ab539, 0xb53cb53b, 0xb53eb53d, 0xb540b53f
  .long 0xb542b541, 0xb544b543, 0xb546b545, 0xb548b547, 0xb54ab549, 0xb54cb54b, 0xb54eb54d, 0xb550b54f
  .long 0xb552b551, 0xb554b553, 0xb556b555, 0xb558b557, 0xb55ab559, 0xb55cb55b, 0xb55eb55d, 0xb560b55f
  .long 0xb562b561, 0xb564b563, 0xb566b565, 0xb568b567, 0xb56ab569, 0xb56cb56b, 0xb56eb56d, 0xb570b56f
  .long 0xb572b571, 0xb574b573, 0xb576b575, 0xb578b577, 0xb57ab579, 0xb57cb57b, 0xb57eb57d, 0xb580b57f
  .long 0xb582b581, 0xb584b583, 0xb586b585, 0xb588b587, 0xb58ab589, 0xb58cb58b, 0xb58eb58d, 0xb590b58f
  .long 0xb592b591, 0xb594b593, 0xb596b595, 0xb598b597, 0xb59ab599, 0xb59cb59b, 0xb59eb59d, 0xb5a0b59f
  .long 0xb5a2b5a1, 0xb5a4b5a3, 0xb5a6b5a5, 0xb5a8b5a7, 0xb5aab5a9, 0xb5acb5ab, 0xb5aeb5ad, 0xb5b0b5af
  .long 0xb5b2b5b1, 0xb5b4b5b3, 0xb5b6b5b5, 0xb5b8b5b7, 0xb5bab5b9, 0xb5bcb5bb, 0xb5beb5bd, 0xb5c0b5bf
  .long 0xb5c2b5c1, 0xb5c4b5c3, 0xb5c6b5c5, 0xb5c8b5c7, 0xb5cab5c9, 0xb5ccb5cb, 0xb5ceb5cd, 0xb5d0b5cf
  .long 0xb5d2b5d1, 0xb5d4b5d3, 0xb5d6b5d5, 0xb5d8b5d7, 0xb5dab5d9, 0xb5dcb5db, 0xb5deb5dd, 0xb5e0b5df
  .long 0xb5e2b5e1, 0xb5e4b5e3, 0xb5e6b5e5, 0xb5e8b5e7, 0xb5eab5e9, 0xb5ecb5eb, 0xb5eeb5ed, 0xb5f0b5ef
  .long 0xb5f2b5f1, 0xb5f4b5f3, 0xb5f6b5f5, 0xb5f8b5f7, 0xb5fab5f9, 0xb5fcb5fb, 0xb5feb5fd, 0xb600b5ff
  .long 0xb602b601, 0xb604b603, 0xb606b605, 0xb608b607, 0xb60ab609, 0xb60cb60b, 0xb60eb60d, 0xb610b60f
  .long 0xb612b611, 0xb614b613, 0xb616b615, 0xb618b617, 0xb61ab619, 0xb61cb61b, 0xb61eb61d, 0xb620b61f
  .long 0xb622b621, 0xb624b623, 0xb626b625, 0xb628b627, 0xb62ab629, 0xb62cb62b, 0xb62eb62d, 0xb630b62f
  .long 0xb632b631, 0xb634b633, 0xb636b635, 0xb638b637, 0xb63ab639, 0xb63cb63b, 0xb63eb63d, 0xb640b63f
  .long 0xb642b641, 0xb644b643, 0xb646b645, 0xb648b647, 0xb64ab649, 0xb64cb64b, 0xb64eb64d, 0xb650b64f
  .long 0xb652b651, 0xb654b653, 0xb656b655, 0xb658b657, 0xb65ab659, 0xb65cb65b, 0xb65eb65d, 0xb660b65f
  .long 0xb662b661, 0xb664b663, 0xb666b665, 0xb668b667, 0xb66ab669, 0xb66cb66b, 0xb66eb66d, 0xb670b66f
  .long 0xb672b671, 0xb674b673, 0xb676b675, 0xb678b677, 0xb67ab679, 0xb67cb67b, 0xb67eb67d, 0xb680b67f
  .long 0xb682b681, 0xb684b683, 0xb686b685, 0xb688b687, 0xb68ab689, 0xb68cb68b, 0xb68eb68d, 0xb690b68f
  .long 0xb692b691, 0xb694b693, 0xb696b695, 0xb698b697, 0xb69ab699, 0xb69cb69b, 0xb69eb69d, 0xb6a0b69f
  .long 0xb6a2b6a1, 0xb6a4b6a3, 0xb6a6b6a5, 0xb6a8b6a7, 0xb6aab6a9, 0xb6acb6ab, 0xb6aeb6ad, 0xb6b0b6af
  .long 0xb6b2b6b1, 0xb6b4b6b3, 0xb6b6b6b5, 0xb6b8b6b7, 0xb6bab6b9, 0xb6bcb6bb, 0xb6beb6bd, 0xb6c0b6bf
  .long 0xb6c2b6c1, 0xb6c4b6c3, 0xb6c6b6c5, 0xb6c8b6c7, 0xb6cab6c9, 0xb6ccb6cb, 0xb6ceb6cd, 0xb6d0b6cf
  .long 0xb6d2b6d1, 0xb6d4b6d3, 0xb6d6b6d5, 0xb6d8b6d7, 0xb6dab6d9, 0xb6dcb6db, 0xb6deb6dd, 0xb6e0b6df
  .long 0xb6e2b6e1, 0xb6e4b6e3, 0xb6e6b6e5, 0xb6e8b6e7, 0xb6eab6e9, 0xb6ecb6eb, 0xb6eeb6ed, 0xb6f0b6ef
  .long 0xb6f2b6f1, 0xb6f4b6f3, 0xb6f6b6f5, 0xb6f8b6f7, 0xb6fab6f9, 0xb6fcb6fb, 0xb6feb6fd, 0xb700b6ff
  .long 0xb702b701, 0xb704b703, 0xb706b705, 0xb708b707, 0xb70ab709, 0xb70cb70b, 0xb70eb70d, 0xb710b70f
  .long 0xb712b711, 0xb714b713, 0xb716b715, 0xb718b717, 0xb71ab719, 0xb71cb71b, 0xb71eb71d, 0xb720b71f
  .long 0xb722b721, 0xb724b723, 0xb726b725, 0xb728b727, 0xb72ab729, 0xb72cb72b, 0xb72eb72d, 0xb730b72f
  .long 0xb732b731, 0xb734b733, 0xb736b735, 0xb738b737, 0xb73ab739, 0xb73cb73b, 0xb73eb73d, 0xb740b73f
  .long 0xb742b741, 0xb744b743, 0xb746b745, 0xb748b747, 0xb74ab749, 0xb74cb74b, 0xb74eb74d, 0xb750b74f
  .long 0xb752b751, 0xb754b753, 0xb756b755, 0xb758b757, 0xb75ab759, 0xb75cb75b, 0xb75eb75d, 0xb760b75f
  .long 0xb762b761, 0xb764b763, 0xb766b765, 0xb768b767, 0xb76ab769, 0xb76cb76b, 0xb76eb76d, 0xb770b76f
  .long 0xb772b771, 0xb774b773, 0xb776b775, 0xb778b777, 0xb77ab779, 0xb77cb77b, 0xb77eb77d, 0xb780b77f
  .long 0xb782b781, 0xb784b783, 0xb786b785, 0xb788b787, 0xb78ab789, 0xb78cb78b, 0xb78eb78d, 0xb790b78f
  .long 0xb792b791, 0xb794b793, 0xb796b795, 0xb798b797, 0xb79ab799, 0xb79cb79b, 0xb79eb79d, 0xb7a0b79f
  .long 0xb7a2b7a1, 0xb7a4b7a3, 0xb7a6b7a5, 0xb7a8b7a7, 0xb7aab7a9, 0xb7acb7ab, 0xb7aeb7ad, 0xb7b0b7af
  .long 0xb7b2b7b1, 0xb7b4b7b3, 0xb7b6b7b5, 0xb7b8b7b7, 0xb7bab7b9, 0xb7bcb7bb, 0xb7beb7bd, 0xb7c0b7bf
  .long 0xb7c2b7c1, 0xb7c4b7c3, 0xb7c6b7c5, 0xb7c8b7c7, 0xb7cab7c9, 0xb7ccb7cb, 0xb7ceb7cd, 0xb7d0b7cf
  .long 0xb7d2b7d1, 0xb7d4b7d3, 0xb7d6b7d5, 0xb7d8b7d7, 0xb7dab7d9, 0xb7dcb7db, 0xb7deb7dd, 0xb7e0b7df
  .long 0xb7e2b7e1, 0xb7e4b7e3, 0xb7e6b7e5, 0xb7e8b7e7, 0xb7eab7e9, 0xb7ecb7eb, 0xb7eeb7ed, 0xb7f0b7ef
  .long 0xb7f2b7f1, 0xb7f4b7f3, 0xb7f6b7f5, 0xb7f8b7f7, 0xb7fab7f9, 0xb7fcb7fb, 0xb7feb7fd, 0xb800b7ff
  .long 0xb802b801, 0xb804b803, 0xb806b805, 0xb808b807, 0xb80ab809, 0xb80cb80b, 0xb80eb80d, 0xb810b80f
  .long 0xb812b811, 0xb814b813, 0xb816b815, 0xb818b817, 0xb81ab819, 0xb81cb81b, 0xb81eb81d, 0xb820b81f
  .long 0xb822b821, 0xb824b823, 0xb826b825, 0xb828b827, 0xb82ab829, 0xb82cb82b, 0xb82eb82d, 0xb830b82f
  .long 0xb832b831, 0xb834b833, 0xb836b835, 0xb838b837, 0xb83ab839, 0xb83cb83b, 0xb83eb83d, 0xb840b83f
  .long 0xb842b841, 0xb844b843, 0xb846b845, 0xb848b847, 0xb84ab849, 0xb84cb84b, 0xb84eb84d, 0xb850b84f
  .long 0xb852b851, 0xb854b853, 0xb856b855, 0xb858b857, 0xb85ab859, 0xb85cb85b, 0xb85eb85d, 0xb860b85f
  .long 0xb862b861, 0xb864b863, 0xb866b865, 0xb868b867, 0xb86ab869, 0xb86cb86b, 0xb86eb86d, 0xb870b86f
  .long 0xb872b871, 0xb874b873, 0xb876b875, 0xb878b877, 0xb87ab879, 0xb87cb87b, 0xb87eb87d, 0xb880b87f
  .long 0xb882b881, 0xb884b883, 0xb886b885, 0xb888b887, 0xb88ab889, 0xb88cb88b, 0xb88eb88d, 0xb890b88f
  .long 0xb892b891, 0xb894b893, 0xb896b895, 0xb898b897, 0xb89ab899, 0xb89cb89b, 0xb89eb89d, 0xb8a0b89f
  .long 0xb8a2b8a1, 0xb8a4b8a3, 0xb8a6b8a5, 0xb8a8b8a7, 0xb8aab8a9, 0xb8acb8ab, 0xb8aeb8ad, 0xb8b0b8af
  .long 0xb8b2b8b1, 0xb8b4b8b3, 0xb8b6b8b5, 0xb8b8b8b7, 0xb8bab8b9, 0xb8bcb8bb, 0xb8beb8bd, 0xb8c0b8bf
  .long 0xb8c2b8c1, 0xb8c4b8c3, 0xb8c6b8c5, 0xb8c8b8c7, 0xb8cab8c9, 0xb8ccb8cb, 0xb8ceb8cd, 0xb8d0b8cf
  .long 0xb8d2b8d1, 0xb8d4b8d3, 0xb8d6b8d5, 0xb8d8b8d7, 0xb8dab8d9, 0xb8dcb8db, 0xb8deb8dd, 0xb8e0b8df
  .long 0xb8e2b8e1, 0xb8e4b8e3, 0xb8e6b8e5, 0xb8e8b8e7, 0xb8eab8e9, 0xb8ecb8eb, 0xb8eeb8ed, 0xb8f0b8ef
  .long 0xb8f2b8f1, 0xb8f4b8f3, 0xb8f6b8f5, 0xb8f8b8f7, 0xb8fab8f9, 0xb8fcb8fb, 0xb8feb8fd, 0xb900b8ff
  .long 0xb902b901, 0xb904b903, 0xb906b905, 0xb908b907, 0xb90ab909, 0xb90cb90b, 0xb90eb90d, 0xb910b90f
  .long 0xb912b911, 0xb914b913, 0xb916b915, 0xb918b917, 0xb91ab919, 0xb91cb91b, 0xb91eb91d, 0xb920b91f
  .long 0xb922b921, 0xb924b923, 0xb926b925, 0xb928b927, 0xb92ab929, 0xb92cb92b, 0xb92eb92d, 0xb930b92f
  .long 0xb932b931, 0xb934b933, 0xb936b935, 0xb938b937, 0xb93ab939, 0xb93cb93b, 0xb93eb93d, 0xb940b93f
  .long 0xb942b941, 0xb944b943, 0xb946b945, 0xb948b947, 0xb94ab949, 0xb94cb94b, 0xb94eb94d, 0xb950b94f
  .long 0xb952b951, 0xb954b953, 0xb956b955, 0xb958b957, 0xb95ab959, 0xb95cb95b, 0xb95eb95d, 0xb960b95f
  .long 0xb962b961, 0xb964b963, 0xb966b965, 0xb968b967, 0xb96ab969, 0xb96cb96b, 0xb96eb96d, 0xb970b96f
  .long 0xb972b971, 0xb974b973, 0xb976b975, 0xb978b977, 0xb97ab979, 0xb97cb97b, 0xb97eb97d, 0xb980b97f
  .long 0xb982b981, 0xb984b983, 0xb986b985, 0xb988b987, 0xb98ab989, 0xb98cb98b, 0xb98eb98d, 0xb990b98f
  .long 0xb992b991, 0xb994b993, 0xb996b995, 0xb998b997, 0xb99ab999, 0xb99cb99b, 0xb99eb99d, 0xb9a0b99f
  .long 0xb9a2b9a1, 0xb9a4b9a3, 0xb9a6b9a5, 0xb9a8b9a7, 0xb9aab9a9, 0xb9acb9ab, 0xb9aeb9ad, 0xb9b0b9af
  .long 0xb9b2b9b1, 0xb9b4b9b3, 0xb9b6b9b5, 0xb9b8b9b7, 0xb9bab9b9, 0xb9bcb9bb, 0xb9beb9bd, 0xb9c0b9bf
  .long 0xb9c2b9c1, 0xb9c4b9c3, 0xb9c6b9c5, 0xb9c8b9c7, 0xb9cab9c9, 0xb9ccb9cb, 0xb9ceb9cd, 0xb9d0b9cf
  .long 0xb9d2b9d1, 0xb9d4b9d3, 0xb9d6b9d5, 0xb9d8b9d7, 0xb9dab9d9, 0xb9dcb9db, 0xb9deb9dd, 0xb9e0b9df
  .long 0xb9e2b9e1, 0xb9e4b9e3, 0xb9e6b9e5, 0xb9e8b9e7, 0xb9eab9e9, 0xb9ecb9eb, 0xb9eeb9ed, 0xb9f0b9ef
  .long 0xb9f2b9f1, 0xb9f4b9f3, 0xb9f6b9f5, 0xb9f8b9f7, 0xb9fab9f9, 0xb9fcb9fb, 0xb9feb9fd, 0xba00b9ff
  .long 0xba02ba01, 0xba04ba03, 0xba06ba05, 0xba08ba07, 0xba0aba09, 0xba0cba0b, 0xba0eba0d, 0xba10ba0f
  .long 0xba12ba11, 0xba14ba13, 0xba16ba15, 0xba18ba17, 0xba1aba19, 0xba1cba1b, 0xba1eba1d, 0xba20ba1f
  .long 0xba22ba21, 0xba24ba23, 0xba26ba25, 0xba28ba27, 0xba2aba29, 0xba2cba2b, 0xba2eba2d, 0xba30ba2f
  .long 0xba32ba31, 0xba34ba33, 0xba36ba35, 0xba38ba37, 0xba3aba39, 0xba3cba3b, 0xba3eba3d, 0xba40ba3f
  .long 0xba42ba41, 0xba44ba43, 0xba46ba45, 0xba48ba47, 0xba4aba49, 0xba4cba4b, 0xba4eba4d, 0xba50ba4f
  .long 0xba52ba51, 0xba54ba53, 0xba56ba55, 0xba58ba57, 0xba5aba59, 0xba5cba5b, 0xba5eba5d, 0xba60ba5f
  .long 0xba62ba61, 0xba64ba63, 0xba66ba65, 0xba68ba67, 0xba6aba69, 0xba6cba6b, 0xba6eba6d, 0xba70ba6f
  .long 0xba72ba71, 0xba74ba73, 0xba76ba75, 0xba78ba77, 0xba7aba79, 0xba7cba7b, 0xba7eba7d, 0xba80ba7f
  .long 0xba82ba81, 0xba84ba83, 0xba86ba85, 0xba88ba87, 0xba8aba89, 0xba8cba8b, 0xba8eba8d, 0xba90ba8f
  .long 0xba92ba91, 0xba94ba93, 0xba96ba95, 0xba98ba97, 0xba9aba99, 0xba9cba9b, 0xba9eba9d, 0xbaa0ba9f
  .long 0xbaa2baa1, 0xbaa4baa3, 0xbaa6baa5, 0xbaa8baa7, 0xbaaabaa9, 0xbaacbaab, 0xbaaebaad, 0xbab0baaf
  .long 0xbab2bab1, 0xbab4bab3, 0xbab6bab5, 0xbab8bab7, 0xbababab9, 0xbabcbabb, 0xbabebabd, 0xbac0babf
  .long 0xbac2bac1, 0xbac4bac3, 0xbac6bac5, 0xbac8bac7, 0xbacabac9, 0xbaccbacb, 0xbacebacd, 0xbad0bacf
  .long 0xbad2bad1, 0xbad4bad3, 0xbad6bad5, 0xbad8bad7, 0xbadabad9, 0xbadcbadb, 0xbadebadd, 0xbae0badf
  .long 0xbae2bae1, 0xbae4bae3, 0xbae6bae5, 0xbae8bae7, 0xbaeabae9, 0xbaecbaeb, 0xbaeebaed, 0xbaf0baef
  .long 0xbaf2baf1, 0xbaf4baf3, 0xbaf6baf5, 0xbaf8baf7, 0xbafabaf9, 0xbafcbafb, 0xbafebafd, 0xbb00baff
  .long 0xbb02bb01, 0xbb04bb03, 0xbb06bb05, 0xbb08bb07, 0xbb0abb09, 0xbb0cbb0b, 0xbb0ebb0d, 0xbb10bb0f
  .long 0xbb12bb11, 0xbb14bb13, 0xbb16bb15, 0xbb18bb17, 0xbb1abb19, 0xbb1cbb1b, 0xbb1ebb1d, 0xbb20bb1f
  .long 0xbb22bb21, 0xbb24bb23, 0xbb26bb25, 0xbb28bb27, 0xbb2abb29, 0xbb2cbb2b, 0xbb2ebb2d, 0xbb30bb2f
  .long 0xbb32bb31, 0xbb34bb33, 0xbb36bb35, 0xbb38bb37, 0xbb3abb39, 0xbb3cbb3b, 0xbb3ebb3d, 0xbb40bb3f
  .long 0xbb42bb41, 0xbb44bb43, 0xbb46bb45, 0xbb48bb47, 0xbb4abb49, 0xbb4cbb4b, 0xbb4ebb4d, 0xbb50bb4f
  .long 0xbb52bb51, 0xbb54bb53, 0xbb56bb55, 0xbb58bb57, 0xbb5abb59, 0xbb5cbb5b, 0xbb5ebb5d, 0xbb60bb5f
  .long 0xbb62bb61, 0xbb64bb63, 0xbb66bb65, 0xbb68bb67, 0xbb6abb69, 0xbb6cbb6b, 0xbb6ebb6d, 0xbb70bb6f
  .long 0xbb72bb71, 0xbb74bb73, 0xbb76bb75, 0xbb78bb77, 0xbb7abb79, 0xbb7cbb7b, 0xbb7ebb7d, 0xbb80bb7f
  .long 0xbb82bb81, 0xbb84bb83, 0xbb86bb85, 0xbb88bb87, 0xbb8abb89, 0xbb8cbb8b, 0xbb8ebb8d, 0xbb90bb8f
  .long 0xbb92bb91, 0xbb94bb93, 0xbb96bb95, 0xbb98bb97, 0xbb9abb99, 0xbb9cbb9b, 0xbb9ebb9d, 0xbba0bb9f
  .long 0xbba2bba1, 0xbba4bba3, 0xbba6bba5, 0xbba8bba7, 0xbbaabba9, 0xbbacbbab, 0xbbaebbad, 0xbbb0bbaf
  .long 0xbbb2bbb1, 0xbbb4bbb3, 0xbbb6bbb5, 0xbbb8bbb7, 0xbbbabbb9, 0xbbbcbbbb, 0xbbbebbbd, 0xbbc0bbbf
  .long 0xbbc2bbc1, 0xbbc4bbc3, 0xbbc6bbc5, 0xbbc8bbc7, 0xbbcabbc9, 0xbbccbbcb, 0xbbcebbcd, 0xbbd0bbcf
  .long 0xbbd2bbd1, 0xbbd4bbd3, 0xbbd6bbd5, 0xbbd8bbd7, 0xbbdbbbd9, 0xbbddbbdc, 0xbbdfbbde, 0xbbe1bbe0
  .long 0xbbe3bbe2, 0xbbe5bbe4, 0xbbe7bbe6, 0xbbe9bbe8, 0xbbebbbea, 0xbbedbbec, 0xbbefbbee, 0xbbf1bbf0
  .long 0xbbf3bbf2, 0xbbf5bbf4, 0xbbf7bbf6, 0xbbf9bbf8, 0xbbfbbbfa, 0xbbfdbbfc, 0xbbffbbfe, 0xbc00bc00
  .long 0xbc02bc01, 0xbc04bc03, 0xbc06bc05, 0xbc08bc07, 0xbc0abc09, 0xbc0cbc0b, 0xbc0ebc0d, 0xbc10bc0f
  .long 0xbc12bc11, 0xbc14bc13, 0xbc16bc15, 0xbc18bc17, 0xbc1abc19, 0xbc1dbc1c, 0xbc1fbc1e, 0xbc21bc20
  .long 0xbc23bc22, 0xbc25bc24, 0xbc27bc26, 0xbc29bc28, 0xbc2bbc2a, 0xbc2dbc2c, 0xbc2fbc2e, 0xbc31bc30
  .long 0xbc33bc32, 0xbc35bc34, 0xbc37bc36, 0xbc39bc38, 0xbc3bbc3a, 0xbc3dbc3c, 0xbc3fbc3e, 0xbc41bc40
  .long 0xbc43bc42, 0xbc45bc44, 0xbc47bc46, 0xbc49bc48, 0xbc4bbc4a, 0xbc4dbc4c, 0xbc4fbc4e, 0xbc51bc50
  .long 0xbc53bc52, 0xbc55bc54, 0xbc57bc56, 0xbc59bc58, 0xbc5cbc5a, 0xbc5ebc5d, 0xbc60bc5f, 0xbc62bc61
  .long 0xbc64bc63, 0xbc66bc65, 0xbc68bc67, 0xbc6abc69, 0xbc6cbc6b, 0xbc6ebc6d, 0xbc70bc6f, 0xbc72bc71
  .long 0xbc74bc73, 0xbc76bc75, 0xbc78bc77, 0xbc7abc79, 0xbc7cbc7b, 0xbc7ebc7d, 0xbc80bc7f, 0xbc81bc81
  .long 0xbc83bc82, 0xbc85bc84, 0xbc87bc86, 0xbc89bc88, 0xbc8bbc8a, 0xbc8dbc8c, 0xbc8fbc8e, 0xbc91bc90
  .long 0xbc93bc92, 0xbc95bc94, 0xbc97bc96, 0xbc99bc98, 0xbc9bbc9a, 0xbc9ebc9d, 0xbca0bc9f, 0xbca2bca1
  .long 0xbca4bca3, 0xbca6bca5, 0xbca8bca7, 0xbcaabca9, 0xbcacbcab, 0xbcaebcad, 0xbcb0bcaf, 0xbcb2bcb1
  .long 0xbcb4bcb3, 0xbcb6bcb5, 0xbcb8bcb7, 0xbcbabcb9, 0xbcbcbcbb, 0xbcbebcbd, 0xbcc1bcc0, 0xbcc3bcc2
  .long 0xbcc5bcc4, 0xbcc7bcc6, 0xbcc9bcc8, 0xbccbbcca, 0xbccdbccc, 0xbccfbcce, 0xbcd1bcd0, 0xbcd3bcd2
  .long 0xbcd5bcd4, 0xbcd7bcd6, 0xbcd9bcd8, 0xbcdbbcda, 0xbcdebcdc, 0xbce0bcdf, 0xbce2bce1, 0xbce4bce3
  .long 0xbce6bce5, 0xbce8bce7, 0xbceabce9, 0xbcecbceb, 0xbceebced, 0xbcf0bcef, 0xbcf2bcf1, 0xbcf4bcf3
  .long 0xbcf6bcf5, 0xbcf9bcf7, 0xbcfbbcfa, 0xbcfdbcfc, 0xbcffbcfe, 0xbd00bd00, 0xbd01bd01, 0xbd03bd02
  .long 0xbd04bd03, 0xbd06bd05, 0xbd09bd07, 0xbd0bbd0a, 0xbd0dbd0c, 0xbd0fbd0e, 0xbd11bd10, 0xbd13bd12
  .long 0xbd15bd14, 0xbd17bd16, 0xbd19bd18, 0xbd1bbd1a, 0xbd1dbd1c, 0xbd20bd1f, 0xbd22bd21, 0xbd24bd23
  .long 0xbd26bd25, 0xbd28bd27, 0xbd2abd29, 0xbd2cbd2b, 0xbd2ebd2d, 0xbd30bd2f, 0xbd33bd32, 0xbd35bd34
  .long 0xbd37bd36, 0xbd39bd38, 0xbd3bbd3a, 0xbd3dbd3c, 0xbd3fbd3e, 0xbd41bd40, 0xbd44bd43, 0xbd46bd45
  .long 0xbd48bd47, 0xbd4abd49, 0xbd4cbd4b, 0xbd4ebd4d, 0xbd50bd4f, 0xbd53bd51, 0xbd55bd54, 0xbd57bd56
  .long 0xbd59bd58, 0xbd5bbd5a, 0xbd5dbd5c, 0xbd5fbd5e, 0xbd62bd60, 0xbd64bd63, 0xbd66bd65, 0xbd68bd67
  .long 0xbd6abd69, 0xbd6cbd6b, 0xbd6ebd6d, 0xbd71bd6f, 0xbd73bd72, 0xbd75bd74, 0xbd77bd76, 0xbd79bd78
  .long 0xbd7bbd7a, 0xbd7ebd7c, 0xbd80bd7f, 0xbd81bd80, 0xbd82bd81, 0xbd83bd83, 0xbd84bd84, 0xbd85bd85
  .long 0xbd87bd86, 0xbd89bd88, 0xbd8cbd8a, 0xbd8ebd8d, 0xbd90bd8f, 0xbd92bd91, 0xbd94bd93, 0xbd96bd95
  .long 0xbd99bd98, 0xbd9bbd9a, 0xbd9dbd9c, 0xbd9fbd9e, 0xbda1bda0, 0xbda4bda3, 0xbda6bda5, 0xbda8bda7
  .long 0xbdaabda9, 0xbdadbdab, 0xbdafbdae, 0xbdb1bdb0, 0xbdb3bdb2, 0xbdb5bdb4, 0xbdb8bdb7, 0xbdbabdb9
  .long 0xbdbcbdbb, 0xbdbebdbd, 0xbdc1bdc0, 0xbdc3bdc2, 0xbdc5bdc4, 0xbdc7bdc6, 0xbdcabdc9, 0xbdccbdcb
  .long 0xbdcebdcd, 0xbdd0bdcf, 0xbdd3bdd2, 0xbdd5bdd4, 0xbdd7bdd6, 0xbdd9bdd8, 0xbddcbddb, 0xbddebddd
  .long 0xbde0bddf, 0xbde3bde1, 0xbde5bde4, 0xbde7bde6, 0xbde9bde8, 0xbdecbdeb, 0xbdeebded, 0xbdf0bdef
  .long 0xbdf3bdf2, 0xbdf5bdf4, 0xbdf7bdf6, 0xbdfabdf8, 0xbdfcbdfb, 0xbdfebdfd, 0xbe00bdff, 0xbe01be01
  .long 0xbe03be02, 0xbe04be03, 0xbe05be04, 0xbe06be06, 0xbe07be07, 0xbe08be08, 0xbe0abe09, 0xbe0bbe0a
  .long 0xbe0dbe0c, 0xbe0fbe0e, 0xbe12be10, 0xbe14be13, 0xbe16be15, 0xbe19be17, 0xbe1bbe1a, 0xbe1dbe1c
  .long 0xbe20be1f, 0xbe22be21, 0xbe25be23, 0xbe27be26, 0xbe29be28, 0xbe2cbe2b, 0xbe2ebe2d, 0xbe31be2f
  .long 0xbe33be32, 0xbe36be34, 0xbe38be37, 0xbe3abe39, 0xbe3dbe3c, 0xbe3fbe3e, 0xbe42be41, 0xbe44be43
  .long 0xbe47be45, 0xbe49be48, 0xbe4cbe4a, 0xbe4ebe4d, 0xbe51be4f, 0xbe53be52, 0xbe56be54, 0xbe58be57
  .long 0xbe5bbe59, 0xbe5dbe5c, 0xbe60be5e, 0xbe62be61, 0xbe65be64, 0xbe67be66, 0xbe6abe69, 0xbe6cbe6b
  .long 0xbe6fbe6e, 0xbe72be70, 0xbe74be73, 0xbe77be75, 0xbe79be78, 0xbe7cbe7b, 0xbe7ebe7d, 0xbe81be80
  .long 0xbe82be81, 0xbe83be82, 0xbe84be84, 0xbe86be85, 0xbe87be86, 0xbe88be88, 0xbe8abe89, 0xbe8bbe8a
  .long 0xbe8cbe8c, 0xbe8ebe8d, 0xbe8fbe8e, 0xbe90be90, 0xbe92be91, 0xbe93be92, 0xbe94be94, 0xbe96be95
  .long 0xbe98be97, 0xbe9bbe99, 0xbe9dbe9c, 0xbea0be9f, 0xbea3bea1, 0xbea6bea4, 0xbea8bea7, 0xbeabbeaa
  .long 0xbeaebeac, 0xbeb1beaf, 0xbeb3beb2, 0xbeb6beb5, 0xbeb9beb8, 0xbebcbeba, 0xbebfbebd, 0xbec1bec0
  .long 0xbec4bec3, 0xbec7bec6, 0xbecabec9, 0xbecdbecb, 0xbed0bece, 0xbed3bed1, 0xbed6bed4, 0xbed8bed7
  .long 0xbedbbeda, 0xbedebedd, 0xbee1bee0, 0xbee4bee3, 0xbee7bee6, 0xbeeabee9, 0xbeedbeec, 0xbef0beef
  .long 0xbef3bef2, 0xbef6bef5, 0xbef9bef8, 0xbefcbefb, 0xbeffbefe, 0xbf01bf00, 0xbf03bf02, 0xbf04bf03
  .long 0xbf06bf05, 0xbf07bf06, 0xbf09bf08, 0xbf0abf0a, 0xbf0cbf0b, 0xbf0dbf0d, 0xbf0fbf0e, 0xbf11bf10
  .long 0xbf12bf11, 0xbf14bf13, 0xbf15bf15, 0xbf17bf16, 0xbf18bf18, 0xbf1abf19, 0xbf1cbf1b, 0xbf1dbf1c
  .long 0xbf1fbf1e, 0xbf20bf20, 0xbf22bf21, 0xbf24bf23, 0xbf25bf25, 0xbf27bf26, 0xbf29bf28, 0xbf2abf29
  .long 0xbf2dbf2b, 0xbf30bf2f, 0xbf34bf32, 0xbf37bf35, 0xbf3abf39, 0xbf3ebf3c, 0xbf41bf40, 0xbf45bf43
  .long 0xbf48bf46, 0xbf4bbf4a, 0xbf4fbf4d, 0xbf52bf51, 0xbf56bf54, 0xbf59bf58, 0xbf5dbf5b, 0xbf60bf5f
  .long 0xbf64bf62, 0xbf67bf66, 0xbf6bbf69, 0xbf6fbf6d, 0xbf72bf70, 0xbf76bf74, 0xbf79bf78, 0xbf7dbf7b
  .long 0xbf80bf7f, 0xbf82bf81, 0xbf84bf83, 0xbf86bf85, 0xbf88bf87, 0xbf8abf89, 0xbf8cbf8b, 0xbf8dbf8c
  .long 0xbf8fbf8e, 0xbf91bf90, 0xbf93bf92, 0xbf95bf94, 0xbf97bf96, 0xbf99bf98, 0xbf9bbf9a, 0xbf9dbf9c
  .long 0xbf9fbf9e, 0xbfa0bf9f, 0xbfa2bfa1, 0xbfa4bfa3, 0xbfa6bfa5, 0xbfa8bfa7, 0xbfaabfa9, 0xbfacbfab
  .long 0xbfaebfad, 0xbfb0bfaf, 0xbfb2bfb1, 0xbfb4bfb3, 0xbfb6bfb5, 0xbfb8bfb7, 0xbfbabfb9, 0xbfbcbfbb
  .long 0xbfbebfbd, 0xbfc0bfbf, 0xbfc2bfc1, 0xbfc4bfc3, 0xbfc6bfc5, 0xbfc8bfc7, 0xbfcabfc9, 0xbfccbfcb
  .long 0xbfd0bfce, 0xbfd4bfd2, 0xbfd8bfd6, 0xbfdcbfda, 0xbfe0bfde, 0xbfe5bfe2, 0xbfe9bfe7, 0xbfedbfeb
  .long 0xbff1bfef, 0xbff5bff3, 0xbffabff7, 0xbffebffc, 0xc001c000, 0xc003c002, 0xc005c004, 0xc007c006
  .long 0xc00ac009, 0xc00cc00b, 0xc00ec00d, 0xc010c00f, 0xc012c011, 0xc014c013, 0xc017c015, 0xc019c018
  .long 0xc01bc01a, 0xc01dc01c, 0xc01fc01e, 0xc021c020, 0xc024c022, 0xc026c025, 0xc028c027, 0xc02ac029
  .long 0xc02cc02b, 0xc02ec02d, 0xc031c030, 0xc033c032, 0xc035c034, 0xc037c036, 0xc039c038, 0xc03cc03b
  .long 0xc03ec03d, 0xc040c03f, 0xc042c041, 0xc044c043, 0xc047c046, 0xc049c048, 0xc04bc04a, 0xc04dc04c
  .long 0xc04fc04e, 0xc052c051, 0xc054c053, 0xc056c055, 0xc058c057, 0xc05ac059, 0xc05dc05c, 0xc05fc05e
  .long 0xc061c060, 0xc063c062, 0xc065c064, 0xc068c067, 0xc06ac069, 0xc06cc06b, 0xc06ec06d, 0xc070c06f
  .long 0xc074c072, 0xc079c076, 0xc07dc07b, 0xc081c07f, 0xc083c082, 0xc085c084, 0xc087c086, 0xc089c088
  .long 0xc08cc08a, 0xc08ec08d, 0xc090c08f, 0xc092c091, 0xc094c093, 0xc096c095, 0xc098c097, 0xc09bc09a
  .long 0xc09dc09c, 0xc09fc09e, 0xc0a1c0a0, 0xc0a3c0a2, 0xc0a5c0a4, 0xc0a7c0a6, 0xc0aac0a8, 0xc0acc0ab
  .long 0xc0aec0ad, 0xc0b0c0af, 0xc0b2c0b1, 0xc0b4c0b3, 0xc0b6c0b5, 0xc0b8c0b7, 0xc0bac0b9, 0xc0bdc0bb
  .long 0xc0bfc0be, 0xc0c1c0c0, 0xc0c3c0c2, 0xc0c5c0c4, 0xc0c7c0c6, 0xc0c9c0c8, 0xc0cbc0ca, 0xc0cdc0cc
  .long 0xc0cfc0ce, 0xc0d1c0d0, 0xc0d3c0d2, 0xc0d5c0d4, 0xc0d8c0d7, 0xc0dac0d9, 0xc0dcc0db, 0xc0dec0dd
  .long 0xc0e0c0df, 0xc0e2c0e1, 0xc0e4c0e3, 0xc0e6c0e5, 0xc0e8c0e7, 0xc0eac0e9, 0xc0ecc0eb, 0xc0eec0ed
  .long 0xc0f0c0ef, 0xc0f2c0f1, 0xc0f4c0f3, 0xc0f6c0f5, 0xc0f8c0f7, 0xc0fac0f9, 0xc0fcc0fb, 0xc0fec0fd
  .long 0xc101c100, 0xc103c102, 0xc105c104, 0xc107c106, 0xc109c108, 0xc10bc10a, 0xc10dc10c, 0xc10fc10e
  .long 0xc111c110, 0xc113c112, 0xc115c114, 0xc117c116, 0xc119c118, 0xc11bc11a, 0xc11dc11c, 0xc11fc11e
  .long 0xc121c120, 0xc123c122, 0xc125c124, 0xc127c126, 0xc129c128, 0xc12bc12a, 0xc12dc12c, 0xc12fc12e
  .long 0xc131c130, 0xc133c132, 0xc135c134, 0xc137c136, 0xc139c138, 0xc13bc13a, 0xc13dc13c, 0xc13fc13e
  .long 0xc141c140, 0xc143c142, 0xc145c144, 0xc147c146, 0xc149c148, 0xc14bc14a, 0xc14dc14c, 0xc14fc14e
  .long 0xc151c150, 0xc153c152, 0xc155c154, 0xc157c156, 0xc159c158, 0xc15bc15a, 0xc15dc15c, 0xc15fc15e
  .long 0xc161c160, 0xc163c162, 0xc165c164, 0xc167c166, 0xc169c168, 0xc16bc16a, 0xc16dc16c, 0xc16fc16e
  .long 0xc171c170, 0xc173c172, 0xc175c174, 0xc177c176, 0xc179c178, 0xc17bc17a, 0xc17dc17c, 0xc17fc17e
  .long 0xc181c180, 0xc183c182, 0xc185c184, 0xc187c186, 0xc189c188, 0xc18bc18a, 0xc18dc18c, 0xc18fc18e
  .long 0xc191c190, 0xc193c192, 0xc195c194, 0xc197c196, 0xc199c198, 0xc19bc19a, 0xc19dc19c, 0xc19fc19e
  .long 0xc1a1c1a0, 0xc1a3c1a2, 0xc1a5c1a4, 0xc1a7c1a6, 0xc1a9c1a8, 0xc1abc1aa, 0xc1adc1ac, 0xc1afc1ae
  .long 0xc1b1c1b0, 0xc1b3c1b2, 0xc1b5c1b4, 0xc1b7c1b6, 0xc1b9c1b8, 0xc1bbc1ba, 0xc1bdc1bc, 0xc1bfc1be
  .long 0xc1c1c1c0, 0xc1c3c1c2, 0xc1c6c1c4, 0xc1c8c1c6, 0xc1cac1c8, 0xc1ccc1ca, 0xc1cec1cc, 0xc1d0c1ce
  .long 0xc1d2c1d0, 0xc1d4c1d2, 0xc1d6c1d4, 0xc1d8c1d6, 0xc1dac1d8, 0xc1dcc1da, 0xc1dec1dc, 0xc1e0c1de
  .long 0xc1e2c1e0, 0xc1e4c1e2, 0xc1e6c1e4, 0xc1e8c1e6, 0xc1eac1e8, 0xc1ecc1ea, 0xc1eec1ec, 0xc1f0c1ee
  .long 0xc1f2c1f0, 0xc1f4c1f2, 0xc1f6c1f4, 0xc1f8c1f6, 0xc1fac1f8, 0xc1fcc1fa, 0xc1fec1fc, 0xc200c1fe
  .long 0xc202c200, 0xc204c202, 0xc206c204, 0xc208c206, 0xc20ac208, 0xc20cc20a, 0xc20ec20c, 0xc210c20e
  .long 0xc212c210, 0xc214c212, 0xc216c214, 0xc218c216, 0xc21ac218, 0xc21cc21a, 0xc21ec21c, 0xc220c21e
  .long 0xc222c220, 0xc224c222, 0xc226c224, 0xc228c226, 0xc22ac228, 0xc22cc22a, 0xc22ec22c, 0xc230c22e
  .long 0xc232c230, 0xc234c232, 0xc236c234, 0xc238c236, 0xc23ac238, 0xc23cc23a, 0xc23ec23c, 0xc240c23e
  .long 0xc242c240, 0xc244c242, 0xc246c244, 0xc248c246, 0xc24ac248, 0xc24cc24a, 0xc24ec24c, 0xc250c24e
  .long 0xc252c250, 0xc254c252, 0xc256c254, 0xc258c256, 0xc25ac258, 0xc25cc25a, 0xc25ec25c, 0xc260c25e
  .long 0xc262c260, 0xc264c262, 0xc266c264, 0xc268c266, 0xc26ac268, 0xc26cc26a, 0xc26ec26c, 0xc270c26e
  .long 0xc272c270, 0xc274c272, 0xc276c274, 0xc278c276, 0xc27ac278, 0xc27cc27a, 0xc27ec27c, 0xc280c27e
  .long 0xc282c280, 0xc284c282, 0xc286c284, 0xc288c286, 0xc28ac288, 0xc28cc28a, 0xc28ec28c, 0xc290c28e
  .long 0xc292c290, 0xc294c292, 0xc296c294, 0xc298c296, 0xc29ac298, 0xc29cc29a, 0xc29ec29c, 0xc2a0c29e
  .long 0xc2a2c2a0, 0xc2a4c2a2, 0xc2a6c2a4, 0xc2a8c2a6, 0xc2aac2a8, 0xc2acc2aa, 0xc2aec2ac, 0xc2b0c2ae
  .long 0xc2b2c2b0, 0xc2b4c2b2, 0xc2b6c2b4, 0xc2b8c2b6, 0xc2bac2b8, 0xc2bcc2ba, 0xc2bec2bc, 0xc2c0c2be
  .long 0xc2c2c2c0, 0xc2c4c2c2, 0xc2c6c2c4, 0xc2c8c2c6, 0xc2cac2c8, 0xc2ccc2ca, 0xc2cec2cc, 0xc2d0c2ce
  .long 0xc2d2c2d0, 0xc2d4c2d2, 0xc2d6c2d4, 0xc2d8c2d6, 0xc2dac2d8, 0xc2dcc2da, 0xc2dec2dc, 0xc2e0c2de
  .long 0xc2e2c2e0, 0xc2e4c2e2, 0xc2e6c2e4, 0xc2e8c2e6, 0xc2eac2e8, 0xc2ecc2ea, 0xc2eec2ec, 0xc2f0c2ee
  .long 0xc2f2c2f0, 0xc2f4c2f2, 0xc2f6c2f4, 0xc2f8c2f6, 0xc2fac2f8, 0xc2fcc2fa, 0xc2fec2fc, 0xc300c2fe
  .long 0xc302c300, 0xc304c302, 0xc306c304, 0xc308c306, 0xc30ac308, 0xc30cc30a, 0xc30ec30c, 0xc310c30e
  .long 0xc312c310, 0xc314c312, 0xc316c314, 0xc318c316, 0xc31ac318, 0xc31cc31a, 0xc31ec31c, 0xc320c31e
  .long 0xc322c320, 0xc324c322, 0xc326c324, 0xc328c326, 0xc32ac328, 0xc32cc32a, 0xc32ec32c, 0xc330c32e
  .long 0xc332c330, 0xc334c332, 0xc336c334, 0xc338c336, 0xc33ac338, 0xc33cc33a, 0xc33ec33c, 0xc340c33e
  .long 0xc342c340, 0xc344c342, 0xc346c344, 0xc348c346, 0xc34ac348, 0xc34cc34a, 0xc34ec34c, 0xc350c34e
  .long 0xc352c350, 0xc354c352, 0xc356c354, 0xc358c356, 0xc35ac358, 0xc35cc35a, 0xc35ec35c, 0xc360c35e
  .long 0xc362c360, 0xc364c362, 0xc366c364, 0xc368c366, 0xc36ac368, 0xc36cc36a, 0xc36ec36c, 0xc370c36e
  .long 0xc372c370, 0xc374c372, 0xc376c374, 0xc378c376, 0xc37ac378, 0xc37cc37a, 0xc37ec37c, 0xc380c37e
  .long 0x0, 0x0, 0x0, 0x0, 0x0, 0x0, 0x0, 0x0
  .long 0x0, 0x0, 0x0, 0x0, 0x0, 0x0, 0x0, 0x0
  .long 0x0, 0x0, 0x0, 0x0, 0x0, 0x0, 0x0, 0x0
  .long 0x0, 0x0, 0x0, 0x0, 0x0, 0x0, 0x0, 0x0
  .long 0x0, 0x0, 0x0, 0x0, 0x0, 0x0, 0x0, 0x0
  .long 0x0, 0x0, 0x0, 0x0, 0x0, 0x0, 0x0, 0x0
  .long 0x0, 0x0, 0x0, 0x0, 0x0, 0x0, 0x0, 0x0
  .long 0x0, 0x0, 0x0, 0x0, 0x0, 0x0, 0x0, 0x0
  .size V_TAB, 78848
.section .rodata,"a"
.p2align 6
.amdhsa_kernel gather_scatter__edge_featured_mpnn_mpnn__graph_kernel
  .amdhsa_next_free_vgpr 256
  .amdhsa_next_free_sgpr 102
  .amdhsa_accum_offset 256
  .amdhsa_group_segment_fixed_size 0
  .amdhsa_kernarg_size 88
  .amdhsa_user_sgpr_count 2
  .amdhsa_user_sgpr_kernarg_segment_ptr 1
  .amdhsa_system_sgpr_workgroup_id_x 1
  .amdhsa_float_denorm_mode_32 3
.end_amdhsa_kernel
```
